```python
import torch

def _softmax(x, axis=-1):
    return torch.softmax(x, dim=axis)
def _gelu(x):
    return torch.nn.functional.gelu(x, approximate="tanh")
def _silu(x):
    return torch.nn.functional.silu(x)
def _sigmoid(x):
    return torch.sigmoid(x)
def _layernorm(x, axis=-1, eps=1e-5):
    m = x.mean(dim=axis, keepdim=True)
    v = x.var(dim=axis, keepdim=True, unbiased=False)
    return (x - m) / torch.sqrt(v + eps)
def _scatter_add(tgt, idx, src, axis=0):
    return tgt.clone().index_add_(axis, idx, src)
def _segment_sum(src, seg, n):
    out = torch.zeros((n,) + src.shape[1:], dtype=src.dtype)
    return out.index_add_(0, seg, src)
def _pad(x, pw):
    flat = tuple(v for pair in reversed(pw) for v in pair)
    return torch.nn.functional.pad(x, flat)

kernel_name = 'sequential_preLN__softmax_full_mha__glu_gated_reglu__prompt'

def setup_inputs():

    _w = (lambda a: (lambda t: t.to(torch.bfloat16) if t.is_floating_point() else t)(torch.as_tensor(a)))
    def _A_setup():
        B, S, D = 1, 2048, 640
        return {
            "x": _w((lambda *s: torch.randn(*s, dtype=torch.bfloat16) * 0.05)(B, S, D)),
            "wqkv": _w((lambda *s: torch.randn(*s, dtype=torch.bfloat16) * 0.05)(D, 3 * D)),
            "wo": _w((lambda *s: torch.randn(*s, dtype=torch.bfloat16) * 0.05)(D, D)),
        }
    _A_in = _A_setup()

    def _B_setup():
        B, S, D, F = 1, 2048, 640, 1536
        return {
            "x": _w((lambda *s: torch.randn(*s, dtype=torch.bfloat16) * 0.05)(B, S, D)),
            "W_gate": _w((lambda *s: torch.randn(*s, dtype=torch.bfloat16) * 0.4)(D, F) * (2.0 / D) ** 0.5),
            "W_up": _w((lambda *s: torch.randn(*s, dtype=torch.bfloat16) * 0.4)(D, F) * (2.0 / D) ** 0.5),
            "W_down": _w((lambda *s: torch.randn(*s, dtype=torch.bfloat16) * 0.4)(F, D) * (1.0 / F) ** 0.5),
        }
    _B_in = _B_setup()

    return {
        "A_x": _A_in["x"],
        "A_wqkv": _A_in["wqkv"],
        "A_wo": _A_in["wo"],
        "B_x": _B_in["x"],
        "B_W_gate": _B_in["W_gate"],
        "B_W_up": _B_in["W_up"],
        "B_W_down": _B_in["W_down"],
    }

def reference(A_x, A_wqkv, A_wo, B_x, B_W_gate, B_W_up, B_W_down):
    def _A_ref(x, wqkv, wo):
        B, S, D = x.shape
        H = 32; Dh = D // H
        qkv = (lambda x, *d: x.permute(*d))((x @ wqkv).reshape(B, S, 3, H, Dh), 2, 0, 3, 1, 4)
        q, k, v = qkv[0], qkv[1], qkv[2]
        scale = Dh ** -0.5
        scores = torch.einsum("bhqd,bhkd->bhqk", q, k) * scale
        p = _softmax(scores, axis=-1)
        o = torch.einsum("bhqk,bhkd->bhqd", p, v)
        return (lambda x, *d: x.permute(*d))(o, 0, 2, 1, 3).reshape(B, S, D) @ wo

    def _B_ref(x, W_gate, W_up, W_down):
        gate = torch.einsum("bsd,df->bsf", x, W_gate)
        up = torch.einsum("bsd,df->bsf", x, W_up)
        gate = gate * (lambda x, dt: x.to(dt))(gate > 0, gate.dtype)
        h = gate * up
        return torch.einsum("bsf,fd->bsd", h, W_down)

    x = A_x
    h = x + _A_ref(_layernorm(x, axis=-1), A_wqkv, A_wo)
    h2 = h + _B_ref(_layernorm(h, axis=-1), B_W_gate, B_W_up, B_W_down)
    return h2
```

```asm
; @launch grid=(256,1,1) block=(512,1,1) lds=163840
.amdgcn_target "amdgcn-amd-amdhsa--gfx950"
.text
.globl sequential_preLN__softmax_full_mha__glu_gated_reglu__prompt_kernel
.p2align 8
.type sequential_preLN__softmax_full_mha__glu_gated_reglu__prompt_kernel,@function
sequential_preLN__softmax_full_mha__glu_gated_reglu__prompt_kernel:
L_k1_start:
    s_cmp_ge_u32 s2, 256
    s_cbranch_scc1 L_qkv_end
    s_load_dwordx4 s[4:7], s[0:1], 0
    s_load_dwordx4 s[48:51], s[0:1], 64
    s_load_dwordx2 s[32:33], s[0:1], 16
    s_load_dwordx2 s[34:35], s[0:1], 48
    v_lshrrev_b32 v8, 6, v0
    s_cmp_lt_u32 s2, 16
    v_readfirstlane_b32 s16, v8
    v_readfirstlane_b32 s3, v8
    s_cbranch_scc1 L_qkv_helper
    v_and_b32 v0, 63, v0
    s_sub_u32 s31, s2, 16
    s_and_b32 s22, s31, 7
    s_lshr_b32 s23, s31, 3
    s_lshr_b32 s24, s22, 2
    s_mul_i32 s24, s24, 30
    s_add_u32 s23, s23, s24
    s_lshr_b32 s18, s23, 2
    s_and_b32 s23, s23, 3
    s_and_b32 s24, s22, 3
    s_lshl_b32 s24, s24, 2
    s_add_u32 s17, s24, s23
    s_cmp_ge_u32 s16, 4
    s_cbranch_scc1 L_qkv_noct
    s_getpc_b64 s[46:47]
L_pc_1:
    s_sub_u32 s46, s46, L_pc_1-L_k1_start
    s_subb_u32 s47, s47, 0
    s_lshr_b32 s23, s31, 3
    s_lshl_b32 s23, s23, 2
    s_add_u32 s23, s23, s16
    s_lshl_b32 s23, s23, 7
    v_mul_u32_u24 v9, 15360, v0
    v_add_u32 v9, s23, v9
    v_min_u32 v9, L_code_end-L_k1_start-4, v9
    s_mov_b64 exec, 31
    global_load_dword v15, v9, s[46:47]
    s_mov_b64 exec, -1
    s_branch L_qkv_compute
L_qkv_noct:
L_qkv_loader:
    s_lshl_b32 s22, s22, 2
    s_lshr_b32 s30, 0x30858530, s22
    s_and_b32 s30, s30, 15
    s_sub_u32 s16, s16, 4
    v_and_b32 v8, 15, v0
    v_lshrrev_b32 v9, 4, v0
    v_lshlrev_b32 v10, 2, v9
    v_xor_b32 v10, v10, v8
    v_mul_u32_u24 v4, 3840, v9
    v_lshl_add_u32 v4, v10, 4, v4
    v_xor_b32 v5, 32, v4
    v_and_b32 v8, 7, v0
    v_xor_b32 v8, v8, v9
    v_lshrrev_b32 v10, 3, v0
    v_mul_u32_u24 v10, 1280, v10
    v_lshl_add_u32 v6, v8, 4, v10
    v_xor_b32 v7, 64, v6
    s_lshl_b32 s21, s18, 8
    s_mul_i32 s22, s16, 61440
    s_add_u32 s21, s21, s22
    s_add_u32 s44, s21, 2457600
    s_mul_i32 s22, s30, 245760
    s_add_u32 s21, s21, s22
    s_lshl_b32 s19, s17, 2
    s_add_u32 s19, s19, s16
    s_mul_i32 s19, s19, 40960
    s_lshl_b32 s22, s30, 7
    s_add_u32 s19, s19, s22
    s_lshl_b32 s25, s16, 12
    s_waitcnt lgkmcnt(0)
    s_mov_b32 s8, s6
    s_and_b32 s9, s7, 0xffff
    s_mov_b32 s10, 0x258000
    s_mov_b32 s11, 0x20000
    s_and_b32 s5, s5, 0xffff
    s_mov_b32 s6, 0x280000
    s_mov_b32 s7, 0x20000
    s_add_u32 m0, s25, 0
    s_add_u32 s22, s21, 0
    buffer_load_dwordx4 v4, s[8:11], s22 offen lds
    s_add_u32 m0, s25, 16384
    s_add_u32 s22, s19, 0
    buffer_load_dwordx4 v6, s[4:7], s22 offen lds
    s_add_u32 m0, s25, 1024
    s_add_u32 s22, s21, 15360
    buffer_load_dwordx4 v4, s[8:11], s22 offen lds
    s_add_u32 m0, s25, 17408
    s_add_u32 s22, s19, 10240
    buffer_load_dwordx4 v7, s[4:7], s22 offen lds
    s_add_u32 m0, s25, 2048
    s_add_u32 s22, s21, 30720
    buffer_load_dwordx4 v5, s[8:11], s22 offen lds
    s_add_u32 m0, s25, 18432
    s_add_u32 s22, s19, 20480
    buffer_load_dwordx4 v6, s[4:7], s22 offen lds
    s_add_u32 m0, s25, 3072
    s_add_u32 s22, s21, 46080
    buffer_load_dwordx4 v5, s[8:11], s22 offen lds
    s_add_u32 m0, s25, 19456
    s_add_u32 s22, s19, 30720
    buffer_load_dwordx4 v7, s[4:7], s22 offen lds
    s_add_u32 s21, s21, 245760
    s_add_u32 s19, s19, 128
    s_cmp_eq_u32 s21, s44
    s_cselect_b32 s22, 2457600, 0
    s_cselect_b32 s23, 1280, 0
    s_sub_u32 s21, s21, s22
    s_sub_u32 s19, s19, s23
    s_add_u32 m0, s25, 32768
    s_add_u32 s22, s21, 0
    buffer_load_dwordx4 v4, s[8:11], s22 offen lds
    s_add_u32 m0, s25, 49152
    s_add_u32 s22, s19, 0
    buffer_load_dwordx4 v6, s[4:7], s22 offen lds
    s_add_u32 m0, s25, 33792
    s_add_u32 s22, s21, 15360
    buffer_load_dwordx4 v4, s[8:11], s22 offen lds
    s_add_u32 m0, s25, 50176
    s_add_u32 s22, s19, 10240
    buffer_load_dwordx4 v7, s[4:7], s22 offen lds
    s_add_u32 m0, s25, 34816
    s_add_u32 s22, s21, 30720
    buffer_load_dwordx4 v5, s[8:11], s22 offen lds
    s_add_u32 m0, s25, 51200
    s_add_u32 s22, s19, 20480
    buffer_load_dwordx4 v6, s[4:7], s22 offen lds
    s_add_u32 m0, s25, 35840
    s_add_u32 s22, s21, 46080
    buffer_load_dwordx4 v5, s[8:11], s22 offen lds
    s_add_u32 m0, s25, 52224
    s_add_u32 s22, s19, 30720
    buffer_load_dwordx4 v7, s[4:7], s22 offen lds
    s_add_u32 s21, s21, 245760
    s_add_u32 s19, s19, 128
    s_cmp_eq_u32 s21, s44
    s_cselect_b32 s22, 2457600, 0
    s_cselect_b32 s23, 1280, 0
    s_sub_u32 s21, s21, s22
    s_sub_u32 s19, s19, s23
    s_mov_b32 s12, s50
    s_and_b32 s13, s51, 0xffff
    s_mov_b32 s14, 0x2000000
    s_mov_b32 s15, 0x20000
    s_waitcnt vmcnt(8)
    s_barrier
    s_add_u32 m0, s25, 65536
    s_add_u32 s22, s21, 0
    buffer_load_dwordx4 v4, s[8:11], s22 offen lds
    s_add_u32 m0, s25, 81920
    s_add_u32 s22, s19, 0
    buffer_load_dwordx4 v6, s[4:7], s22 offen lds
    s_add_u32 m0, s25, 66560
    s_add_u32 s22, s21, 15360
    buffer_load_dwordx4 v4, s[8:11], s22 offen lds
    s_add_u32 m0, s25, 82944
    s_add_u32 s22, s19, 10240
    buffer_load_dwordx4 v7, s[4:7], s22 offen lds
    s_add_u32 m0, s25, 67584
    s_add_u32 s22, s21, 30720
    buffer_load_dwordx4 v5, s[8:11], s22 offen lds
    s_add_u32 m0, s25, 83968
    s_add_u32 s22, s19, 20480
    buffer_load_dwordx4 v6, s[4:7], s22 offen lds
    s_add_u32 m0, s25, 68608
    s_add_u32 s22, s21, 46080
    buffer_load_dwordx4 v5, s[8:11], s22 offen lds
    s_add_u32 m0, s25, 84992
    s_add_u32 s22, s19, 30720
    buffer_load_dwordx4 v7, s[4:7], s22 offen lds
    s_add_u32 s21, s21, 245760
    s_add_u32 s19, s19, 128
    s_cmp_eq_u32 s21, s44
    s_cselect_b32 s22, 2457600, 0
    s_cselect_b32 s23, 1280, 0
    s_sub_u32 s21, s21, s22
    s_sub_u32 s19, s19, s23
    s_waitcnt vmcnt(8)
    s_barrier
    s_add_u32 m0, s25, 98304
    s_add_u32 s22, s21, 0
    buffer_load_dwordx4 v4, s[8:11], s22 offen lds
    s_add_u32 m0, s25, 114688
    s_add_u32 s22, s19, 0
    buffer_load_dwordx4 v6, s[4:7], s22 offen lds
    s_add_u32 m0, s25, 99328
    s_add_u32 s22, s21, 15360
    buffer_load_dwordx4 v4, s[8:11], s22 offen lds
    s_add_u32 m0, s25, 115712
    s_add_u32 s22, s19, 10240
    buffer_load_dwordx4 v7, s[4:7], s22 offen lds
    s_add_u32 m0, s25, 100352
    s_add_u32 s22, s21, 30720
    buffer_load_dwordx4 v5, s[8:11], s22 offen lds
    s_add_u32 m0, s25, 116736
    s_add_u32 s22, s19, 20480
    buffer_load_dwordx4 v6, s[4:7], s22 offen lds
    s_add_u32 m0, s25, 101376
    s_add_u32 s22, s21, 46080
    buffer_load_dwordx4 v5, s[8:11], s22 offen lds
    s_add_u32 m0, s25, 117760
    s_add_u32 s22, s19, 30720
    buffer_load_dwordx4 v7, s[4:7], s22 offen lds
    s_add_u32 s21, s21, 245760
    s_add_u32 s19, s19, 128
    s_cmp_eq_u32 s21, s44
    s_cselect_b32 s22, 2457600, 0
    s_cselect_b32 s23, 1280, 0
    s_sub_u32 s21, s21, s22
    s_sub_u32 s19, s19, s23
    s_waitcnt vmcnt(8)
    s_barrier
    s_add_u32 m0, s25, 131072
    s_add_u32 s22, s21, 0
    buffer_load_dwordx4 v4, s[8:11], s22 offen lds
    s_add_u32 m0, s25, 147456
    s_add_u32 s22, s19, 0
    buffer_load_dwordx4 v6, s[4:7], s22 offen lds
    s_add_u32 m0, s25, 132096
    s_add_u32 s22, s21, 15360
    buffer_load_dwordx4 v4, s[8:11], s22 offen lds
    s_add_u32 m0, s25, 148480
    s_add_u32 s22, s19, 10240
    buffer_load_dwordx4 v7, s[4:7], s22 offen lds
    s_add_u32 m0, s25, 133120
    s_add_u32 s22, s21, 30720
    buffer_load_dwordx4 v5, s[8:11], s22 offen lds
    s_add_u32 m0, s25, 149504
    s_add_u32 s22, s19, 20480
    buffer_load_dwordx4 v6, s[4:7], s22 offen lds
    s_add_u32 m0, s25, 134144
    s_add_u32 s22, s21, 46080
    buffer_load_dwordx4 v5, s[8:11], s22 offen lds
    s_add_u32 m0, s25, 150528
    s_add_u32 s22, s19, 30720
    buffer_load_dwordx4 v7, s[4:7], s22 offen lds
    s_add_u32 s21, s21, 245760
    s_add_u32 s19, s19, 128
    s_cmp_eq_u32 s21, s44
    s_cselect_b32 s22, 2457600, 0
    s_cselect_b32 s23, 1280, 0
    s_sub_u32 s21, s21, s22
    s_sub_u32 s19, s19, s23
    s_waitcnt vmcnt(8)
    s_barrier
    s_add_u32 m0, s25, 0
    s_add_u32 s22, s21, 0
    buffer_load_dwordx4 v4, s[8:11], s22 offen lds
    s_add_u32 m0, s25, 16384
    s_add_u32 s22, s19, 0
    buffer_load_dwordx4 v6, s[4:7], s22 offen lds
    s_add_u32 m0, s25, 1024
    s_add_u32 s22, s21, 15360
    buffer_load_dwordx4 v4, s[8:11], s22 offen lds
    s_add_u32 m0, s25, 17408
    s_add_u32 s22, s19, 10240
    buffer_load_dwordx4 v7, s[4:7], s22 offen lds
    s_add_u32 m0, s25, 2048
    s_add_u32 s22, s21, 30720
    buffer_load_dwordx4 v5, s[8:11], s22 offen lds
    s_add_u32 m0, s25, 18432
    s_add_u32 s22, s19, 20480
    buffer_load_dwordx4 v6, s[4:7], s22 offen lds
    s_add_u32 m0, s25, 3072
    s_add_u32 s22, s21, 46080
    buffer_load_dwordx4 v5, s[8:11], s22 offen lds
    s_add_u32 m0, s25, 19456
    s_add_u32 s22, s19, 30720
    buffer_load_dwordx4 v7, s[4:7], s22 offen lds
    s_add_u32 s21, s21, 245760
    s_add_u32 s19, s19, 128
    s_cmp_eq_u32 s21, s44
    s_cselect_b32 s22, 2457600, 0
    s_cselect_b32 s23, 1280, 0
    s_sub_u32 s21, s21, s22
    s_sub_u32 s19, s19, s23
    s_waitcnt vmcnt(8)
    s_barrier
    s_add_u32 m0, s25, 32768
    s_add_u32 s22, s21, 0
    buffer_load_dwordx4 v4, s[8:11], s22 offen lds
    s_add_u32 m0, s25, 49152
    s_add_u32 s22, s19, 0
    buffer_load_dwordx4 v6, s[4:7], s22 offen lds
    s_add_u32 m0, s25, 33792
    s_add_u32 s22, s21, 15360
    buffer_load_dwordx4 v4, s[8:11], s22 offen lds
    s_add_u32 m0, s25, 50176
    s_add_u32 s22, s19, 10240
    buffer_load_dwordx4 v7, s[4:7], s22 offen lds
    s_add_u32 m0, s25, 34816
    s_add_u32 s22, s21, 30720
    buffer_load_dwordx4 v5, s[8:11], s22 offen lds
    s_add_u32 m0, s25, 51200
    s_add_u32 s22, s19, 20480
    buffer_load_dwordx4 v6, s[4:7], s22 offen lds
    s_add_u32 m0, s25, 35840
    s_add_u32 s22, s21, 46080
    buffer_load_dwordx4 v5, s[8:11], s22 offen lds
    s_add_u32 m0, s25, 52224
    s_add_u32 s22, s19, 30720
    buffer_load_dwordx4 v7, s[4:7], s22 offen lds
    s_add_u32 s21, s21, 245760
    s_add_u32 s19, s19, 128
    s_cmp_eq_u32 s21, s44
    s_cselect_b32 s22, 2457600, 0
    s_cselect_b32 s23, 1280, 0
    s_sub_u32 s21, s21, s22
    s_sub_u32 s19, s19, s23
    s_waitcnt vmcnt(8)
    s_barrier
    s_add_u32 m0, s25, 65536
    s_add_u32 s22, s21, 0
    buffer_load_dwordx4 v4, s[8:11], s22 offen lds
    s_add_u32 m0, s25, 81920
    s_add_u32 s22, s19, 0
    buffer_load_dwordx4 v6, s[4:7], s22 offen lds
    s_add_u32 m0, s25, 66560
    s_add_u32 s22, s21, 15360
    buffer_load_dwordx4 v4, s[8:11], s22 offen lds
    s_add_u32 m0, s25, 82944
    s_add_u32 s22, s19, 10240
    buffer_load_dwordx4 v7, s[4:7], s22 offen lds
    s_add_u32 m0, s25, 67584
    s_add_u32 s22, s21, 30720
    buffer_load_dwordx4 v5, s[8:11], s22 offen lds
    s_add_u32 m0, s25, 83968
    s_add_u32 s22, s19, 20480
    buffer_load_dwordx4 v6, s[4:7], s22 offen lds
    s_add_u32 m0, s25, 68608
    s_add_u32 s22, s21, 46080
    buffer_load_dwordx4 v5, s[8:11], s22 offen lds
    s_add_u32 m0, s25, 84992
    s_add_u32 s22, s19, 30720
    buffer_load_dwordx4 v7, s[4:7], s22 offen lds
    s_add_u32 s21, s21, 245760
    s_add_u32 s19, s19, 128
    s_cmp_eq_u32 s21, s44
    s_cselect_b32 s22, 2457600, 0
    s_cselect_b32 s23, 1280, 0
    s_sub_u32 s21, s21, s22
    s_sub_u32 s19, s19, s23
    s_waitcnt vmcnt(8)
    s_barrier
    s_add_u32 m0, s25, 98304
    s_add_u32 s22, s21, 0
    buffer_load_dwordx4 v4, s[8:11], s22 offen lds
    s_add_u32 m0, s25, 114688
    s_add_u32 s22, s19, 0
    buffer_load_dwordx4 v6, s[4:7], s22 offen lds
    s_add_u32 m0, s25, 99328
    s_add_u32 s22, s21, 15360
    buffer_load_dwordx4 v4, s[8:11], s22 offen lds
    s_add_u32 m0, s25, 115712
    s_add_u32 s22, s19, 10240
    buffer_load_dwordx4 v7, s[4:7], s22 offen lds
    s_add_u32 m0, s25, 100352
    s_add_u32 s22, s21, 30720
    buffer_load_dwordx4 v5, s[8:11], s22 offen lds
    s_add_u32 m0, s25, 116736
    s_add_u32 s22, s19, 20480
    buffer_load_dwordx4 v6, s[4:7], s22 offen lds
    s_add_u32 m0, s25, 101376
    s_add_u32 s22, s21, 46080
    buffer_load_dwordx4 v5, s[8:11], s22 offen lds
    s_add_u32 m0, s25, 117760
    s_add_u32 s22, s19, 30720
    buffer_load_dwordx4 v7, s[4:7], s22 offen lds
    s_add_u32 s21, s21, 245760
    s_add_u32 s19, s19, 128
    s_cmp_eq_u32 s21, s44
    s_cselect_b32 s22, 2457600, 0
    s_cselect_b32 s23, 1280, 0
    s_sub_u32 s21, s21, s22
    s_sub_u32 s19, s19, s23
    s_waitcnt vmcnt(8)
    s_barrier
    s_add_u32 m0, s25, 131072
    s_add_u32 s22, s21, 0
    buffer_load_dwordx4 v4, s[8:11], s22 offen lds
    s_add_u32 m0, s25, 147456
    s_add_u32 s22, s19, 0
    buffer_load_dwordx4 v6, s[4:7], s22 offen lds
    s_add_u32 m0, s25, 132096
    s_add_u32 s22, s21, 15360
    buffer_load_dwordx4 v4, s[8:11], s22 offen lds
    s_add_u32 m0, s25, 148480
    s_add_u32 s22, s19, 10240
    buffer_load_dwordx4 v7, s[4:7], s22 offen lds
    s_add_u32 m0, s25, 133120
    s_add_u32 s22, s21, 30720
    buffer_load_dwordx4 v5, s[8:11], s22 offen lds
    s_add_u32 m0, s25, 149504
    s_add_u32 s22, s19, 20480
    buffer_load_dwordx4 v6, s[4:7], s22 offen lds
    s_add_u32 m0, s25, 134144
    s_add_u32 s22, s21, 46080
    buffer_load_dwordx4 v5, s[8:11], s22 offen lds
    s_add_u32 m0, s25, 150528
    s_add_u32 s22, s19, 30720
    buffer_load_dwordx4 v7, s[4:7], s22 offen lds
    s_add_u32 s21, s21, 245760
    s_add_u32 s19, s19, 128
    s_cmp_eq_u32 s21, s44
    s_cselect_b32 s22, 2457600, 0
    s_cselect_b32 s23, 1280, 0
    s_sub_u32 s21, s21, s22
    s_sub_u32 s19, s19, s23
    s_waitcnt vmcnt(8)
    s_barrier
    s_waitcnt vmcnt(0)
    s_barrier
    s_barrier
    s_waitcnt vmcnt(0)
    s_waitcnt lgkmcnt(0)
    s_mov_b32 s94, 0x2000000
    s_branch L_main
L_qkv_compute:
    s_and_b32 s22, s16, 1
    s_mov_b32 s44, s16
    s_xor_b32 s45, s16, 1
    s_lshl_b32 s26, s17, 1
    s_add_u32 s26, s26, s22
    s_lshl_b32 s26, s26, 1
    v_and_b32 v8, 15, v0
    v_lshrrev_b32 v9, 4, v0
    v_bfe_u32 v10, v0, 2, 2
    s_lshl_b32 s23, s22, 13
    s_add_u32 s23, s23, 16384
    v_bfe_u32 v11, v0, 1, 3
    v_xor_b32 v11, v11, v9
    v_lshlrev_b32 v12, 7, v8
    v_lshl_add_u32 v12, v11, 4, v12
    v_add_u32 v2, s23, v12
    v_xor_b32 v3, 64, v2
    v_lshl_add_u32 v11, v9, 3, v10
    v_lshlrev_b32 v11, 8, v11
    v_bfe_u32 v12, v0, 4, 1
    v_lshl_add_u32 v11, v12, 5, v11
    v_and_b32 v12, 3, v0
    v_lshl_add_u32 v11, v12, 3, v11
    v_xor_b32 v4, s44, v10
    v_lshl_add_u32 v4, v4, 6, v11
    v_xor_b32 v5, 32, v4
    v_xor_b32 v6, s45, v10
    v_lshl_add_u32 v6, v6, 6, v11
    v_xor_b32 v7, 32, v6
    v_mov_b32 v11, 0x3f803f80
    v_accvgpr_write_b32 a64, v11
    v_accvgpr_write_b32 a65, v11
    v_accvgpr_write_b32 a66, v11
    v_accvgpr_write_b32 a67, v11
    s_lshl_b32 s19, s17, 11
    s_add_u32 s19, s19, 0x15e0000
    s_lshl_b32 s22, s22, 6
    v_add_u32 v11, s22, v8
    v_lshlrev_b32 v84, 3, v11
    v_cmp_gt_u32 vcc, 16, v0
    v_mov_b32 v12, 0x7f000000
    s_nop 0
    v_cndmask_b32 v84, v12, v84, vcc
    v_lshlrev_b32 v85, 2, v11
    v_lshlrev_b32 v11, 2, v9
    v_add_u32 v11, s22, v11
    v_lshlrev_b32 v86, 2, v11
    v_lshlrev_b32 v87, 4, v8
    s_mov_b32 s20, 0
    s_waitcnt lgkmcnt(0)
    s_mov_b32 s12, s50
    s_and_b32 s13, s51, 0xffff
    s_mov_b32 s14, 0x2000000
    s_mov_b32 s15, 0x20000
    s_and_b32 s49, s49, 0xffff
    s_mov_b32 s50, 0x100
    s_mov_b32 s51, 0x20000
    s_cmp_ge_u32 s18, 10
    s_cbranch_scc1 L_qkv_V
    s_cmp_ge_u32 s18, 5
    s_cselect_b32 s23, 5, 0
    s_cselect_b32 s27, 0x0, 0x280000
    s_cselect_b32 s28, 1.0, 0x3ea52b5c
    s_sub_u32 s23, s18, s23
    s_lshl_b32 s23, s23, 4
    s_mul_i32 s24, s26, 2560
    s_add_u32 s27, s27, s24
    v_bfe_u32 v13, v0, 4, 1
    v_lshrrev_b32 v11, 5, v0
    v_lshl_add_u32 v13, v13, 1, v11
    v_add_u32 v13, s23, v13
    v_lshlrev_b32 v8, 4, v8
    s_mov_b32 s24, 161280
    s_lshl_b32 s22, s44, 2
    v_add_u32 v11, s22, v13
    v_mul_u32_u24 v12, 205, v11
    v_lshrrev_b32 v12, 10, v12
    v_mul_lo_u32 v12, s24, v12
    v_lshl_add_u32 v11, v11, 9, v8
    v_add_u32 v80, v11, v12
    s_lshl_b32 s22, s45, 2
    v_add_u32 v11, s22, v13
    v_mul_u32_u24 v12, 205, v11
    v_lshrrev_b32 v12, 10, v12
    v_mul_lo_u32 v12, s24, v12
    v_lshl_add_u32 v11, v11, 9, v8
    v_add_u32 v81, v11, v12
    s_barrier
    ds_read_b64_tr_b16 a[0:1], v4 offset:0
    ds_read_b64_tr_b16 a[2:3], v4 offset:1024
    ds_read_b128 a[16:19], v2 offset:0
    ds_read_b128 a[20:23], v2 offset:2048
    ds_read_b128 a[24:27], v2 offset:4096
    ds_read_b128 a[28:31], v2 offset:6144
    ds_read_b64_tr_b16 a[4:5], v5 offset:0
    ds_read_b64_tr_b16 a[6:7], v5 offset:1024
    ds_read_b64_tr_b16 a[8:9], v6 offset:0
    ds_read_b64_tr_b16 a[10:11], v6 offset:1024
    ds_read_b64_tr_b16 a[12:13], v7 offset:0
    ds_read_b64_tr_b16 a[14:15], v7 offset:1024
    s_waitcnt lgkmcnt(6)
    v_mfma_f32_16x16x32_bf16 v[16:19], a[0:3], a[16:19], 0
    ds_read_b64_tr_b16 a[32:33], v4 offset:8192
    v_mfma_f32_16x16x32_bf16 v[32:35], a[0:3], a[20:23], 0
    ds_read_b64_tr_b16 a[34:35], v4 offset:9216
    v_mfma_f32_16x16x32_bf16 v[48:51], a[0:3], a[24:27], 0
    ds_read_b128 a[48:51], v3 offset:0
    v_mfma_f32_16x16x32_bf16 v[64:67], a[0:3], a[28:31], 0
    ds_read_b128 a[52:55], v3 offset:2048
    s_waitcnt lgkmcnt(4)
    v_mfma_f32_16x16x32_bf16 v[20:23], a[4:7], a[16:19], 0
    ds_read_b128 a[56:59], v3 offset:4096
    v_mfma_f32_16x16x32_bf16 v[36:39], a[4:7], a[20:23], 0
    ds_read_b128 a[60:63], v3 offset:6144
    v_mfma_f32_16x16x32_bf16 v[52:55], a[4:7], a[24:27], 0
    ds_read_b64_tr_b16 a[36:37], v5 offset:8192
    v_mfma_f32_16x16x32_bf16 v[68:71], a[4:7], a[28:31], 0
    ds_read_b64_tr_b16 a[38:39], v5 offset:9216
    v_mfma_f32_16x16x32_bf16 v[24:27], a[8:11], a[16:19], 0
    ds_read_b64_tr_b16 a[40:41], v6 offset:8192
    v_mfma_f32_16x16x32_bf16 v[40:43], a[8:11], a[20:23], 0
    ds_read_b64_tr_b16 a[42:43], v6 offset:9216
    v_mfma_f32_16x16x32_bf16 v[56:59], a[8:11], a[24:27], 0
    ds_read_b64_tr_b16 a[44:45], v7 offset:8192
    v_mfma_f32_16x16x32_bf16 v[72:75], a[8:11], a[28:31], 0
    ds_read_b64_tr_b16 a[46:47], v7 offset:9216
    v_mfma_f32_16x16x32_bf16 a[68:71], a[64:67], a[0:3], 0
    v_mfma_f32_16x16x32_bf16 v[28:31], a[12:15], a[16:19], 0
    v_mfma_f32_16x16x32_bf16 v[44:47], a[12:15], a[20:23], 0
    v_mfma_f32_16x16x32_bf16 v[60:63], a[12:15], a[24:27], 0
    v_mfma_f32_16x16x32_bf16 v[76:79], a[12:15], a[28:31], 0
    v_mfma_f32_16x16x32_bf16 a[72:75], a[64:67], a[4:7], 0
    s_barrier
    s_waitcnt lgkmcnt(6)
    v_mfma_f32_16x16x32_bf16 v[16:19], a[32:35], a[48:51], v[16:19]
    ds_read_b64_tr_b16 a[0:1], v4 offset:32768
    v_mfma_f32_16x16x32_bf16 v[32:35], a[32:35], a[52:55], v[32:35]
    ds_read_b64_tr_b16 a[2:3], v4 offset:33792
    v_mfma_f32_16x16x32_bf16 v[48:51], a[32:35], a[56:59], v[48:51]
    ds_read_b128 a[16:19], v2 offset:32768
    v_mfma_f32_16x16x32_bf16 v[64:67], a[32:35], a[60:63], v[64:67]
    ds_read_b128 a[20:23], v2 offset:34816
    s_waitcnt lgkmcnt(4)
    v_mfma_f32_16x16x32_bf16 v[20:23], a[36:39], a[48:51], v[20:23]
    ds_read_b128 a[24:27], v2 offset:36864
    v_mfma_f32_16x16x32_bf16 v[36:39], a[36:39], a[52:55], v[36:39]
    ds_read_b128 a[28:31], v2 offset:38912
    v_mfma_f32_16x16x32_bf16 v[52:55], a[36:39], a[56:59], v[52:55]
    ds_read_b64_tr_b16 a[4:5], v5 offset:32768
    v_mfma_f32_16x16x32_bf16 v[68:71], a[36:39], a[60:63], v[68:71]
    ds_read_b64_tr_b16 a[6:7], v5 offset:33792
    v_mfma_f32_16x16x32_bf16 v[24:27], a[40:43], a[48:51], v[24:27]
    ds_read_b64_tr_b16 a[8:9], v6 offset:32768
    v_mfma_f32_16x16x32_bf16 v[40:43], a[40:43], a[52:55], v[40:43]
    ds_read_b64_tr_b16 a[10:11], v6 offset:33792
    v_mfma_f32_16x16x32_bf16 v[56:59], a[40:43], a[56:59], v[56:59]
    ds_read_b64_tr_b16 a[12:13], v7 offset:32768
    v_mfma_f32_16x16x32_bf16 v[72:75], a[40:43], a[60:63], v[72:75]
    ds_read_b64_tr_b16 a[14:15], v7 offset:33792
    v_mfma_f32_16x16x32_bf16 a[68:71], a[64:67], a[32:35], a[68:71]
    v_mfma_f32_16x16x32_bf16 v[28:31], a[44:47], a[48:51], v[28:31]
    v_mfma_f32_16x16x32_bf16 v[44:47], a[44:47], a[52:55], v[44:47]
    v_mfma_f32_16x16x32_bf16 v[60:63], a[44:47], a[56:59], v[60:63]
    v_mfma_f32_16x16x32_bf16 v[76:79], a[44:47], a[60:63], v[76:79]
    v_mfma_f32_16x16x32_bf16 a[72:75], a[64:67], a[36:39], a[72:75]
    s_waitcnt lgkmcnt(6)
    v_mfma_f32_16x16x32_bf16 v[16:19], a[0:3], a[16:19], v[16:19]
    ds_read_b64_tr_b16 a[32:33], v4 offset:40960
    v_mfma_f32_16x16x32_bf16 v[32:35], a[0:3], a[20:23], v[32:35]
    ds_read_b64_tr_b16 a[34:35], v4 offset:41984
    v_mfma_f32_16x16x32_bf16 v[48:51], a[0:3], a[24:27], v[48:51]
    ds_read_b128 a[48:51], v3 offset:32768
    v_mfma_f32_16x16x32_bf16 v[64:67], a[0:3], a[28:31], v[64:67]
    ds_read_b128 a[52:55], v3 offset:34816
    s_waitcnt lgkmcnt(4)
    v_mfma_f32_16x16x32_bf16 v[20:23], a[4:7], a[16:19], v[20:23]
    ds_read_b128 a[56:59], v3 offset:36864
    v_mfma_f32_16x16x32_bf16 v[36:39], a[4:7], a[20:23], v[36:39]
    ds_read_b128 a[60:63], v3 offset:38912
    v_mfma_f32_16x16x32_bf16 v[52:55], a[4:7], a[24:27], v[52:55]
    ds_read_b64_tr_b16 a[36:37], v5 offset:40960
    v_mfma_f32_16x16x32_bf16 v[68:71], a[4:7], a[28:31], v[68:71]
    ds_read_b64_tr_b16 a[38:39], v5 offset:41984
    v_mfma_f32_16x16x32_bf16 v[24:27], a[8:11], a[16:19], v[24:27]
    ds_read_b64_tr_b16 a[40:41], v6 offset:40960
    v_mfma_f32_16x16x32_bf16 v[40:43], a[8:11], a[20:23], v[40:43]
    ds_read_b64_tr_b16 a[42:43], v6 offset:41984
    v_mfma_f32_16x16x32_bf16 v[56:59], a[8:11], a[24:27], v[56:59]
    ds_read_b64_tr_b16 a[44:45], v7 offset:40960
    v_mfma_f32_16x16x32_bf16 v[72:75], a[8:11], a[28:31], v[72:75]
    ds_read_b64_tr_b16 a[46:47], v7 offset:41984
    v_mfma_f32_16x16x32_bf16 a[68:71], a[64:67], a[0:3], a[68:71]
    v_mfma_f32_16x16x32_bf16 v[28:31], a[12:15], a[16:19], v[28:31]
    v_mfma_f32_16x16x32_bf16 v[44:47], a[12:15], a[20:23], v[44:47]
    v_mfma_f32_16x16x32_bf16 v[60:63], a[12:15], a[24:27], v[60:63]
    v_mfma_f32_16x16x32_bf16 v[76:79], a[12:15], a[28:31], v[76:79]
    v_mfma_f32_16x16x32_bf16 a[72:75], a[64:67], a[4:7], a[72:75]
    s_barrier
    v_add_u32 v4, 65536, v4
    v_add_u32 v5, 65536, v5
    v_add_u32 v6, 65536, v6
    v_add_u32 v7, 65536, v7
    v_add_u32 v2, 65536, v2
    v_add_u32 v3, 65536, v3
    s_waitcnt lgkmcnt(6)
    v_mfma_f32_16x16x32_bf16 v[16:19], a[32:35], a[48:51], v[16:19]
    ds_read_b64_tr_b16 a[0:1], v4 offset:0
    v_mfma_f32_16x16x32_bf16 v[32:35], a[32:35], a[52:55], v[32:35]
    ds_read_b64_tr_b16 a[2:3], v4 offset:1024
    v_mfma_f32_16x16x32_bf16 v[48:51], a[32:35], a[56:59], v[48:51]
    ds_read_b128 a[16:19], v2 offset:0
    v_mfma_f32_16x16x32_bf16 v[64:67], a[32:35], a[60:63], v[64:67]
    ds_read_b128 a[20:23], v2 offset:2048
    s_waitcnt lgkmcnt(4)
    v_mfma_f32_16x16x32_bf16 v[20:23], a[36:39], a[48:51], v[20:23]
    ds_read_b128 a[24:27], v2 offset:4096
    v_mfma_f32_16x16x32_bf16 v[36:39], a[36:39], a[52:55], v[36:39]
    ds_read_b128 a[28:31], v2 offset:6144
    v_mfma_f32_16x16x32_bf16 v[52:55], a[36:39], a[56:59], v[52:55]
    ds_read_b64_tr_b16 a[4:5], v5 offset:0
    v_mfma_f32_16x16x32_bf16 v[68:71], a[36:39], a[60:63], v[68:71]
    ds_read_b64_tr_b16 a[6:7], v5 offset:1024
    v_mfma_f32_16x16x32_bf16 v[24:27], a[40:43], a[48:51], v[24:27]
    ds_read_b64_tr_b16 a[8:9], v6 offset:0
    v_mfma_f32_16x16x32_bf16 v[40:43], a[40:43], a[52:55], v[40:43]
    ds_read_b64_tr_b16 a[10:11], v6 offset:1024
    v_mfma_f32_16x16x32_bf16 v[56:59], a[40:43], a[56:59], v[56:59]
    ds_read_b64_tr_b16 a[12:13], v7 offset:0
    v_mfma_f32_16x16x32_bf16 v[72:75], a[40:43], a[60:63], v[72:75]
    ds_read_b64_tr_b16 a[14:15], v7 offset:1024
    v_mfma_f32_16x16x32_bf16 a[68:71], a[64:67], a[32:35], a[68:71]
    v_mfma_f32_16x16x32_bf16 v[28:31], a[44:47], a[48:51], v[28:31]
    v_mfma_f32_16x16x32_bf16 v[44:47], a[44:47], a[52:55], v[44:47]
    v_mfma_f32_16x16x32_bf16 v[60:63], a[44:47], a[56:59], v[60:63]
    v_mfma_f32_16x16x32_bf16 v[76:79], a[44:47], a[60:63], v[76:79]
    v_mfma_f32_16x16x32_bf16 a[72:75], a[64:67], a[36:39], a[72:75]
    s_waitcnt lgkmcnt(6)
    v_mfma_f32_16x16x32_bf16 v[16:19], a[0:3], a[16:19], v[16:19]
    ds_read_b64_tr_b16 a[32:33], v4 offset:8192
    v_mfma_f32_16x16x32_bf16 v[32:35], a[0:3], a[20:23], v[32:35]
    ds_read_b64_tr_b16 a[34:35], v4 offset:9216
    v_mfma_f32_16x16x32_bf16 v[48:51], a[0:3], a[24:27], v[48:51]
    ds_read_b128 a[48:51], v3 offset:0
    v_mfma_f32_16x16x32_bf16 v[64:67], a[0:3], a[28:31], v[64:67]
    ds_read_b128 a[52:55], v3 offset:2048
    s_waitcnt lgkmcnt(4)
    v_mfma_f32_16x16x32_bf16 v[20:23], a[4:7], a[16:19], v[20:23]
    ds_read_b128 a[56:59], v3 offset:4096
    v_mfma_f32_16x16x32_bf16 v[36:39], a[4:7], a[20:23], v[36:39]
    ds_read_b128 a[60:63], v3 offset:6144
    v_mfma_f32_16x16x32_bf16 v[52:55], a[4:7], a[24:27], v[52:55]
    ds_read_b64_tr_b16 a[36:37], v5 offset:8192
    v_mfma_f32_16x16x32_bf16 v[68:71], a[4:7], a[28:31], v[68:71]
    ds_read_b64_tr_b16 a[38:39], v5 offset:9216
    v_mfma_f32_16x16x32_bf16 v[24:27], a[8:11], a[16:19], v[24:27]
    ds_read_b64_tr_b16 a[40:41], v6 offset:8192
    v_mfma_f32_16x16x32_bf16 v[40:43], a[8:11], a[20:23], v[40:43]
    ds_read_b64_tr_b16 a[42:43], v6 offset:9216
    v_mfma_f32_16x16x32_bf16 v[56:59], a[8:11], a[24:27], v[56:59]
    ds_read_b64_tr_b16 a[44:45], v7 offset:8192
    v_mfma_f32_16x16x32_bf16 v[72:75], a[8:11], a[28:31], v[72:75]
    ds_read_b64_tr_b16 a[46:47], v7 offset:9216
    v_mfma_f32_16x16x32_bf16 a[68:71], a[64:67], a[0:3], a[68:71]
    v_mfma_f32_16x16x32_bf16 v[28:31], a[12:15], a[16:19], v[28:31]
    v_mfma_f32_16x16x32_bf16 v[44:47], a[12:15], a[20:23], v[44:47]
    v_mfma_f32_16x16x32_bf16 v[60:63], a[12:15], a[24:27], v[60:63]
    v_mfma_f32_16x16x32_bf16 v[76:79], a[12:15], a[28:31], v[76:79]
    v_mfma_f32_16x16x32_bf16 a[72:75], a[64:67], a[4:7], a[72:75]
    s_barrier
    s_waitcnt lgkmcnt(6)
    v_mfma_f32_16x16x32_bf16 v[16:19], a[32:35], a[48:51], v[16:19]
    ds_read_b64_tr_b16 a[0:1], v4 offset:32768
    v_mfma_f32_16x16x32_bf16 v[32:35], a[32:35], a[52:55], v[32:35]
    ds_read_b64_tr_b16 a[2:3], v4 offset:33792
    v_mfma_f32_16x16x32_bf16 v[48:51], a[32:35], a[56:59], v[48:51]
    ds_read_b128 a[16:19], v2 offset:32768
    v_mfma_f32_16x16x32_bf16 v[64:67], a[32:35], a[60:63], v[64:67]
    ds_read_b128 a[20:23], v2 offset:34816
    s_waitcnt lgkmcnt(4)
    v_mfma_f32_16x16x32_bf16 v[20:23], a[36:39], a[48:51], v[20:23]
    ds_read_b128 a[24:27], v2 offset:36864
    v_mfma_f32_16x16x32_bf16 v[36:39], a[36:39], a[52:55], v[36:39]
    ds_read_b128 a[28:31], v2 offset:38912
    v_mfma_f32_16x16x32_bf16 v[52:55], a[36:39], a[56:59], v[52:55]
    ds_read_b64_tr_b16 a[4:5], v5 offset:32768
    v_mfma_f32_16x16x32_bf16 v[68:71], a[36:39], a[60:63], v[68:71]
    ds_read_b64_tr_b16 a[6:7], v5 offset:33792
    v_mfma_f32_16x16x32_bf16 v[24:27], a[40:43], a[48:51], v[24:27]
    ds_read_b64_tr_b16 a[8:9], v6 offset:32768
    v_mfma_f32_16x16x32_bf16 v[40:43], a[40:43], a[52:55], v[40:43]
    ds_read_b64_tr_b16 a[10:11], v6 offset:33792
    v_mfma_f32_16x16x32_bf16 v[56:59], a[40:43], a[56:59], v[56:59]
    ds_read_b64_tr_b16 a[12:13], v7 offset:32768
    v_mfma_f32_16x16x32_bf16 v[72:75], a[40:43], a[60:63], v[72:75]
    ds_read_b64_tr_b16 a[14:15], v7 offset:33792
    v_mfma_f32_16x16x32_bf16 a[68:71], a[64:67], a[32:35], a[68:71]
    v_mfma_f32_16x16x32_bf16 v[28:31], a[44:47], a[48:51], v[28:31]
    v_mfma_f32_16x16x32_bf16 v[44:47], a[44:47], a[52:55], v[44:47]
    v_mfma_f32_16x16x32_bf16 v[60:63], a[44:47], a[56:59], v[60:63]
    v_mfma_f32_16x16x32_bf16 v[76:79], a[44:47], a[60:63], v[76:79]
    v_mfma_f32_16x16x32_bf16 a[72:75], a[64:67], a[36:39], a[72:75]
    s_waitcnt lgkmcnt(6)
    v_mfma_f32_16x16x32_bf16 v[16:19], a[0:3], a[16:19], v[16:19]
    ds_read_b64_tr_b16 a[32:33], v4 offset:40960
    v_mfma_f32_16x16x32_bf16 v[32:35], a[0:3], a[20:23], v[32:35]
    ds_read_b64_tr_b16 a[34:35], v4 offset:41984
    v_mfma_f32_16x16x32_bf16 v[48:51], a[0:3], a[24:27], v[48:51]
    ds_read_b128 a[48:51], v3 offset:32768
    v_mfma_f32_16x16x32_bf16 v[64:67], a[0:3], a[28:31], v[64:67]
    ds_read_b128 a[52:55], v3 offset:34816
    s_waitcnt lgkmcnt(4)
    v_mfma_f32_16x16x32_bf16 v[20:23], a[4:7], a[16:19], v[20:23]
    ds_read_b128 a[56:59], v3 offset:36864
    v_mfma_f32_16x16x32_bf16 v[36:39], a[4:7], a[20:23], v[36:39]
    ds_read_b128 a[60:63], v3 offset:38912
    v_mfma_f32_16x16x32_bf16 v[52:55], a[4:7], a[24:27], v[52:55]
    ds_read_b64_tr_b16 a[36:37], v5 offset:40960
    v_mfma_f32_16x16x32_bf16 v[68:71], a[4:7], a[28:31], v[68:71]
    ds_read_b64_tr_b16 a[38:39], v5 offset:41984
    v_mfma_f32_16x16x32_bf16 v[24:27], a[8:11], a[16:19], v[24:27]
    ds_read_b64_tr_b16 a[40:41], v6 offset:40960
    v_mfma_f32_16x16x32_bf16 v[40:43], a[8:11], a[20:23], v[40:43]
    ds_read_b64_tr_b16 a[42:43], v6 offset:41984
    v_mfma_f32_16x16x32_bf16 v[56:59], a[8:11], a[24:27], v[56:59]
    ds_read_b64_tr_b16 a[44:45], v7 offset:40960
    v_mfma_f32_16x16x32_bf16 v[72:75], a[8:11], a[28:31], v[72:75]
    ds_read_b64_tr_b16 a[46:47], v7 offset:41984
    v_mfma_f32_16x16x32_bf16 a[68:71], a[64:67], a[0:3], a[68:71]
    v_mfma_f32_16x16x32_bf16 v[28:31], a[12:15], a[16:19], v[28:31]
    v_mfma_f32_16x16x32_bf16 v[44:47], a[12:15], a[20:23], v[44:47]
    v_mfma_f32_16x16x32_bf16 v[60:63], a[12:15], a[24:27], v[60:63]
    v_mfma_f32_16x16x32_bf16 v[76:79], a[12:15], a[28:31], v[76:79]
    v_mfma_f32_16x16x32_bf16 a[72:75], a[64:67], a[4:7], a[72:75]
    s_barrier
    v_add_u32 v4, 65536, v4
    v_add_u32 v5, 65536, v5
    v_add_u32 v6, 65536, v6
    v_add_u32 v7, 65536, v7
    v_add_u32 v2, 65536, v2
    v_add_u32 v3, 65536, v3
    s_waitcnt lgkmcnt(6)
    v_mfma_f32_16x16x32_bf16 v[16:19], a[32:35], a[48:51], v[16:19]
    ds_read_b64_tr_b16 a[0:1], v4 offset:0
    v_mfma_f32_16x16x32_bf16 v[32:35], a[32:35], a[52:55], v[32:35]
    ds_read_b64_tr_b16 a[2:3], v4 offset:1024
    v_mfma_f32_16x16x32_bf16 v[48:51], a[32:35], a[56:59], v[48:51]
    ds_read_b128 a[16:19], v2 offset:0
    v_mfma_f32_16x16x32_bf16 v[64:67], a[32:35], a[60:63], v[64:67]
    ds_read_b128 a[20:23], v2 offset:2048
    s_waitcnt lgkmcnt(4)
    v_mfma_f32_16x16x32_bf16 v[20:23], a[36:39], a[48:51], v[20:23]
    ds_read_b128 a[24:27], v2 offset:4096
    v_mfma_f32_16x16x32_bf16 v[36:39], a[36:39], a[52:55], v[36:39]
    ds_read_b128 a[28:31], v2 offset:6144
    v_mfma_f32_16x16x32_bf16 v[52:55], a[36:39], a[56:59], v[52:55]
    ds_read_b64_tr_b16 a[4:5], v5 offset:0
    v_mfma_f32_16x16x32_bf16 v[68:71], a[36:39], a[60:63], v[68:71]
    ds_read_b64_tr_b16 a[6:7], v5 offset:1024
    v_mfma_f32_16x16x32_bf16 v[24:27], a[40:43], a[48:51], v[24:27]
    ds_read_b64_tr_b16 a[8:9], v6 offset:0
    v_mfma_f32_16x16x32_bf16 v[40:43], a[40:43], a[52:55], v[40:43]
    ds_read_b64_tr_b16 a[10:11], v6 offset:1024
    v_mfma_f32_16x16x32_bf16 v[56:59], a[40:43], a[56:59], v[56:59]
    ds_read_b64_tr_b16 a[12:13], v7 offset:0
    v_mfma_f32_16x16x32_bf16 v[72:75], a[40:43], a[60:63], v[72:75]
    ds_read_b64_tr_b16 a[14:15], v7 offset:1024
    v_mfma_f32_16x16x32_bf16 a[68:71], a[64:67], a[32:35], a[68:71]
    v_mfma_f32_16x16x32_bf16 v[28:31], a[44:47], a[48:51], v[28:31]
    v_mfma_f32_16x16x32_bf16 v[44:47], a[44:47], a[52:55], v[44:47]
    v_mfma_f32_16x16x32_bf16 v[60:63], a[44:47], a[56:59], v[60:63]
    v_mfma_f32_16x16x32_bf16 v[76:79], a[44:47], a[60:63], v[76:79]
    v_mfma_f32_16x16x32_bf16 a[72:75], a[64:67], a[36:39], a[72:75]
    s_waitcnt lgkmcnt(6)
    v_mfma_f32_16x16x32_bf16 v[16:19], a[0:3], a[16:19], v[16:19]
    ds_read_b64_tr_b16 a[32:33], v4 offset:8192
    v_mfma_f32_16x16x32_bf16 v[32:35], a[0:3], a[20:23], v[32:35]
    ds_read_b64_tr_b16 a[34:35], v4 offset:9216
    v_mfma_f32_16x16x32_bf16 v[48:51], a[0:3], a[24:27], v[48:51]
    ds_read_b128 a[48:51], v3 offset:0
    v_mfma_f32_16x16x32_bf16 v[64:67], a[0:3], a[28:31], v[64:67]
    ds_read_b128 a[52:55], v3 offset:2048
    s_waitcnt lgkmcnt(4)
    v_mfma_f32_16x16x32_bf16 v[20:23], a[4:7], a[16:19], v[20:23]
    ds_read_b128 a[56:59], v3 offset:4096
    v_mfma_f32_16x16x32_bf16 v[36:39], a[4:7], a[20:23], v[36:39]
    ds_read_b128 a[60:63], v3 offset:6144
    v_mfma_f32_16x16x32_bf16 v[52:55], a[4:7], a[24:27], v[52:55]
    ds_read_b64_tr_b16 a[36:37], v5 offset:8192
    v_mfma_f32_16x16x32_bf16 v[68:71], a[4:7], a[28:31], v[68:71]
    ds_read_b64_tr_b16 a[38:39], v5 offset:9216
    v_mfma_f32_16x16x32_bf16 v[24:27], a[8:11], a[16:19], v[24:27]
    ds_read_b64_tr_b16 a[40:41], v6 offset:8192
    v_mfma_f32_16x16x32_bf16 v[40:43], a[8:11], a[20:23], v[40:43]
    ds_read_b64_tr_b16 a[42:43], v6 offset:9216
    v_mfma_f32_16x16x32_bf16 v[56:59], a[8:11], a[24:27], v[56:59]
    ds_read_b64_tr_b16 a[44:45], v7 offset:8192
    v_mfma_f32_16x16x32_bf16 v[72:75], a[8:11], a[28:31], v[72:75]
    ds_read_b64_tr_b16 a[46:47], v7 offset:9216
    v_mfma_f32_16x16x32_bf16 a[68:71], a[64:67], a[0:3], a[68:71]
    v_mfma_f32_16x16x32_bf16 v[28:31], a[12:15], a[16:19], v[28:31]
    v_mfma_f32_16x16x32_bf16 v[44:47], a[12:15], a[20:23], v[44:47]
    v_mfma_f32_16x16x32_bf16 v[60:63], a[12:15], a[24:27], v[60:63]
    v_mfma_f32_16x16x32_bf16 v[76:79], a[12:15], a[28:31], v[76:79]
    v_mfma_f32_16x16x32_bf16 a[72:75], a[64:67], a[4:7], a[72:75]
    s_barrier
    v_add_u32 v4, 4294836224, v4
    v_add_u32 v5, 4294836224, v5
    v_add_u32 v6, 4294836224, v6
    v_add_u32 v7, 4294836224, v7
    v_add_u32 v2, 4294836224, v2
    v_add_u32 v3, 4294836224, v3
    s_waitcnt lgkmcnt(6)
    v_mfma_f32_16x16x32_bf16 v[16:19], a[32:35], a[48:51], v[16:19]
    ds_read_b64_tr_b16 a[0:1], v4 offset:0
    v_mfma_f32_16x16x32_bf16 v[32:35], a[32:35], a[52:55], v[32:35]
    ds_read_b64_tr_b16 a[2:3], v4 offset:1024
    v_mfma_f32_16x16x32_bf16 v[48:51], a[32:35], a[56:59], v[48:51]
    ds_read_b128 a[16:19], v2 offset:0
    v_mfma_f32_16x16x32_bf16 v[64:67], a[32:35], a[60:63], v[64:67]
    ds_read_b128 a[20:23], v2 offset:2048
    s_waitcnt lgkmcnt(4)
    v_mfma_f32_16x16x32_bf16 v[20:23], a[36:39], a[48:51], v[20:23]
    ds_read_b128 a[24:27], v2 offset:4096
    v_mfma_f32_16x16x32_bf16 v[36:39], a[36:39], a[52:55], v[36:39]
    ds_read_b128 a[28:31], v2 offset:6144
    v_mfma_f32_16x16x32_bf16 v[52:55], a[36:39], a[56:59], v[52:55]
    ds_read_b64_tr_b16 a[4:5], v5 offset:0
    v_mfma_f32_16x16x32_bf16 v[68:71], a[36:39], a[60:63], v[68:71]
    ds_read_b64_tr_b16 a[6:7], v5 offset:1024
    v_mfma_f32_16x16x32_bf16 v[24:27], a[40:43], a[48:51], v[24:27]
    ds_read_b64_tr_b16 a[8:9], v6 offset:0
    v_mfma_f32_16x16x32_bf16 v[40:43], a[40:43], a[52:55], v[40:43]
    ds_read_b64_tr_b16 a[10:11], v6 offset:1024
    v_mfma_f32_16x16x32_bf16 v[56:59], a[40:43], a[56:59], v[56:59]
    ds_read_b64_tr_b16 a[12:13], v7 offset:0
    v_mfma_f32_16x16x32_bf16 v[72:75], a[40:43], a[60:63], v[72:75]
    ds_read_b64_tr_b16 a[14:15], v7 offset:1024
    v_mfma_f32_16x16x32_bf16 a[68:71], a[64:67], a[32:35], a[68:71]
    v_mfma_f32_16x16x32_bf16 v[28:31], a[44:47], a[48:51], v[28:31]
    v_mfma_f32_16x16x32_bf16 v[44:47], a[44:47], a[52:55], v[44:47]
    v_mfma_f32_16x16x32_bf16 v[60:63], a[44:47], a[56:59], v[60:63]
    v_mfma_f32_16x16x32_bf16 v[76:79], a[44:47], a[60:63], v[76:79]
    v_mfma_f32_16x16x32_bf16 a[72:75], a[64:67], a[36:39], a[72:75]
    s_waitcnt lgkmcnt(6)
    v_mfma_f32_16x16x32_bf16 v[16:19], a[0:3], a[16:19], v[16:19]
    ds_read_b64_tr_b16 a[32:33], v4 offset:8192
    v_mfma_f32_16x16x32_bf16 v[32:35], a[0:3], a[20:23], v[32:35]
    ds_read_b64_tr_b16 a[34:35], v4 offset:9216
    v_mfma_f32_16x16x32_bf16 v[48:51], a[0:3], a[24:27], v[48:51]
    ds_read_b128 a[48:51], v3 offset:0
    v_mfma_f32_16x16x32_bf16 v[64:67], a[0:3], a[28:31], v[64:67]
    ds_read_b128 a[52:55], v3 offset:2048
    s_waitcnt lgkmcnt(4)
    v_mfma_f32_16x16x32_bf16 v[20:23], a[4:7], a[16:19], v[20:23]
    ds_read_b128 a[56:59], v3 offset:4096
    v_mfma_f32_16x16x32_bf16 v[36:39], a[4:7], a[20:23], v[36:39]
    ds_read_b128 a[60:63], v3 offset:6144
    v_mfma_f32_16x16x32_bf16 v[52:55], a[4:7], a[24:27], v[52:55]
    ds_read_b64_tr_b16 a[36:37], v5 offset:8192
    v_mfma_f32_16x16x32_bf16 v[68:71], a[4:7], a[28:31], v[68:71]
    ds_read_b64_tr_b16 a[38:39], v5 offset:9216
    v_mfma_f32_16x16x32_bf16 v[24:27], a[8:11], a[16:19], v[24:27]
    ds_read_b64_tr_b16 a[40:41], v6 offset:8192
    v_mfma_f32_16x16x32_bf16 v[40:43], a[8:11], a[20:23], v[40:43]
    ds_read_b64_tr_b16 a[42:43], v6 offset:9216
    v_mfma_f32_16x16x32_bf16 v[56:59], a[8:11], a[24:27], v[56:59]
    ds_read_b64_tr_b16 a[44:45], v7 offset:8192
    v_mfma_f32_16x16x32_bf16 v[72:75], a[8:11], a[28:31], v[72:75]
    ds_read_b64_tr_b16 a[46:47], v7 offset:9216
    v_mfma_f32_16x16x32_bf16 a[68:71], a[64:67], a[0:3], a[68:71]
    v_mfma_f32_16x16x32_bf16 v[28:31], a[12:15], a[16:19], v[28:31]
    v_mfma_f32_16x16x32_bf16 v[44:47], a[12:15], a[20:23], v[44:47]
    v_mfma_f32_16x16x32_bf16 v[60:63], a[12:15], a[24:27], v[60:63]
    v_mfma_f32_16x16x32_bf16 v[76:79], a[12:15], a[28:31], v[76:79]
    v_mfma_f32_16x16x32_bf16 a[72:75], a[64:67], a[4:7], a[72:75]
    s_barrier
    s_waitcnt lgkmcnt(6)
    v_mfma_f32_16x16x32_bf16 v[16:19], a[32:35], a[48:51], v[16:19]
    ds_read_b64_tr_b16 a[0:1], v4 offset:32768
    v_mfma_f32_16x16x32_bf16 v[32:35], a[32:35], a[52:55], v[32:35]
    ds_read_b64_tr_b16 a[2:3], v4 offset:33792
    v_mfma_f32_16x16x32_bf16 v[48:51], a[32:35], a[56:59], v[48:51]
    ds_read_b128 a[16:19], v2 offset:32768
    v_mfma_f32_16x16x32_bf16 v[64:67], a[32:35], a[60:63], v[64:67]
    ds_read_b128 a[20:23], v2 offset:34816
    s_waitcnt lgkmcnt(4)
    v_mfma_f32_16x16x32_bf16 v[20:23], a[36:39], a[48:51], v[20:23]
    ds_read_b128 a[24:27], v2 offset:36864
    v_mfma_f32_16x16x32_bf16 v[36:39], a[36:39], a[52:55], v[36:39]
    ds_read_b128 a[28:31], v2 offset:38912
    v_mfma_f32_16x16x32_bf16 v[52:55], a[36:39], a[56:59], v[52:55]
    ds_read_b64_tr_b16 a[4:5], v5 offset:32768
    v_mfma_f32_16x16x32_bf16 v[68:71], a[36:39], a[60:63], v[68:71]
    ds_read_b64_tr_b16 a[6:7], v5 offset:33792
    v_mfma_f32_16x16x32_bf16 v[24:27], a[40:43], a[48:51], v[24:27]
    ds_read_b64_tr_b16 a[8:9], v6 offset:32768
    v_mfma_f32_16x16x32_bf16 v[40:43], a[40:43], a[52:55], v[40:43]
    ds_read_b64_tr_b16 a[10:11], v6 offset:33792
    v_mfma_f32_16x16x32_bf16 v[56:59], a[40:43], a[56:59], v[56:59]
    ds_read_b64_tr_b16 a[12:13], v7 offset:32768
    v_mfma_f32_16x16x32_bf16 v[72:75], a[40:43], a[60:63], v[72:75]
    ds_read_b64_tr_b16 a[14:15], v7 offset:33792
    v_mfma_f32_16x16x32_bf16 a[68:71], a[64:67], a[32:35], a[68:71]
    v_mfma_f32_16x16x32_bf16 v[28:31], a[44:47], a[48:51], v[28:31]
    v_mfma_f32_16x16x32_bf16 v[44:47], a[44:47], a[52:55], v[44:47]
    v_mfma_f32_16x16x32_bf16 v[60:63], a[44:47], a[56:59], v[60:63]
    v_mfma_f32_16x16x32_bf16 v[76:79], a[44:47], a[60:63], v[76:79]
    v_mfma_f32_16x16x32_bf16 a[72:75], a[64:67], a[36:39], a[72:75]
    s_waitcnt lgkmcnt(6)
    v_mfma_f32_16x16x32_bf16 v[16:19], a[0:3], a[16:19], v[16:19]
    ds_read_b64_tr_b16 a[32:33], v4 offset:40960
    v_mfma_f32_16x16x32_bf16 v[32:35], a[0:3], a[20:23], v[32:35]
    ds_read_b64_tr_b16 a[34:35], v4 offset:41984
    v_mfma_f32_16x16x32_bf16 v[48:51], a[0:3], a[24:27], v[48:51]
    ds_read_b128 a[48:51], v3 offset:32768
    v_mfma_f32_16x16x32_bf16 v[64:67], a[0:3], a[28:31], v[64:67]
    ds_read_b128 a[52:55], v3 offset:34816
    s_waitcnt lgkmcnt(4)
    v_mfma_f32_16x16x32_bf16 v[20:23], a[4:7], a[16:19], v[20:23]
    ds_read_b128 a[56:59], v3 offset:36864
    v_mfma_f32_16x16x32_bf16 v[36:39], a[4:7], a[20:23], v[36:39]
    ds_read_b128 a[60:63], v3 offset:38912
    v_mfma_f32_16x16x32_bf16 v[52:55], a[4:7], a[24:27], v[52:55]
    ds_read_b64_tr_b16 a[36:37], v5 offset:40960
    v_mfma_f32_16x16x32_bf16 v[68:71], a[4:7], a[28:31], v[68:71]
    ds_read_b64_tr_b16 a[38:39], v5 offset:41984
    v_mfma_f32_16x16x32_bf16 v[24:27], a[8:11], a[16:19], v[24:27]
    ds_read_b64_tr_b16 a[40:41], v6 offset:40960
    v_mfma_f32_16x16x32_bf16 v[40:43], a[8:11], a[20:23], v[40:43]
    ds_read_b64_tr_b16 a[42:43], v6 offset:41984
    v_mfma_f32_16x16x32_bf16 v[56:59], a[8:11], a[24:27], v[56:59]
    ds_read_b64_tr_b16 a[44:45], v7 offset:40960
    v_mfma_f32_16x16x32_bf16 v[72:75], a[8:11], a[28:31], v[72:75]
    ds_read_b64_tr_b16 a[46:47], v7 offset:41984
    v_mfma_f32_16x16x32_bf16 a[68:71], a[64:67], a[0:3], a[68:71]
    v_mfma_f32_16x16x32_bf16 v[28:31], a[12:15], a[16:19], v[28:31]
    v_mfma_f32_16x16x32_bf16 v[44:47], a[12:15], a[20:23], v[44:47]
    v_mfma_f32_16x16x32_bf16 v[60:63], a[12:15], a[24:27], v[60:63]
    v_mfma_f32_16x16x32_bf16 v[76:79], a[12:15], a[28:31], v[76:79]
    v_mfma_f32_16x16x32_bf16 a[72:75], a[64:67], a[4:7], a[72:75]
    s_barrier
    v_add_u32 v4, 65536, v4
    v_add_u32 v5, 65536, v5
    v_add_u32 v6, 65536, v6
    v_add_u32 v7, 65536, v7
    v_add_u32 v2, 65536, v2
    v_add_u32 v3, 65536, v3
    s_waitcnt lgkmcnt(6)
    v_mfma_f32_16x16x32_bf16 v[16:19], a[32:35], a[48:51], v[16:19]
    ds_read_b64_tr_b16 a[0:1], v4 offset:0
    v_mfma_f32_16x16x32_bf16 v[32:35], a[32:35], a[52:55], v[32:35]
    ds_read_b64_tr_b16 a[2:3], v4 offset:1024
    v_mfma_f32_16x16x32_bf16 v[48:51], a[32:35], a[56:59], v[48:51]
    ds_read_b128 a[16:19], v2 offset:0
    v_mfma_f32_16x16x32_bf16 v[64:67], a[32:35], a[60:63], v[64:67]
    ds_read_b128 a[20:23], v2 offset:2048
    s_waitcnt lgkmcnt(4)
    v_mfma_f32_16x16x32_bf16 v[20:23], a[36:39], a[48:51], v[20:23]
    ds_read_b128 a[24:27], v2 offset:4096
    v_mfma_f32_16x16x32_bf16 v[36:39], a[36:39], a[52:55], v[36:39]
    ds_read_b128 a[28:31], v2 offset:6144
    v_mfma_f32_16x16x32_bf16 v[52:55], a[36:39], a[56:59], v[52:55]
    ds_read_b64_tr_b16 a[4:5], v5 offset:0
    v_mfma_f32_16x16x32_bf16 v[68:71], a[36:39], a[60:63], v[68:71]
    ds_read_b64_tr_b16 a[6:7], v5 offset:1024
    v_mfma_f32_16x16x32_bf16 v[24:27], a[40:43], a[48:51], v[24:27]
    ds_read_b64_tr_b16 a[8:9], v6 offset:0
    v_mfma_f32_16x16x32_bf16 v[40:43], a[40:43], a[52:55], v[40:43]
    ds_read_b64_tr_b16 a[10:11], v6 offset:1024
    v_mfma_f32_16x16x32_bf16 v[56:59], a[40:43], a[56:59], v[56:59]
    ds_read_b64_tr_b16 a[12:13], v7 offset:0
    v_mfma_f32_16x16x32_bf16 v[72:75], a[40:43], a[60:63], v[72:75]
    ds_read_b64_tr_b16 a[14:15], v7 offset:1024
    v_mfma_f32_16x16x32_bf16 a[68:71], a[64:67], a[32:35], a[68:71]
    v_mfma_f32_16x16x32_bf16 v[28:31], a[44:47], a[48:51], v[28:31]
    v_mfma_f32_16x16x32_bf16 v[44:47], a[44:47], a[52:55], v[44:47]
    v_mfma_f32_16x16x32_bf16 v[60:63], a[44:47], a[56:59], v[60:63]
    v_mfma_f32_16x16x32_bf16 v[76:79], a[44:47], a[60:63], v[76:79]
    v_mfma_f32_16x16x32_bf16 a[72:75], a[64:67], a[36:39], a[72:75]
    s_waitcnt lgkmcnt(6)
    v_mfma_f32_16x16x32_bf16 v[16:19], a[0:3], a[16:19], v[16:19]
    ds_read_b64_tr_b16 a[32:33], v4 offset:8192
    v_mfma_f32_16x16x32_bf16 v[32:35], a[0:3], a[20:23], v[32:35]
    ds_read_b64_tr_b16 a[34:35], v4 offset:9216
    v_mfma_f32_16x16x32_bf16 v[48:51], a[0:3], a[24:27], v[48:51]
    ds_read_b128 a[48:51], v3 offset:0
    v_mfma_f32_16x16x32_bf16 v[64:67], a[0:3], a[28:31], v[64:67]
    ds_read_b128 a[52:55], v3 offset:2048
    s_waitcnt lgkmcnt(4)
    v_mfma_f32_16x16x32_bf16 v[20:23], a[4:7], a[16:19], v[20:23]
    ds_read_b128 a[56:59], v3 offset:4096
    v_mfma_f32_16x16x32_bf16 v[36:39], a[4:7], a[20:23], v[36:39]
    ds_read_b128 a[60:63], v3 offset:6144
    v_mfma_f32_16x16x32_bf16 v[52:55], a[4:7], a[24:27], v[52:55]
    ds_read_b64_tr_b16 a[36:37], v5 offset:8192
    v_mfma_f32_16x16x32_bf16 v[68:71], a[4:7], a[28:31], v[68:71]
    ds_read_b64_tr_b16 a[38:39], v5 offset:9216
    v_mfma_f32_16x16x32_bf16 v[24:27], a[8:11], a[16:19], v[24:27]
    ds_read_b64_tr_b16 a[40:41], v6 offset:8192
    v_mfma_f32_16x16x32_bf16 v[40:43], a[8:11], a[20:23], v[40:43]
    ds_read_b64_tr_b16 a[42:43], v6 offset:9216
    v_mfma_f32_16x16x32_bf16 v[56:59], a[8:11], a[24:27], v[56:59]
    ds_read_b64_tr_b16 a[44:45], v7 offset:8192
    v_mfma_f32_16x16x32_bf16 v[72:75], a[8:11], a[28:31], v[72:75]
    ds_read_b64_tr_b16 a[46:47], v7 offset:9216
    v_mfma_f32_16x16x32_bf16 a[68:71], a[64:67], a[0:3], a[68:71]
    v_mfma_f32_16x16x32_bf16 v[28:31], a[12:15], a[16:19], v[28:31]
    v_mfma_f32_16x16x32_bf16 v[44:47], a[12:15], a[20:23], v[44:47]
    v_mfma_f32_16x16x32_bf16 v[60:63], a[12:15], a[24:27], v[60:63]
    v_mfma_f32_16x16x32_bf16 v[76:79], a[12:15], a[28:31], v[76:79]
    v_mfma_f32_16x16x32_bf16 a[72:75], a[64:67], a[4:7], a[72:75]
    buffer_load_dword v8, v87, s[48:51], s20 offen sc1
    s_barrier
    s_waitcnt lgkmcnt(6)
    v_mfma_f32_16x16x32_bf16 v[16:19], a[32:35], a[48:51], v[16:19]
    ds_read_b64_tr_b16 a[0:1], v4 offset:32768
    v_mfma_f32_16x16x32_bf16 v[32:35], a[32:35], a[52:55], v[32:35]
    ds_read_b64_tr_b16 a[2:3], v4 offset:33792
    v_mfma_f32_16x16x32_bf16 v[48:51], a[32:35], a[56:59], v[48:51]
    ds_read_b128 a[16:19], v2 offset:32768
    v_mfma_f32_16x16x32_bf16 v[64:67], a[32:35], a[60:63], v[64:67]
    ds_read_b128 a[20:23], v2 offset:34816
    s_waitcnt lgkmcnt(4)
    v_mfma_f32_16x16x32_bf16 v[20:23], a[36:39], a[48:51], v[20:23]
    ds_read_b128 a[24:27], v2 offset:36864
    v_mfma_f32_16x16x32_bf16 v[36:39], a[36:39], a[52:55], v[36:39]
    ds_read_b128 a[28:31], v2 offset:38912
    v_mfma_f32_16x16x32_bf16 v[52:55], a[36:39], a[56:59], v[52:55]
    ds_read_b64_tr_b16 a[4:5], v5 offset:32768
    v_mfma_f32_16x16x32_bf16 v[68:71], a[36:39], a[60:63], v[68:71]
    ds_read_b64_tr_b16 a[6:7], v5 offset:33792
    v_mfma_f32_16x16x32_bf16 v[24:27], a[40:43], a[48:51], v[24:27]
    ds_read_b64_tr_b16 a[8:9], v6 offset:32768
    v_mfma_f32_16x16x32_bf16 v[40:43], a[40:43], a[52:55], v[40:43]
    ds_read_b64_tr_b16 a[10:11], v6 offset:33792
    v_mfma_f32_16x16x32_bf16 v[56:59], a[40:43], a[56:59], v[56:59]
    ds_read_b64_tr_b16 a[12:13], v7 offset:32768
    v_mfma_f32_16x16x32_bf16 v[72:75], a[40:43], a[60:63], v[72:75]
    ds_read_b64_tr_b16 a[14:15], v7 offset:33792
    v_mfma_f32_16x16x32_bf16 a[68:71], a[64:67], a[32:35], a[68:71]
    v_mfma_f32_16x16x32_bf16 v[28:31], a[44:47], a[48:51], v[28:31]
    v_mfma_f32_16x16x32_bf16 v[44:47], a[44:47], a[52:55], v[44:47]
    v_mfma_f32_16x16x32_bf16 v[60:63], a[44:47], a[56:59], v[60:63]
    v_mfma_f32_16x16x32_bf16 v[76:79], a[44:47], a[60:63], v[76:79]
    v_mfma_f32_16x16x32_bf16 a[72:75], a[64:67], a[36:39], a[72:75]
    s_waitcnt lgkmcnt(6)
    v_mfma_f32_16x16x32_bf16 v[16:19], a[0:3], a[16:19], v[16:19]
    ds_read_b64_tr_b16 a[32:33], v4 offset:40960
    v_mfma_f32_16x16x32_bf16 v[32:35], a[0:3], a[20:23], v[32:35]
    ds_read_b64_tr_b16 a[34:35], v4 offset:41984
    v_mfma_f32_16x16x32_bf16 v[48:51], a[0:3], a[24:27], v[48:51]
    ds_read_b128 a[48:51], v3 offset:32768
    v_mfma_f32_16x16x32_bf16 v[64:67], a[0:3], a[28:31], v[64:67]
    ds_read_b128 a[52:55], v3 offset:34816
    s_waitcnt lgkmcnt(4)
    v_mfma_f32_16x16x32_bf16 v[20:23], a[4:7], a[16:19], v[20:23]
    ds_read_b128 a[56:59], v3 offset:36864
    v_mfma_f32_16x16x32_bf16 v[36:39], a[4:7], a[20:23], v[36:39]
    ds_read_b128 a[60:63], v3 offset:38912
    v_mfma_f32_16x16x32_bf16 v[52:55], a[4:7], a[24:27], v[52:55]
    ds_read_b64_tr_b16 a[36:37], v5 offset:40960
    v_mfma_f32_16x16x32_bf16 v[68:71], a[4:7], a[28:31], v[68:71]
    ds_read_b64_tr_b16 a[38:39], v5 offset:41984
    v_mfma_f32_16x16x32_bf16 v[24:27], a[8:11], a[16:19], v[24:27]
    ds_read_b64_tr_b16 a[40:41], v6 offset:40960
    v_mfma_f32_16x16x32_bf16 v[40:43], a[8:11], a[20:23], v[40:43]
    ds_read_b64_tr_b16 a[42:43], v6 offset:41984
    v_mfma_f32_16x16x32_bf16 v[56:59], a[8:11], a[24:27], v[56:59]
    ds_read_b64_tr_b16 a[44:45], v7 offset:40960
    v_mfma_f32_16x16x32_bf16 v[72:75], a[8:11], a[28:31], v[72:75]
    ds_read_b64_tr_b16 a[46:47], v7 offset:41984
    v_mfma_f32_16x16x32_bf16 a[68:71], a[64:67], a[0:3], a[68:71]
    v_mfma_f32_16x16x32_bf16 v[28:31], a[12:15], a[16:19], v[28:31]
    v_mfma_f32_16x16x32_bf16 v[44:47], a[12:15], a[20:23], v[44:47]
    v_mfma_f32_16x16x32_bf16 v[60:63], a[12:15], a[24:27], v[60:63]
    v_mfma_f32_16x16x32_bf16 v[76:79], a[12:15], a[28:31], v[76:79]
    v_mfma_f32_16x16x32_bf16 a[72:75], a[64:67], a[4:7], a[72:75]
    s_barrier
    v_add_u32 v4, 65536, v4
    v_add_u32 v5, 65536, v5
    v_add_u32 v6, 65536, v6
    v_add_u32 v7, 65536, v7
    v_add_u32 v2, 65536, v2
    v_add_u32 v3, 65536, v3
    s_waitcnt lgkmcnt(6)
    v_mfma_f32_16x16x32_bf16 v[16:19], a[32:35], a[48:51], v[16:19]
    ds_read_b64_tr_b16 a[0:1], v4 offset:0
    v_mfma_f32_16x16x32_bf16 v[32:35], a[32:35], a[52:55], v[32:35]
    ds_read_b64_tr_b16 a[2:3], v4 offset:1024
    v_mfma_f32_16x16x32_bf16 v[48:51], a[32:35], a[56:59], v[48:51]
    ds_read_b128 a[16:19], v2 offset:0
    v_mfma_f32_16x16x32_bf16 v[64:67], a[32:35], a[60:63], v[64:67]
    ds_read_b128 a[20:23], v2 offset:2048
    s_waitcnt lgkmcnt(4)
    v_mfma_f32_16x16x32_bf16 v[20:23], a[36:39], a[48:51], v[20:23]
    ds_read_b128 a[24:27], v2 offset:4096
    v_mfma_f32_16x16x32_bf16 v[36:39], a[36:39], a[52:55], v[36:39]
    ds_read_b128 a[28:31], v2 offset:6144
    v_mfma_f32_16x16x32_bf16 v[52:55], a[36:39], a[56:59], v[52:55]
    ds_read_b64_tr_b16 a[4:5], v5 offset:0
    v_mfma_f32_16x16x32_bf16 v[68:71], a[36:39], a[60:63], v[68:71]
    ds_read_b64_tr_b16 a[6:7], v5 offset:1024
    v_mfma_f32_16x16x32_bf16 v[24:27], a[40:43], a[48:51], v[24:27]
    ds_read_b64_tr_b16 a[8:9], v6 offset:0
    v_mfma_f32_16x16x32_bf16 v[40:43], a[40:43], a[52:55], v[40:43]
    ds_read_b64_tr_b16 a[10:11], v6 offset:1024
    v_mfma_f32_16x16x32_bf16 v[56:59], a[40:43], a[56:59], v[56:59]
    ds_read_b64_tr_b16 a[12:13], v7 offset:0
    v_mfma_f32_16x16x32_bf16 v[72:75], a[40:43], a[60:63], v[72:75]
    ds_read_b64_tr_b16 a[14:15], v7 offset:1024
    v_mfma_f32_16x16x32_bf16 a[68:71], a[64:67], a[32:35], a[68:71]
    v_mfma_f32_16x16x32_bf16 v[28:31], a[44:47], a[48:51], v[28:31]
    v_mfma_f32_16x16x32_bf16 v[44:47], a[44:47], a[52:55], v[44:47]
    v_mfma_f32_16x16x32_bf16 v[60:63], a[44:47], a[56:59], v[60:63]
    v_mfma_f32_16x16x32_bf16 v[76:79], a[44:47], a[60:63], v[76:79]
    v_mfma_f32_16x16x32_bf16 a[72:75], a[64:67], a[36:39], a[72:75]
    s_mov_b32 s23, 0
L_qp_2:
    s_waitcnt vmcnt(0)
    v_cmp_eq_u32 vcc, 0, v8
    s_add_u32 s23, s23, 1
    s_cmp_lt_u32 s23, 0x40000
    s_cselect_b64 vcc, vcc, 0
    s_cbranch_vccz L_qd_3
    s_sleep 4
    buffer_load_dword v8, v87, s[48:51], s20 offen sc1
    s_branch L_qp_2
L_qd_3:
    buffer_load_dwordx2 v[88:89], v84, s[12:15], s19 offen offset:0 sc1
    buffer_load_dwordx2 v[90:91], v84, s[12:15], s19 offen offset:128 sc1
    buffer_load_dwordx2 v[92:93], v84, s[12:15], s19 offen offset:256 sc1
    buffer_load_dwordx2 v[94:95], v84, s[12:15], s19 offen offset:384 sc1
    buffer_load_dword v96, v85, s[12:15], s19 offen offset:1024 sc1
    buffer_load_dword v98, v85, s[12:15], s19 offen offset:1088 sc1
    buffer_load_dword v100, v85, s[12:15], s19 offen offset:1152 sc1
    buffer_load_dword v102, v85, s[12:15], s19 offen offset:1216 sc1
    s_waitcnt lgkmcnt(6)
    v_mfma_f32_16x16x32_bf16 v[16:19], a[0:3], a[16:19], v[16:19]
    ds_read_b64_tr_b16 a[32:33], v4 offset:8192
    v_mfma_f32_16x16x32_bf16 v[32:35], a[0:3], a[20:23], v[32:35]
    ds_read_b64_tr_b16 a[34:35], v4 offset:9216
    v_mfma_f32_16x16x32_bf16 v[48:51], a[0:3], a[24:27], v[48:51]
    ds_read_b128 a[48:51], v3 offset:0
    v_mfma_f32_16x16x32_bf16 v[64:67], a[0:3], a[28:31], v[64:67]
    ds_read_b128 a[52:55], v3 offset:2048
    s_waitcnt lgkmcnt(4)
    v_mfma_f32_16x16x32_bf16 v[20:23], a[4:7], a[16:19], v[20:23]
    ds_read_b128 a[56:59], v3 offset:4096
    v_mfma_f32_16x16x32_bf16 v[36:39], a[4:7], a[20:23], v[36:39]
    ds_read_b128 a[60:63], v3 offset:6144
    v_mfma_f32_16x16x32_bf16 v[52:55], a[4:7], a[24:27], v[52:55]
    ds_read_b64_tr_b16 a[36:37], v5 offset:8192
    v_mfma_f32_16x16x32_bf16 v[68:71], a[4:7], a[28:31], v[68:71]
    ds_read_b64_tr_b16 a[38:39], v5 offset:9216
    v_mfma_f32_16x16x32_bf16 v[24:27], a[8:11], a[16:19], v[24:27]
    ds_read_b64_tr_b16 a[40:41], v6 offset:8192
    v_mfma_f32_16x16x32_bf16 v[40:43], a[8:11], a[20:23], v[40:43]
    ds_read_b64_tr_b16 a[42:43], v6 offset:9216
    v_mfma_f32_16x16x32_bf16 v[56:59], a[8:11], a[24:27], v[56:59]
    ds_read_b64_tr_b16 a[44:45], v7 offset:8192
    v_mfma_f32_16x16x32_bf16 v[72:75], a[8:11], a[28:31], v[72:75]
    ds_read_b64_tr_b16 a[46:47], v7 offset:9216
    v_mfma_f32_16x16x32_bf16 a[68:71], a[64:67], a[0:3], a[68:71]
    v_mfma_f32_16x16x32_bf16 v[28:31], a[12:15], a[16:19], v[28:31]
    v_mfma_f32_16x16x32_bf16 v[44:47], a[12:15], a[20:23], v[44:47]
    v_mfma_f32_16x16x32_bf16 v[60:63], a[12:15], a[24:27], v[60:63]
    v_mfma_f32_16x16x32_bf16 v[76:79], a[12:15], a[28:31], v[76:79]
    v_mfma_f32_16x16x32_bf16 a[72:75], a[64:67], a[4:7], a[72:75]
    s_waitcnt lgkmcnt(0)
    v_mfma_f32_16x16x32_bf16 a[68:71], a[64:67], a[32:35], a[68:71]
    v_mfma_f32_16x16x32_bf16 a[72:75], a[64:67], a[36:39], a[72:75]
    v_mfma_f32_16x16x32_bf16 v[16:19], a[32:35], a[48:51], v[16:19]
    s_lshl_b32 s22, s44, 10
    s_lshl_b32 s23, s45, 10
    v_mfma_f32_16x16x32_bf16 v[32:35], a[32:35], a[52:55], v[32:35]
    v_lshlrev_b32 v4, 4, v0
    v_add_u32 v5, s23, v4
    v_mfma_f32_16x16x32_bf16 v[48:51], a[32:35], a[56:59], v[48:51]
    v_add_u32 v4, s22, v4
    s_nop 0
    v_mfma_f32_16x16x32_bf16 v[64:67], a[32:35], a[60:63], v[64:67]
    v_accvgpr_read_b32 v6, a68
    v_cvt_pk_bf16_f32 v7, v6, v6
    v_mfma_f32_16x16x32_bf16 v[20:23], a[36:39], a[48:51], v[20:23]
    v_and_b32 v7, 0xffff0000, v7
    v_sub_f32 v6, v6, v7
    v_mfma_f32_16x16x32_bf16 v[36:39], a[36:39], a[52:55], v[36:39]
    v_cvt_pk_bf16_f32 v8, v7, v6
    v_lshrrev_b32 v9, 16, v7
    v_mfma_f32_16x16x32_bf16 v[52:55], a[36:39], a[56:59], v[52:55]
    v_accvgpr_read_b32 v6, a72
    v_cvt_pk_bf16_f32 v7, v6, v6
    v_mfma_f32_16x16x32_bf16 v[68:71], a[36:39], a[60:63], v[68:71]
    v_and_b32 v7, 0xffff0000, v7
    v_sub_f32 v6, v6, v7
    v_mfma_f32_16x16x32_bf16 v[24:27], a[40:43], a[48:51], v[24:27]
    v_cvt_pk_bf16_f32 v10, v7, v6
    v_lshrrev_b32 v11, 16, v7
    v_mfma_f32_16x16x32_bf16 v[40:43], a[40:43], a[52:55], v[40:43]
    ds_write_b128 v4, v[8:11] offset:32768
    v_mfma_f32_16x16x32_bf16 v[56:59], a[40:43], a[56:59], v[56:59]
    v_mfma_f32_16x16x32_bf16 v[72:75], a[40:43], a[60:63], v[72:75]
    s_waitcnt lgkmcnt(0)
    s_barrier
    ds_read_b128 v[12:15], v5 offset:32768
    v_mfma_f32_16x16x32_bf16 v[28:31], a[44:47], a[48:51], v[28:31]
    v_mfma_f32_16x16x32_bf16 v[44:47], a[44:47], a[52:55], v[44:47]
    v_mfma_f32_16x16x32_bf16 v[60:63], a[44:47], a[56:59], v[60:63]
    v_mfma_f32_16x16x32_bf16 v[76:79], a[44:47], a[60:63], v[76:79]
    s_waitcnt vmcnt(0) lgkmcnt(0)
    v_mfma_f32_16x16x16_bf16 v[16:19], v[8:9], v[88:89], v[16:19]
    v_mfma_f32_16x16x16_bf16 v[20:23], v[10:11], v[88:89], v[20:23]
    v_mfma_f32_16x16x16_bf16 v[32:35], v[8:9], v[90:91], v[32:35]
    v_mfma_f32_16x16x16_bf16 v[36:39], v[10:11], v[90:91], v[36:39]
    v_mfma_f32_16x16x16_bf16 v[48:51], v[8:9], v[92:93], v[48:51]
    v_mfma_f32_16x16x16_bf16 v[52:55], v[10:11], v[92:93], v[52:55]
    v_mfma_f32_16x16x16_bf16 v[64:67], v[8:9], v[94:95], v[64:67]
    v_mul_f32 v96, s28, v96
    v_mov_b32 v97, v96
    v_mul_f32 v16, v96, v16
    v_mul_f32 v17, v96, v17
    v_mul_f32 v18, v96, v18
    v_mfma_f32_16x16x16_bf16 v[68:71], v[10:11], v[94:95], v[68:71]
    v_mul_f32 v19, v96, v19
    v_mul_f32 v20, v96, v20
    v_mul_f32 v21, v96, v21
    v_mul_f32 v22, v96, v22
    v_mul_f32 v23, v96, v23
    v_cvt_pk_bf16_f32 v16, v16, v17
    v_cvt_pk_bf16_f32 v17, v18, v19
    v_cvt_pk_bf16_f32 v18, v20, v21
    v_cvt_pk_bf16_f32 v19, v22, v23
    s_nop 0
    v_permlane16_swap_b32 v16, v18
    v_permlane16_swap_b32 v17, v19
    v_mfma_f32_16x16x16_bf16 v[24:27], v[12:13], v[88:89], v[24:27]
    v_mul_f32 v98, s28, v98
    v_mov_b32 v99, v98
    v_mul_f32 v32, v98, v32
    v_mul_f32 v33, v98, v33
    v_mul_f32 v34, v98, v34
    v_mfma_f32_16x16x16_bf16 v[28:31], v[14:15], v[88:89], v[28:31]
    v_mul_f32 v35, v98, v35
    v_mul_f32 v36, v98, v36
    v_mul_f32 v37, v98, v37
    v_mul_f32 v38, v98, v38
    v_mul_f32 v39, v98, v39
    v_cvt_pk_bf16_f32 v32, v32, v33
    v_cvt_pk_bf16_f32 v33, v34, v35
    v_cvt_pk_bf16_f32 v34, v36, v37
    v_cvt_pk_bf16_f32 v35, v38, v39
    buffer_store_dwordx4 v[16:19], v80, s[12:15], s27 offen offset:0 sc1
    v_permlane16_swap_b32 v32, v34
    v_permlane16_swap_b32 v33, v35
    v_mfma_f32_16x16x16_bf16 v[40:43], v[12:13], v[90:91], v[40:43]
    v_mul_f32 v100, s28, v100
    v_mov_b32 v101, v100
    v_mul_f32 v48, v100, v48
    v_mul_f32 v49, v100, v49
    v_mul_f32 v50, v100, v50
    v_mfma_f32_16x16x16_bf16 v[44:47], v[14:15], v[90:91], v[44:47]
    v_mul_f32 v51, v100, v51
    v_mul_f32 v52, v100, v52
    v_mul_f32 v53, v100, v53
    v_mul_f32 v54, v100, v54
    v_mul_f32 v55, v100, v55
    v_cvt_pk_bf16_f32 v48, v48, v49
    v_cvt_pk_bf16_f32 v49, v50, v51
    v_cvt_pk_bf16_f32 v50, v52, v53
    v_cvt_pk_bf16_f32 v51, v54, v55
    buffer_store_dwordx4 v[32:35], v80, s[12:15], s27 offen offset:256 sc1
    v_permlane16_swap_b32 v48, v50
    v_permlane16_swap_b32 v49, v51
    v_mfma_f32_16x16x16_bf16 v[56:59], v[12:13], v[92:93], v[56:59]
    v_mul_f32 v102, s28, v102
    v_mov_b32 v103, v102
    v_mul_f32 v64, v102, v64
    v_mul_f32 v65, v102, v65
    v_mul_f32 v66, v102, v66
    v_mfma_f32_16x16x16_bf16 v[60:63], v[14:15], v[92:93], v[60:63]
    v_mul_f32 v67, v102, v67
    v_mul_f32 v68, v102, v68
    v_mul_f32 v69, v102, v69
    v_mul_f32 v70, v102, v70
    v_mul_f32 v71, v102, v71
    v_cvt_pk_bf16_f32 v64, v64, v65
    v_cvt_pk_bf16_f32 v65, v66, v67
    v_cvt_pk_bf16_f32 v66, v68, v69
    v_cvt_pk_bf16_f32 v67, v70, v71
    buffer_store_dwordx4 v[48:51], v80, s[12:15], s27 offen offset:2560 sc1
    v_permlane16_swap_b32 v64, v66
    v_permlane16_swap_b32 v65, v67
    v_mfma_f32_16x16x16_bf16 v[72:75], v[12:13], v[94:95], v[72:75]
    v_mul_f32 v24, v96, v24
    v_mul_f32 v25, v96, v25
    v_mul_f32 v26, v96, v26
    v_mul_f32 v27, v96, v27
    v_mul_f32 v28, v96, v28
    v_mfma_f32_16x16x16_bf16 v[76:79], v[14:15], v[94:95], v[76:79]
    v_mul_f32 v29, v96, v29
    v_mul_f32 v30, v96, v30
    v_mul_f32 v31, v96, v31
    v_cvt_pk_bf16_f32 v24, v24, v25
    v_cvt_pk_bf16_f32 v25, v26, v27
    v_cvt_pk_bf16_f32 v26, v28, v29
    v_cvt_pk_bf16_f32 v27, v30, v31
    buffer_store_dwordx4 v[64:67], v80, s[12:15], s27 offen offset:2816 sc1
    v_permlane16_swap_b32 v24, v26
    v_permlane16_swap_b32 v25, v27
    v_mul_f32 v40, v98, v40
    v_mul_f32 v41, v98, v41
    v_mul_f32 v42, v98, v42
    v_mul_f32 v43, v98, v43
    v_mul_f32 v44, v98, v44
    v_mul_f32 v45, v98, v45
    v_mul_f32 v46, v98, v46
    v_mul_f32 v47, v98, v47
    v_cvt_pk_bf16_f32 v40, v40, v41
    v_cvt_pk_bf16_f32 v41, v42, v43
    v_cvt_pk_bf16_f32 v42, v44, v45
    v_cvt_pk_bf16_f32 v43, v46, v47
    buffer_store_dwordx4 v[24:27], v81, s[12:15], s27 offen offset:0 sc1
    v_permlane16_swap_b32 v40, v42
    v_permlane16_swap_b32 v41, v43
    v_pk_mul_f32 v[56:57], v[56:57], v[100:101]
    v_pk_mul_f32 v[58:59], v[58:59], v[100:101]
    v_pk_mul_f32 v[60:61], v[60:61], v[100:101]
    v_pk_mul_f32 v[62:63], v[62:63], v[100:101]
    v_cvt_pk_bf16_f32 v56, v56, v57
    v_cvt_pk_bf16_f32 v57, v58, v59
    v_cvt_pk_bf16_f32 v58, v60, v61
    v_cvt_pk_bf16_f32 v59, v62, v63
    buffer_store_dwordx4 v[40:43], v81, s[12:15], s27 offen offset:256 sc1
    v_permlane16_swap_b32 v56, v58
    v_permlane16_swap_b32 v57, v59
    v_pk_mul_f32 v[72:73], v[72:73], v[102:103]
    v_pk_mul_f32 v[74:75], v[74:75], v[102:103]
    v_pk_mul_f32 v[76:77], v[76:77], v[102:103]
    v_pk_mul_f32 v[78:79], v[78:79], v[102:103]
    v_cvt_pk_bf16_f32 v72, v72, v73
    v_cvt_pk_bf16_f32 v73, v74, v75
    v_cvt_pk_bf16_f32 v74, v76, v77
    v_cvt_pk_bf16_f32 v75, v78, v79
    buffer_store_dwordx4 v[56:59], v81, s[12:15], s27 offen offset:2560 sc1
    v_permlane16_swap_b32 v72, v74
    v_permlane16_swap_b32 v73, v75
    buffer_store_dwordx4 v[72:75], v81, s[12:15], s27 offen offset:2816 sc1
    s_branch L_qkv_fin
L_qkv_V:
    s_mul_i32 s27, s26, 1280
    s_add_u32 s27, s27, 0x500000
    s_sub_u32 s23, s18, 10
    s_lshl_b32 s23, s23, 7
    v_bfe_u32 v13, v0, 4, 1
    v_lshrrev_b32 v11, 5, v0
    v_lshl_add_u32 v13, v13, 1, v11
    v_mul_u32_u24 v13, 320, v13
    v_add_u32 v8, s23, v8
    s_mov_b32 s24, 81600
    s_lshl_b32 s22, s44, 5
    s_add_u32 s22, s22, 0
    v_add_u32 v11, s22, v8
    v_mul_u32_u24 v12, 3277, v11
    v_lshrrev_b32 v12, 16, v12
    v_mul_lo_u32 v12, s24, v12
    v_lshl_add_u32 v11, v11, 4, v13
    v_add_u32 v80, v11, v12
    s_lshl_b32 s22, s44, 5
    s_add_u32 s22, s22, 16
    v_add_u32 v11, s22, v8
    v_mul_u32_u24 v12, 3277, v11
    v_lshrrev_b32 v12, 16, v12
    v_mul_lo_u32 v12, s24, v12
    v_lshl_add_u32 v11, v11, 4, v13
    v_add_u32 v81, v11, v12
    s_lshl_b32 s22, s45, 5
    s_add_u32 s22, s22, 0
    v_add_u32 v11, s22, v8
    v_mul_u32_u24 v12, 3277, v11
    v_lshrrev_b32 v12, 16, v12
    v_mul_lo_u32 v12, s24, v12
    v_lshl_add_u32 v11, v11, 4, v13
    v_add_u32 v82, v11, v12
    s_lshl_b32 s22, s45, 5
    s_add_u32 s22, s22, 16
    v_add_u32 v11, s22, v8
    v_mul_u32_u24 v12, 3277, v11
    v_lshrrev_b32 v12, 16, v12
    v_mul_lo_u32 v12, s24, v12
    v_lshl_add_u32 v11, v11, 4, v13
    v_add_u32 v83, v11, v12
    s_barrier
    ds_read_b64_tr_b16 a[0:1], v4 offset:0
    ds_read_b64_tr_b16 a[2:3], v4 offset:1024
    ds_read_b128 a[16:19], v2 offset:0
    ds_read_b128 a[20:23], v2 offset:2048
    ds_read_b128 a[24:27], v2 offset:4096
    ds_read_b128 a[28:31], v2 offset:6144
    ds_read_b64_tr_b16 a[4:5], v5 offset:0
    ds_read_b64_tr_b16 a[6:7], v5 offset:1024
    ds_read_b64_tr_b16 a[8:9], v6 offset:0
    ds_read_b64_tr_b16 a[10:11], v6 offset:1024
    ds_read_b64_tr_b16 a[12:13], v7 offset:0
    ds_read_b64_tr_b16 a[14:15], v7 offset:1024
    s_waitcnt lgkmcnt(6)
    v_mfma_f32_16x16x32_bf16 v[16:19], a[16:19], a[0:3], 0
    ds_read_b64_tr_b16 a[32:33], v4 offset:8192
    v_mfma_f32_16x16x32_bf16 v[32:35], a[20:23], a[0:3], 0
    ds_read_b64_tr_b16 a[34:35], v4 offset:9216
    v_mfma_f32_16x16x32_bf16 v[48:51], a[24:27], a[0:3], 0
    ds_read_b128 a[48:51], v3 offset:0
    v_mfma_f32_16x16x32_bf16 v[64:67], a[28:31], a[0:3], 0
    ds_read_b128 a[52:55], v3 offset:2048
    s_waitcnt lgkmcnt(4)
    v_mfma_f32_16x16x32_bf16 v[20:23], a[16:19], a[4:7], 0
    ds_read_b128 a[56:59], v3 offset:4096
    v_mfma_f32_16x16x32_bf16 v[36:39], a[20:23], a[4:7], 0
    ds_read_b128 a[60:63], v3 offset:6144
    v_mfma_f32_16x16x32_bf16 v[52:55], a[24:27], a[4:7], 0
    ds_read_b64_tr_b16 a[36:37], v5 offset:8192
    v_mfma_f32_16x16x32_bf16 v[68:71], a[28:31], a[4:7], 0
    ds_read_b64_tr_b16 a[38:39], v5 offset:9216
    v_mfma_f32_16x16x32_bf16 v[24:27], a[16:19], a[8:11], 0
    ds_read_b64_tr_b16 a[40:41], v6 offset:8192
    v_mfma_f32_16x16x32_bf16 v[40:43], a[20:23], a[8:11], 0
    ds_read_b64_tr_b16 a[42:43], v6 offset:9216
    v_mfma_f32_16x16x32_bf16 v[56:59], a[24:27], a[8:11], 0
    ds_read_b64_tr_b16 a[44:45], v7 offset:8192
    v_mfma_f32_16x16x32_bf16 v[72:75], a[28:31], a[8:11], 0
    ds_read_b64_tr_b16 a[46:47], v7 offset:9216
    v_mfma_f32_16x16x32_bf16 a[68:71], a[64:67], a[0:3], 0
    v_mfma_f32_16x16x32_bf16 v[28:31], a[16:19], a[12:15], 0
    v_mfma_f32_16x16x32_bf16 v[44:47], a[20:23], a[12:15], 0
    v_mfma_f32_16x16x32_bf16 v[60:63], a[24:27], a[12:15], 0
    v_mfma_f32_16x16x32_bf16 v[76:79], a[28:31], a[12:15], 0
    v_mfma_f32_16x16x32_bf16 a[72:75], a[64:67], a[4:7], 0
    s_barrier
    s_waitcnt lgkmcnt(6)
    v_mfma_f32_16x16x32_bf16 v[16:19], a[48:51], a[32:35], v[16:19]
    ds_read_b64_tr_b16 a[0:1], v4 offset:32768
    v_mfma_f32_16x16x32_bf16 v[32:35], a[52:55], a[32:35], v[32:35]
    ds_read_b64_tr_b16 a[2:3], v4 offset:33792
    v_mfma_f32_16x16x32_bf16 v[48:51], a[56:59], a[32:35], v[48:51]
    ds_read_b128 a[16:19], v2 offset:32768
    v_mfma_f32_16x16x32_bf16 v[64:67], a[60:63], a[32:35], v[64:67]
    ds_read_b128 a[20:23], v2 offset:34816
    s_waitcnt lgkmcnt(4)
    v_mfma_f32_16x16x32_bf16 v[20:23], a[48:51], a[36:39], v[20:23]
    ds_read_b128 a[24:27], v2 offset:36864
    v_mfma_f32_16x16x32_bf16 v[36:39], a[52:55], a[36:39], v[36:39]
    ds_read_b128 a[28:31], v2 offset:38912
    v_mfma_f32_16x16x32_bf16 v[52:55], a[56:59], a[36:39], v[52:55]
    ds_read_b64_tr_b16 a[4:5], v5 offset:32768
    v_mfma_f32_16x16x32_bf16 v[68:71], a[60:63], a[36:39], v[68:71]
    ds_read_b64_tr_b16 a[6:7], v5 offset:33792
    v_mfma_f32_16x16x32_bf16 v[24:27], a[48:51], a[40:43], v[24:27]
    ds_read_b64_tr_b16 a[8:9], v6 offset:32768
    v_mfma_f32_16x16x32_bf16 v[40:43], a[52:55], a[40:43], v[40:43]
    ds_read_b64_tr_b16 a[10:11], v6 offset:33792
    v_mfma_f32_16x16x32_bf16 v[56:59], a[56:59], a[40:43], v[56:59]
    ds_read_b64_tr_b16 a[12:13], v7 offset:32768
    v_mfma_f32_16x16x32_bf16 v[72:75], a[60:63], a[40:43], v[72:75]
    ds_read_b64_tr_b16 a[14:15], v7 offset:33792
    v_mfma_f32_16x16x32_bf16 a[68:71], a[64:67], a[32:35], a[68:71]
    v_mfma_f32_16x16x32_bf16 v[28:31], a[48:51], a[44:47], v[28:31]
    v_mfma_f32_16x16x32_bf16 v[44:47], a[52:55], a[44:47], v[44:47]
    v_mfma_f32_16x16x32_bf16 v[60:63], a[56:59], a[44:47], v[60:63]
    v_mfma_f32_16x16x32_bf16 v[76:79], a[60:63], a[44:47], v[76:79]
    v_mfma_f32_16x16x32_bf16 a[72:75], a[64:67], a[36:39], a[72:75]
    s_waitcnt lgkmcnt(6)
    v_mfma_f32_16x16x32_bf16 v[16:19], a[16:19], a[0:3], v[16:19]
    ds_read_b64_tr_b16 a[32:33], v4 offset:40960
    v_mfma_f32_16x16x32_bf16 v[32:35], a[20:23], a[0:3], v[32:35]
    ds_read_b64_tr_b16 a[34:35], v4 offset:41984
    v_mfma_f32_16x16x32_bf16 v[48:51], a[24:27], a[0:3], v[48:51]
    ds_read_b128 a[48:51], v3 offset:32768
    v_mfma_f32_16x16x32_bf16 v[64:67], a[28:31], a[0:3], v[64:67]
    ds_read_b128 a[52:55], v3 offset:34816
    s_waitcnt lgkmcnt(4)
    v_mfma_f32_16x16x32_bf16 v[20:23], a[16:19], a[4:7], v[20:23]
    ds_read_b128 a[56:59], v3 offset:36864
    v_mfma_f32_16x16x32_bf16 v[36:39], a[20:23], a[4:7], v[36:39]
    ds_read_b128 a[60:63], v3 offset:38912
    v_mfma_f32_16x16x32_bf16 v[52:55], a[24:27], a[4:7], v[52:55]
    ds_read_b64_tr_b16 a[36:37], v5 offset:40960
    v_mfma_f32_16x16x32_bf16 v[68:71], a[28:31], a[4:7], v[68:71]
    ds_read_b64_tr_b16 a[38:39], v5 offset:41984
    v_mfma_f32_16x16x32_bf16 v[24:27], a[16:19], a[8:11], v[24:27]
    ds_read_b64_tr_b16 a[40:41], v6 offset:40960
    v_mfma_f32_16x16x32_bf16 v[40:43], a[20:23], a[8:11], v[40:43]
    ds_read_b64_tr_b16 a[42:43], v6 offset:41984
    v_mfma_f32_16x16x32_bf16 v[56:59], a[24:27], a[8:11], v[56:59]
    ds_read_b64_tr_b16 a[44:45], v7 offset:40960
    v_mfma_f32_16x16x32_bf16 v[72:75], a[28:31], a[8:11], v[72:75]
    ds_read_b64_tr_b16 a[46:47], v7 offset:41984
    v_mfma_f32_16x16x32_bf16 a[68:71], a[64:67], a[0:3], a[68:71]
    v_mfma_f32_16x16x32_bf16 v[28:31], a[16:19], a[12:15], v[28:31]
    v_mfma_f32_16x16x32_bf16 v[44:47], a[20:23], a[12:15], v[44:47]
    v_mfma_f32_16x16x32_bf16 v[60:63], a[24:27], a[12:15], v[60:63]
    v_mfma_f32_16x16x32_bf16 v[76:79], a[28:31], a[12:15], v[76:79]
    v_mfma_f32_16x16x32_bf16 a[72:75], a[64:67], a[4:7], a[72:75]
    s_barrier
    v_add_u32 v4, 65536, v4
    v_add_u32 v5, 65536, v5
    v_add_u32 v6, 65536, v6
    v_add_u32 v7, 65536, v7
    v_add_u32 v2, 65536, v2
    v_add_u32 v3, 65536, v3
    s_waitcnt lgkmcnt(6)
    v_mfma_f32_16x16x32_bf16 v[16:19], a[48:51], a[32:35], v[16:19]
    ds_read_b64_tr_b16 a[0:1], v4 offset:0
    v_mfma_f32_16x16x32_bf16 v[32:35], a[52:55], a[32:35], v[32:35]
    ds_read_b64_tr_b16 a[2:3], v4 offset:1024
    v_mfma_f32_16x16x32_bf16 v[48:51], a[56:59], a[32:35], v[48:51]
    ds_read_b128 a[16:19], v2 offset:0
    v_mfma_f32_16x16x32_bf16 v[64:67], a[60:63], a[32:35], v[64:67]
    ds_read_b128 a[20:23], v2 offset:2048
    s_waitcnt lgkmcnt(4)
    v_mfma_f32_16x16x32_bf16 v[20:23], a[48:51], a[36:39], v[20:23]
    ds_read_b128 a[24:27], v2 offset:4096
    v_mfma_f32_16x16x32_bf16 v[36:39], a[52:55], a[36:39], v[36:39]
    ds_read_b128 a[28:31], v2 offset:6144
    v_mfma_f32_16x16x32_bf16 v[52:55], a[56:59], a[36:39], v[52:55]
    ds_read_b64_tr_b16 a[4:5], v5 offset:0
    v_mfma_f32_16x16x32_bf16 v[68:71], a[60:63], a[36:39], v[68:71]
    ds_read_b64_tr_b16 a[6:7], v5 offset:1024
    v_mfma_f32_16x16x32_bf16 v[24:27], a[48:51], a[40:43], v[24:27]
    ds_read_b64_tr_b16 a[8:9], v6 offset:0
    v_mfma_f32_16x16x32_bf16 v[40:43], a[52:55], a[40:43], v[40:43]
    ds_read_b64_tr_b16 a[10:11], v6 offset:1024
    v_mfma_f32_16x16x32_bf16 v[56:59], a[56:59], a[40:43], v[56:59]
    ds_read_b64_tr_b16 a[12:13], v7 offset:0
    v_mfma_f32_16x16x32_bf16 v[72:75], a[60:63], a[40:43], v[72:75]
    ds_read_b64_tr_b16 a[14:15], v7 offset:1024
    v_mfma_f32_16x16x32_bf16 a[68:71], a[64:67], a[32:35], a[68:71]
    v_mfma_f32_16x16x32_bf16 v[28:31], a[48:51], a[44:47], v[28:31]
    v_mfma_f32_16x16x32_bf16 v[44:47], a[52:55], a[44:47], v[44:47]
    v_mfma_f32_16x16x32_bf16 v[60:63], a[56:59], a[44:47], v[60:63]
    v_mfma_f32_16x16x32_bf16 v[76:79], a[60:63], a[44:47], v[76:79]
    v_mfma_f32_16x16x32_bf16 a[72:75], a[64:67], a[36:39], a[72:75]
    s_waitcnt lgkmcnt(6)
    v_mfma_f32_16x16x32_bf16 v[16:19], a[16:19], a[0:3], v[16:19]
    ds_read_b64_tr_b16 a[32:33], v4 offset:8192
    v_mfma_f32_16x16x32_bf16 v[32:35], a[20:23], a[0:3], v[32:35]
    ds_read_b64_tr_b16 a[34:35], v4 offset:9216
    v_mfma_f32_16x16x32_bf16 v[48:51], a[24:27], a[0:3], v[48:51]
    ds_read_b128 a[48:51], v3 offset:0
    v_mfma_f32_16x16x32_bf16 v[64:67], a[28:31], a[0:3], v[64:67]
    ds_read_b128 a[52:55], v3 offset:2048
    s_waitcnt lgkmcnt(4)
    v_mfma_f32_16x16x32_bf16 v[20:23], a[16:19], a[4:7], v[20:23]
    ds_read_b128 a[56:59], v3 offset:4096
    v_mfma_f32_16x16x32_bf16 v[36:39], a[20:23], a[4:7], v[36:39]
    ds_read_b128 a[60:63], v3 offset:6144
    v_mfma_f32_16x16x32_bf16 v[52:55], a[24:27], a[4:7], v[52:55]
    ds_read_b64_tr_b16 a[36:37], v5 offset:8192
    v_mfma_f32_16x16x32_bf16 v[68:71], a[28:31], a[4:7], v[68:71]
    ds_read_b64_tr_b16 a[38:39], v5 offset:9216
    v_mfma_f32_16x16x32_bf16 v[24:27], a[16:19], a[8:11], v[24:27]
    ds_read_b64_tr_b16 a[40:41], v6 offset:8192
    v_mfma_f32_16x16x32_bf16 v[40:43], a[20:23], a[8:11], v[40:43]
    ds_read_b64_tr_b16 a[42:43], v6 offset:9216
    v_mfma_f32_16x16x32_bf16 v[56:59], a[24:27], a[8:11], v[56:59]
    ds_read_b64_tr_b16 a[44:45], v7 offset:8192
    v_mfma_f32_16x16x32_bf16 v[72:75], a[28:31], a[8:11], v[72:75]
    ds_read_b64_tr_b16 a[46:47], v7 offset:9216
    v_mfma_f32_16x16x32_bf16 a[68:71], a[64:67], a[0:3], a[68:71]
    v_mfma_f32_16x16x32_bf16 v[28:31], a[16:19], a[12:15], v[28:31]
    v_mfma_f32_16x16x32_bf16 v[44:47], a[20:23], a[12:15], v[44:47]
    v_mfma_f32_16x16x32_bf16 v[60:63], a[24:27], a[12:15], v[60:63]
    v_mfma_f32_16x16x32_bf16 v[76:79], a[28:31], a[12:15], v[76:79]
    v_mfma_f32_16x16x32_bf16 a[72:75], a[64:67], a[4:7], a[72:75]
    s_barrier
    s_waitcnt lgkmcnt(6)
    v_mfma_f32_16x16x32_bf16 v[16:19], a[48:51], a[32:35], v[16:19]
    ds_read_b64_tr_b16 a[0:1], v4 offset:32768
    v_mfma_f32_16x16x32_bf16 v[32:35], a[52:55], a[32:35], v[32:35]
    ds_read_b64_tr_b16 a[2:3], v4 offset:33792
    v_mfma_f32_16x16x32_bf16 v[48:51], a[56:59], a[32:35], v[48:51]
    ds_read_b128 a[16:19], v2 offset:32768
    v_mfma_f32_16x16x32_bf16 v[64:67], a[60:63], a[32:35], v[64:67]
    ds_read_b128 a[20:23], v2 offset:34816
    s_waitcnt lgkmcnt(4)
    v_mfma_f32_16x16x32_bf16 v[20:23], a[48:51], a[36:39], v[20:23]
    ds_read_b128 a[24:27], v2 offset:36864
    v_mfma_f32_16x16x32_bf16 v[36:39], a[52:55], a[36:39], v[36:39]
    ds_read_b128 a[28:31], v2 offset:38912
    v_mfma_f32_16x16x32_bf16 v[52:55], a[56:59], a[36:39], v[52:55]
    ds_read_b64_tr_b16 a[4:5], v5 offset:32768
    v_mfma_f32_16x16x32_bf16 v[68:71], a[60:63], a[36:39], v[68:71]
    ds_read_b64_tr_b16 a[6:7], v5 offset:33792
    v_mfma_f32_16x16x32_bf16 v[24:27], a[48:51], a[40:43], v[24:27]
    ds_read_b64_tr_b16 a[8:9], v6 offset:32768
    v_mfma_f32_16x16x32_bf16 v[40:43], a[52:55], a[40:43], v[40:43]
    ds_read_b64_tr_b16 a[10:11], v6 offset:33792
    v_mfma_f32_16x16x32_bf16 v[56:59], a[56:59], a[40:43], v[56:59]
    ds_read_b64_tr_b16 a[12:13], v7 offset:32768
    v_mfma_f32_16x16x32_bf16 v[72:75], a[60:63], a[40:43], v[72:75]
    ds_read_b64_tr_b16 a[14:15], v7 offset:33792
    v_mfma_f32_16x16x32_bf16 a[68:71], a[64:67], a[32:35], a[68:71]
    v_mfma_f32_16x16x32_bf16 v[28:31], a[48:51], a[44:47], v[28:31]
    v_mfma_f32_16x16x32_bf16 v[44:47], a[52:55], a[44:47], v[44:47]
    v_mfma_f32_16x16x32_bf16 v[60:63], a[56:59], a[44:47], v[60:63]
    v_mfma_f32_16x16x32_bf16 v[76:79], a[60:63], a[44:47], v[76:79]
    v_mfma_f32_16x16x32_bf16 a[72:75], a[64:67], a[36:39], a[72:75]
    s_waitcnt lgkmcnt(6)
    v_mfma_f32_16x16x32_bf16 v[16:19], a[16:19], a[0:3], v[16:19]
    ds_read_b64_tr_b16 a[32:33], v4 offset:40960
    v_mfma_f32_16x16x32_bf16 v[32:35], a[20:23], a[0:3], v[32:35]
    ds_read_b64_tr_b16 a[34:35], v4 offset:41984
    v_mfma_f32_16x16x32_bf16 v[48:51], a[24:27], a[0:3], v[48:51]
    ds_read_b128 a[48:51], v3 offset:32768
    v_mfma_f32_16x16x32_bf16 v[64:67], a[28:31], a[0:3], v[64:67]
    ds_read_b128 a[52:55], v3 offset:34816
    s_waitcnt lgkmcnt(4)
    v_mfma_f32_16x16x32_bf16 v[20:23], a[16:19], a[4:7], v[20:23]
    ds_read_b128 a[56:59], v3 offset:36864
    v_mfma_f32_16x16x32_bf16 v[36:39], a[20:23], a[4:7], v[36:39]
    ds_read_b128 a[60:63], v3 offset:38912
    v_mfma_f32_16x16x32_bf16 v[52:55], a[24:27], a[4:7], v[52:55]
    ds_read_b64_tr_b16 a[36:37], v5 offset:40960
    v_mfma_f32_16x16x32_bf16 v[68:71], a[28:31], a[4:7], v[68:71]
    ds_read_b64_tr_b16 a[38:39], v5 offset:41984
    v_mfma_f32_16x16x32_bf16 v[24:27], a[16:19], a[8:11], v[24:27]
    ds_read_b64_tr_b16 a[40:41], v6 offset:40960
    v_mfma_f32_16x16x32_bf16 v[40:43], a[20:23], a[8:11], v[40:43]
    ds_read_b64_tr_b16 a[42:43], v6 offset:41984
    v_mfma_f32_16x16x32_bf16 v[56:59], a[24:27], a[8:11], v[56:59]
    ds_read_b64_tr_b16 a[44:45], v7 offset:40960
    v_mfma_f32_16x16x32_bf16 v[72:75], a[28:31], a[8:11], v[72:75]
    ds_read_b64_tr_b16 a[46:47], v7 offset:41984
    v_mfma_f32_16x16x32_bf16 a[68:71], a[64:67], a[0:3], a[68:71]
    v_mfma_f32_16x16x32_bf16 v[28:31], a[16:19], a[12:15], v[28:31]
    v_mfma_f32_16x16x32_bf16 v[44:47], a[20:23], a[12:15], v[44:47]
    v_mfma_f32_16x16x32_bf16 v[60:63], a[24:27], a[12:15], v[60:63]
    v_mfma_f32_16x16x32_bf16 v[76:79], a[28:31], a[12:15], v[76:79]
    v_mfma_f32_16x16x32_bf16 a[72:75], a[64:67], a[4:7], a[72:75]
    s_barrier
    v_add_u32 v4, 65536, v4
    v_add_u32 v5, 65536, v5
    v_add_u32 v6, 65536, v6
    v_add_u32 v7, 65536, v7
    v_add_u32 v2, 65536, v2
    v_add_u32 v3, 65536, v3
    s_waitcnt lgkmcnt(6)
    v_mfma_f32_16x16x32_bf16 v[16:19], a[48:51], a[32:35], v[16:19]
    ds_read_b64_tr_b16 a[0:1], v4 offset:0
    v_mfma_f32_16x16x32_bf16 v[32:35], a[52:55], a[32:35], v[32:35]
    ds_read_b64_tr_b16 a[2:3], v4 offset:1024
    v_mfma_f32_16x16x32_bf16 v[48:51], a[56:59], a[32:35], v[48:51]
    ds_read_b128 a[16:19], v2 offset:0
    v_mfma_f32_16x16x32_bf16 v[64:67], a[60:63], a[32:35], v[64:67]
    ds_read_b128 a[20:23], v2 offset:2048
    s_waitcnt lgkmcnt(4)
    v_mfma_f32_16x16x32_bf16 v[20:23], a[48:51], a[36:39], v[20:23]
    ds_read_b128 a[24:27], v2 offset:4096
    v_mfma_f32_16x16x32_bf16 v[36:39], a[52:55], a[36:39], v[36:39]
    ds_read_b128 a[28:31], v2 offset:6144
    v_mfma_f32_16x16x32_bf16 v[52:55], a[56:59], a[36:39], v[52:55]
    ds_read_b64_tr_b16 a[4:5], v5 offset:0
    v_mfma_f32_16x16x32_bf16 v[68:71], a[60:63], a[36:39], v[68:71]
    ds_read_b64_tr_b16 a[6:7], v5 offset:1024
    v_mfma_f32_16x16x32_bf16 v[24:27], a[48:51], a[40:43], v[24:27]
    ds_read_b64_tr_b16 a[8:9], v6 offset:0
    v_mfma_f32_16x16x32_bf16 v[40:43], a[52:55], a[40:43], v[40:43]
    ds_read_b64_tr_b16 a[10:11], v6 offset:1024
    v_mfma_f32_16x16x32_bf16 v[56:59], a[56:59], a[40:43], v[56:59]
    ds_read_b64_tr_b16 a[12:13], v7 offset:0
    v_mfma_f32_16x16x32_bf16 v[72:75], a[60:63], a[40:43], v[72:75]
    ds_read_b64_tr_b16 a[14:15], v7 offset:1024
    v_mfma_f32_16x16x32_bf16 a[68:71], a[64:67], a[32:35], a[68:71]
    v_mfma_f32_16x16x32_bf16 v[28:31], a[48:51], a[44:47], v[28:31]
    v_mfma_f32_16x16x32_bf16 v[44:47], a[52:55], a[44:47], v[44:47]
    v_mfma_f32_16x16x32_bf16 v[60:63], a[56:59], a[44:47], v[60:63]
    v_mfma_f32_16x16x32_bf16 v[76:79], a[60:63], a[44:47], v[76:79]
    v_mfma_f32_16x16x32_bf16 a[72:75], a[64:67], a[36:39], a[72:75]
    s_waitcnt lgkmcnt(6)
    v_mfma_f32_16x16x32_bf16 v[16:19], a[16:19], a[0:3], v[16:19]
    ds_read_b64_tr_b16 a[32:33], v4 offset:8192
    v_mfma_f32_16x16x32_bf16 v[32:35], a[20:23], a[0:3], v[32:35]
    ds_read_b64_tr_b16 a[34:35], v4 offset:9216
    v_mfma_f32_16x16x32_bf16 v[48:51], a[24:27], a[0:3], v[48:51]
    ds_read_b128 a[48:51], v3 offset:0
    v_mfma_f32_16x16x32_bf16 v[64:67], a[28:31], a[0:3], v[64:67]
    ds_read_b128 a[52:55], v3 offset:2048
    s_waitcnt lgkmcnt(4)
    v_mfma_f32_16x16x32_bf16 v[20:23], a[16:19], a[4:7], v[20:23]
    ds_read_b128 a[56:59], v3 offset:4096
    v_mfma_f32_16x16x32_bf16 v[36:39], a[20:23], a[4:7], v[36:39]
    ds_read_b128 a[60:63], v3 offset:6144
    v_mfma_f32_16x16x32_bf16 v[52:55], a[24:27], a[4:7], v[52:55]
    ds_read_b64_tr_b16 a[36:37], v5 offset:8192
    v_mfma_f32_16x16x32_bf16 v[68:71], a[28:31], a[4:7], v[68:71]
    ds_read_b64_tr_b16 a[38:39], v5 offset:9216
    v_mfma_f32_16x16x32_bf16 v[24:27], a[16:19], a[8:11], v[24:27]
    ds_read_b64_tr_b16 a[40:41], v6 offset:8192
    v_mfma_f32_16x16x32_bf16 v[40:43], a[20:23], a[8:11], v[40:43]
    ds_read_b64_tr_b16 a[42:43], v6 offset:9216
    v_mfma_f32_16x16x32_bf16 v[56:59], a[24:27], a[8:11], v[56:59]
    ds_read_b64_tr_b16 a[44:45], v7 offset:8192
    v_mfma_f32_16x16x32_bf16 v[72:75], a[28:31], a[8:11], v[72:75]
    ds_read_b64_tr_b16 a[46:47], v7 offset:9216
    v_mfma_f32_16x16x32_bf16 a[68:71], a[64:67], a[0:3], a[68:71]
    v_mfma_f32_16x16x32_bf16 v[28:31], a[16:19], a[12:15], v[28:31]
    v_mfma_f32_16x16x32_bf16 v[44:47], a[20:23], a[12:15], v[44:47]
    v_mfma_f32_16x16x32_bf16 v[60:63], a[24:27], a[12:15], v[60:63]
    v_mfma_f32_16x16x32_bf16 v[76:79], a[28:31], a[12:15], v[76:79]
    v_mfma_f32_16x16x32_bf16 a[72:75], a[64:67], a[4:7], a[72:75]
    s_barrier
    v_add_u32 v4, 4294836224, v4
    v_add_u32 v5, 4294836224, v5
    v_add_u32 v6, 4294836224, v6
    v_add_u32 v7, 4294836224, v7
    v_add_u32 v2, 4294836224, v2
    v_add_u32 v3, 4294836224, v3
    s_waitcnt lgkmcnt(6)
    v_mfma_f32_16x16x32_bf16 v[16:19], a[48:51], a[32:35], v[16:19]
    ds_read_b64_tr_b16 a[0:1], v4 offset:0
    v_mfma_f32_16x16x32_bf16 v[32:35], a[52:55], a[32:35], v[32:35]
    ds_read_b64_tr_b16 a[2:3], v4 offset:1024
    v_mfma_f32_16x16x32_bf16 v[48:51], a[56:59], a[32:35], v[48:51]
    ds_read_b128 a[16:19], v2 offset:0
    v_mfma_f32_16x16x32_bf16 v[64:67], a[60:63], a[32:35], v[64:67]
    ds_read_b128 a[20:23], v2 offset:2048
    s_waitcnt lgkmcnt(4)
    v_mfma_f32_16x16x32_bf16 v[20:23], a[48:51], a[36:39], v[20:23]
    ds_read_b128 a[24:27], v2 offset:4096
    v_mfma_f32_16x16x32_bf16 v[36:39], a[52:55], a[36:39], v[36:39]
    ds_read_b128 a[28:31], v2 offset:6144
    v_mfma_f32_16x16x32_bf16 v[52:55], a[56:59], a[36:39], v[52:55]
    ds_read_b64_tr_b16 a[4:5], v5 offset:0
    v_mfma_f32_16x16x32_bf16 v[68:71], a[60:63], a[36:39], v[68:71]
    ds_read_b64_tr_b16 a[6:7], v5 offset:1024
    v_mfma_f32_16x16x32_bf16 v[24:27], a[48:51], a[40:43], v[24:27]
    ds_read_b64_tr_b16 a[8:9], v6 offset:0
    v_mfma_f32_16x16x32_bf16 v[40:43], a[52:55], a[40:43], v[40:43]
    ds_read_b64_tr_b16 a[10:11], v6 offset:1024
    v_mfma_f32_16x16x32_bf16 v[56:59], a[56:59], a[40:43], v[56:59]
    ds_read_b64_tr_b16 a[12:13], v7 offset:0
    v_mfma_f32_16x16x32_bf16 v[72:75], a[60:63], a[40:43], v[72:75]
    ds_read_b64_tr_b16 a[14:15], v7 offset:1024
    v_mfma_f32_16x16x32_bf16 a[68:71], a[64:67], a[32:35], a[68:71]
    v_mfma_f32_16x16x32_bf16 v[28:31], a[48:51], a[44:47], v[28:31]
    v_mfma_f32_16x16x32_bf16 v[44:47], a[52:55], a[44:47], v[44:47]
    v_mfma_f32_16x16x32_bf16 v[60:63], a[56:59], a[44:47], v[60:63]
    v_mfma_f32_16x16x32_bf16 v[76:79], a[60:63], a[44:47], v[76:79]
    v_mfma_f32_16x16x32_bf16 a[72:75], a[64:67], a[36:39], a[72:75]
    s_waitcnt lgkmcnt(6)
    v_mfma_f32_16x16x32_bf16 v[16:19], a[16:19], a[0:3], v[16:19]
    ds_read_b64_tr_b16 a[32:33], v4 offset:8192
    v_mfma_f32_16x16x32_bf16 v[32:35], a[20:23], a[0:3], v[32:35]
    ds_read_b64_tr_b16 a[34:35], v4 offset:9216
    v_mfma_f32_16x16x32_bf16 v[48:51], a[24:27], a[0:3], v[48:51]
    ds_read_b128 a[48:51], v3 offset:0
    v_mfma_f32_16x16x32_bf16 v[64:67], a[28:31], a[0:3], v[64:67]
    ds_read_b128 a[52:55], v3 offset:2048
    s_waitcnt lgkmcnt(4)
    v_mfma_f32_16x16x32_bf16 v[20:23], a[16:19], a[4:7], v[20:23]
    ds_read_b128 a[56:59], v3 offset:4096
    v_mfma_f32_16x16x32_bf16 v[36:39], a[20:23], a[4:7], v[36:39]
    ds_read_b128 a[60:63], v3 offset:6144
    v_mfma_f32_16x16x32_bf16 v[52:55], a[24:27], a[4:7], v[52:55]
    ds_read_b64_tr_b16 a[36:37], v5 offset:8192
    v_mfma_f32_16x16x32_bf16 v[68:71], a[28:31], a[4:7], v[68:71]
    ds_read_b64_tr_b16 a[38:39], v5 offset:9216
    v_mfma_f32_16x16x32_bf16 v[24:27], a[16:19], a[8:11], v[24:27]
    ds_read_b64_tr_b16 a[40:41], v6 offset:8192
    v_mfma_f32_16x16x32_bf16 v[40:43], a[20:23], a[8:11], v[40:43]
    ds_read_b64_tr_b16 a[42:43], v6 offset:9216
    v_mfma_f32_16x16x32_bf16 v[56:59], a[24:27], a[8:11], v[56:59]
    ds_read_b64_tr_b16 a[44:45], v7 offset:8192
    v_mfma_f32_16x16x32_bf16 v[72:75], a[28:31], a[8:11], v[72:75]
    ds_read_b64_tr_b16 a[46:47], v7 offset:9216
    v_mfma_f32_16x16x32_bf16 a[68:71], a[64:67], a[0:3], a[68:71]
    v_mfma_f32_16x16x32_bf16 v[28:31], a[16:19], a[12:15], v[28:31]
    v_mfma_f32_16x16x32_bf16 v[44:47], a[20:23], a[12:15], v[44:47]
    v_mfma_f32_16x16x32_bf16 v[60:63], a[24:27], a[12:15], v[60:63]
    v_mfma_f32_16x16x32_bf16 v[76:79], a[28:31], a[12:15], v[76:79]
    v_mfma_f32_16x16x32_bf16 a[72:75], a[64:67], a[4:7], a[72:75]
    s_barrier
    s_waitcnt lgkmcnt(6)
    v_mfma_f32_16x16x32_bf16 v[16:19], a[48:51], a[32:35], v[16:19]
    ds_read_b64_tr_b16 a[0:1], v4 offset:32768
    v_mfma_f32_16x16x32_bf16 v[32:35], a[52:55], a[32:35], v[32:35]
    ds_read_b64_tr_b16 a[2:3], v4 offset:33792
    v_mfma_f32_16x16x32_bf16 v[48:51], a[56:59], a[32:35], v[48:51]
    ds_read_b128 a[16:19], v2 offset:32768
    v_mfma_f32_16x16x32_bf16 v[64:67], a[60:63], a[32:35], v[64:67]
    ds_read_b128 a[20:23], v2 offset:34816
    s_waitcnt lgkmcnt(4)
    v_mfma_f32_16x16x32_bf16 v[20:23], a[48:51], a[36:39], v[20:23]
    ds_read_b128 a[24:27], v2 offset:36864
    v_mfma_f32_16x16x32_bf16 v[36:39], a[52:55], a[36:39], v[36:39]
    ds_read_b128 a[28:31], v2 offset:38912
    v_mfma_f32_16x16x32_bf16 v[52:55], a[56:59], a[36:39], v[52:55]
    ds_read_b64_tr_b16 a[4:5], v5 offset:32768
    v_mfma_f32_16x16x32_bf16 v[68:71], a[60:63], a[36:39], v[68:71]
    ds_read_b64_tr_b16 a[6:7], v5 offset:33792
    v_mfma_f32_16x16x32_bf16 v[24:27], a[48:51], a[40:43], v[24:27]
    ds_read_b64_tr_b16 a[8:9], v6 offset:32768
    v_mfma_f32_16x16x32_bf16 v[40:43], a[52:55], a[40:43], v[40:43]
    ds_read_b64_tr_b16 a[10:11], v6 offset:33792
    v_mfma_f32_16x16x32_bf16 v[56:59], a[56:59], a[40:43], v[56:59]
    ds_read_b64_tr_b16 a[12:13], v7 offset:32768
    v_mfma_f32_16x16x32_bf16 v[72:75], a[60:63], a[40:43], v[72:75]
    ds_read_b64_tr_b16 a[14:15], v7 offset:33792
    v_mfma_f32_16x16x32_bf16 a[68:71], a[64:67], a[32:35], a[68:71]
    v_mfma_f32_16x16x32_bf16 v[28:31], a[48:51], a[44:47], v[28:31]
    v_mfma_f32_16x16x32_bf16 v[44:47], a[52:55], a[44:47], v[44:47]
    v_mfma_f32_16x16x32_bf16 v[60:63], a[56:59], a[44:47], v[60:63]
    v_mfma_f32_16x16x32_bf16 v[76:79], a[60:63], a[44:47], v[76:79]
    v_mfma_f32_16x16x32_bf16 a[72:75], a[64:67], a[36:39], a[72:75]
    s_waitcnt lgkmcnt(6)
    v_mfma_f32_16x16x32_bf16 v[16:19], a[16:19], a[0:3], v[16:19]
    ds_read_b64_tr_b16 a[32:33], v4 offset:40960
    v_mfma_f32_16x16x32_bf16 v[32:35], a[20:23], a[0:3], v[32:35]
    ds_read_b64_tr_b16 a[34:35], v4 offset:41984
    v_mfma_f32_16x16x32_bf16 v[48:51], a[24:27], a[0:3], v[48:51]
    ds_read_b128 a[48:51], v3 offset:32768
    v_mfma_f32_16x16x32_bf16 v[64:67], a[28:31], a[0:3], v[64:67]
    ds_read_b128 a[52:55], v3 offset:34816
    s_waitcnt lgkmcnt(4)
    v_mfma_f32_16x16x32_bf16 v[20:23], a[16:19], a[4:7], v[20:23]
    ds_read_b128 a[56:59], v3 offset:36864
    v_mfma_f32_16x16x32_bf16 v[36:39], a[20:23], a[4:7], v[36:39]
    ds_read_b128 a[60:63], v3 offset:38912
    v_mfma_f32_16x16x32_bf16 v[52:55], a[24:27], a[4:7], v[52:55]
    ds_read_b64_tr_b16 a[36:37], v5 offset:40960
    v_mfma_f32_16x16x32_bf16 v[68:71], a[28:31], a[4:7], v[68:71]
    ds_read_b64_tr_b16 a[38:39], v5 offset:41984
    v_mfma_f32_16x16x32_bf16 v[24:27], a[16:19], a[8:11], v[24:27]
    ds_read_b64_tr_b16 a[40:41], v6 offset:40960
    v_mfma_f32_16x16x32_bf16 v[40:43], a[20:23], a[8:11], v[40:43]
    ds_read_b64_tr_b16 a[42:43], v6 offset:41984
    v_mfma_f32_16x16x32_bf16 v[56:59], a[24:27], a[8:11], v[56:59]
    ds_read_b64_tr_b16 a[44:45], v7 offset:40960
    v_mfma_f32_16x16x32_bf16 v[72:75], a[28:31], a[8:11], v[72:75]
    ds_read_b64_tr_b16 a[46:47], v7 offset:41984
    v_mfma_f32_16x16x32_bf16 a[68:71], a[64:67], a[0:3], a[68:71]
    v_mfma_f32_16x16x32_bf16 v[28:31], a[16:19], a[12:15], v[28:31]
    v_mfma_f32_16x16x32_bf16 v[44:47], a[20:23], a[12:15], v[44:47]
    v_mfma_f32_16x16x32_bf16 v[60:63], a[24:27], a[12:15], v[60:63]
    v_mfma_f32_16x16x32_bf16 v[76:79], a[28:31], a[12:15], v[76:79]
    v_mfma_f32_16x16x32_bf16 a[72:75], a[64:67], a[4:7], a[72:75]
    s_barrier
    v_add_u32 v4, 65536, v4
    v_add_u32 v5, 65536, v5
    v_add_u32 v6, 65536, v6
    v_add_u32 v7, 65536, v7
    v_add_u32 v2, 65536, v2
    v_add_u32 v3, 65536, v3
    s_waitcnt lgkmcnt(6)
    v_mfma_f32_16x16x32_bf16 v[16:19], a[48:51], a[32:35], v[16:19]
    ds_read_b64_tr_b16 a[0:1], v4 offset:0
    v_mfma_f32_16x16x32_bf16 v[32:35], a[52:55], a[32:35], v[32:35]
    ds_read_b64_tr_b16 a[2:3], v4 offset:1024
    v_mfma_f32_16x16x32_bf16 v[48:51], a[56:59], a[32:35], v[48:51]
    ds_read_b128 a[16:19], v2 offset:0
    v_mfma_f32_16x16x32_bf16 v[64:67], a[60:63], a[32:35], v[64:67]
    ds_read_b128 a[20:23], v2 offset:2048
    s_waitcnt lgkmcnt(4)
    v_mfma_f32_16x16x32_bf16 v[20:23], a[48:51], a[36:39], v[20:23]
    ds_read_b128 a[24:27], v2 offset:4096
    v_mfma_f32_16x16x32_bf16 v[36:39], a[52:55], a[36:39], v[36:39]
    ds_read_b128 a[28:31], v2 offset:6144
    v_mfma_f32_16x16x32_bf16 v[52:55], a[56:59], a[36:39], v[52:55]
    ds_read_b64_tr_b16 a[4:5], v5 offset:0
    v_mfma_f32_16x16x32_bf16 v[68:71], a[60:63], a[36:39], v[68:71]
    ds_read_b64_tr_b16 a[6:7], v5 offset:1024
    v_mfma_f32_16x16x32_bf16 v[24:27], a[48:51], a[40:43], v[24:27]
    ds_read_b64_tr_b16 a[8:9], v6 offset:0
    v_mfma_f32_16x16x32_bf16 v[40:43], a[52:55], a[40:43], v[40:43]
    ds_read_b64_tr_b16 a[10:11], v6 offset:1024
    v_mfma_f32_16x16x32_bf16 v[56:59], a[56:59], a[40:43], v[56:59]
    ds_read_b64_tr_b16 a[12:13], v7 offset:0
    v_mfma_f32_16x16x32_bf16 v[72:75], a[60:63], a[40:43], v[72:75]
    ds_read_b64_tr_b16 a[14:15], v7 offset:1024
    v_mfma_f32_16x16x32_bf16 a[68:71], a[64:67], a[32:35], a[68:71]
    v_mfma_f32_16x16x32_bf16 v[28:31], a[48:51], a[44:47], v[28:31]
    v_mfma_f32_16x16x32_bf16 v[44:47], a[52:55], a[44:47], v[44:47]
    v_mfma_f32_16x16x32_bf16 v[60:63], a[56:59], a[44:47], v[60:63]
    v_mfma_f32_16x16x32_bf16 v[76:79], a[60:63], a[44:47], v[76:79]
    v_mfma_f32_16x16x32_bf16 a[72:75], a[64:67], a[36:39], a[72:75]
    s_waitcnt lgkmcnt(6)
    v_mfma_f32_16x16x32_bf16 v[16:19], a[16:19], a[0:3], v[16:19]
    ds_read_b64_tr_b16 a[32:33], v4 offset:8192
    v_mfma_f32_16x16x32_bf16 v[32:35], a[20:23], a[0:3], v[32:35]
    ds_read_b64_tr_b16 a[34:35], v4 offset:9216
    v_mfma_f32_16x16x32_bf16 v[48:51], a[24:27], a[0:3], v[48:51]
    ds_read_b128 a[48:51], v3 offset:0
    v_mfma_f32_16x16x32_bf16 v[64:67], a[28:31], a[0:3], v[64:67]
    ds_read_b128 a[52:55], v3 offset:2048
    s_waitcnt lgkmcnt(4)
    v_mfma_f32_16x16x32_bf16 v[20:23], a[16:19], a[4:7], v[20:23]
    ds_read_b128 a[56:59], v3 offset:4096
    v_mfma_f32_16x16x32_bf16 v[36:39], a[20:23], a[4:7], v[36:39]
    ds_read_b128 a[60:63], v3 offset:6144
    v_mfma_f32_16x16x32_bf16 v[52:55], a[24:27], a[4:7], v[52:55]
    ds_read_b64_tr_b16 a[36:37], v5 offset:8192
    v_mfma_f32_16x16x32_bf16 v[68:71], a[28:31], a[4:7], v[68:71]
    ds_read_b64_tr_b16 a[38:39], v5 offset:9216
    v_mfma_f32_16x16x32_bf16 v[24:27], a[16:19], a[8:11], v[24:27]
    ds_read_b64_tr_b16 a[40:41], v6 offset:8192
    v_mfma_f32_16x16x32_bf16 v[40:43], a[20:23], a[8:11], v[40:43]
    ds_read_b64_tr_b16 a[42:43], v6 offset:9216
    v_mfma_f32_16x16x32_bf16 v[56:59], a[24:27], a[8:11], v[56:59]
    ds_read_b64_tr_b16 a[44:45], v7 offset:8192
    v_mfma_f32_16x16x32_bf16 v[72:75], a[28:31], a[8:11], v[72:75]
    ds_read_b64_tr_b16 a[46:47], v7 offset:9216
    v_mfma_f32_16x16x32_bf16 a[68:71], a[64:67], a[0:3], a[68:71]
    v_mfma_f32_16x16x32_bf16 v[28:31], a[16:19], a[12:15], v[28:31]
    v_mfma_f32_16x16x32_bf16 v[44:47], a[20:23], a[12:15], v[44:47]
    v_mfma_f32_16x16x32_bf16 v[60:63], a[24:27], a[12:15], v[60:63]
    v_mfma_f32_16x16x32_bf16 v[76:79], a[28:31], a[12:15], v[76:79]
    v_mfma_f32_16x16x32_bf16 a[72:75], a[64:67], a[4:7], a[72:75]
    buffer_load_dword v8, v87, s[48:51], s20 offen sc1
    s_barrier
    s_waitcnt lgkmcnt(6)
    v_mfma_f32_16x16x32_bf16 v[16:19], a[48:51], a[32:35], v[16:19]
    ds_read_b64_tr_b16 a[0:1], v4 offset:32768
    v_mfma_f32_16x16x32_bf16 v[32:35], a[52:55], a[32:35], v[32:35]
    ds_read_b64_tr_b16 a[2:3], v4 offset:33792
    v_mfma_f32_16x16x32_bf16 v[48:51], a[56:59], a[32:35], v[48:51]
    ds_read_b128 a[16:19], v2 offset:32768
    v_mfma_f32_16x16x32_bf16 v[64:67], a[60:63], a[32:35], v[64:67]
    ds_read_b128 a[20:23], v2 offset:34816
    s_waitcnt lgkmcnt(4)
    v_mfma_f32_16x16x32_bf16 v[20:23], a[48:51], a[36:39], v[20:23]
    ds_read_b128 a[24:27], v2 offset:36864
    v_mfma_f32_16x16x32_bf16 v[36:39], a[52:55], a[36:39], v[36:39]
    ds_read_b128 a[28:31], v2 offset:38912
    v_mfma_f32_16x16x32_bf16 v[52:55], a[56:59], a[36:39], v[52:55]
    ds_read_b64_tr_b16 a[4:5], v5 offset:32768
    v_mfma_f32_16x16x32_bf16 v[68:71], a[60:63], a[36:39], v[68:71]
    ds_read_b64_tr_b16 a[6:7], v5 offset:33792
    v_mfma_f32_16x16x32_bf16 v[24:27], a[48:51], a[40:43], v[24:27]
    ds_read_b64_tr_b16 a[8:9], v6 offset:32768
    v_mfma_f32_16x16x32_bf16 v[40:43], a[52:55], a[40:43], v[40:43]
    ds_read_b64_tr_b16 a[10:11], v6 offset:33792
    v_mfma_f32_16x16x32_bf16 v[56:59], a[56:59], a[40:43], v[56:59]
    ds_read_b64_tr_b16 a[12:13], v7 offset:32768
    v_mfma_f32_16x16x32_bf16 v[72:75], a[60:63], a[40:43], v[72:75]
    ds_read_b64_tr_b16 a[14:15], v7 offset:33792
    v_mfma_f32_16x16x32_bf16 a[68:71], a[64:67], a[32:35], a[68:71]
    v_mfma_f32_16x16x32_bf16 v[28:31], a[48:51], a[44:47], v[28:31]
    v_mfma_f32_16x16x32_bf16 v[44:47], a[52:55], a[44:47], v[44:47]
    v_mfma_f32_16x16x32_bf16 v[60:63], a[56:59], a[44:47], v[60:63]
    v_mfma_f32_16x16x32_bf16 v[76:79], a[60:63], a[44:47], v[76:79]
    v_mfma_f32_16x16x32_bf16 a[72:75], a[64:67], a[36:39], a[72:75]
    s_waitcnt lgkmcnt(6)
    v_mfma_f32_16x16x32_bf16 v[16:19], a[16:19], a[0:3], v[16:19]
    ds_read_b64_tr_b16 a[32:33], v4 offset:40960
    v_mfma_f32_16x16x32_bf16 v[32:35], a[20:23], a[0:3], v[32:35]
    ds_read_b64_tr_b16 a[34:35], v4 offset:41984
    v_mfma_f32_16x16x32_bf16 v[48:51], a[24:27], a[0:3], v[48:51]
    ds_read_b128 a[48:51], v3 offset:32768
    v_mfma_f32_16x16x32_bf16 v[64:67], a[28:31], a[0:3], v[64:67]
    ds_read_b128 a[52:55], v3 offset:34816
    s_waitcnt lgkmcnt(4)
    v_mfma_f32_16x16x32_bf16 v[20:23], a[16:19], a[4:7], v[20:23]
    ds_read_b128 a[56:59], v3 offset:36864
    v_mfma_f32_16x16x32_bf16 v[36:39], a[20:23], a[4:7], v[36:39]
    ds_read_b128 a[60:63], v3 offset:38912
    v_mfma_f32_16x16x32_bf16 v[52:55], a[24:27], a[4:7], v[52:55]
    ds_read_b64_tr_b16 a[36:37], v5 offset:40960
    v_mfma_f32_16x16x32_bf16 v[68:71], a[28:31], a[4:7], v[68:71]
    ds_read_b64_tr_b16 a[38:39], v5 offset:41984
    v_mfma_f32_16x16x32_bf16 v[24:27], a[16:19], a[8:11], v[24:27]
    ds_read_b64_tr_b16 a[40:41], v6 offset:40960
    v_mfma_f32_16x16x32_bf16 v[40:43], a[20:23], a[8:11], v[40:43]
    ds_read_b64_tr_b16 a[42:43], v6 offset:41984
    v_mfma_f32_16x16x32_bf16 v[56:59], a[24:27], a[8:11], v[56:59]
    ds_read_b64_tr_b16 a[44:45], v7 offset:40960
    v_mfma_f32_16x16x32_bf16 v[72:75], a[28:31], a[8:11], v[72:75]
    ds_read_b64_tr_b16 a[46:47], v7 offset:41984
    v_mfma_f32_16x16x32_bf16 a[68:71], a[64:67], a[0:3], a[68:71]
    v_mfma_f32_16x16x32_bf16 v[28:31], a[16:19], a[12:15], v[28:31]
    v_mfma_f32_16x16x32_bf16 v[44:47], a[20:23], a[12:15], v[44:47]
    v_mfma_f32_16x16x32_bf16 v[60:63], a[24:27], a[12:15], v[60:63]
    v_mfma_f32_16x16x32_bf16 v[76:79], a[28:31], a[12:15], v[76:79]
    v_mfma_f32_16x16x32_bf16 a[72:75], a[64:67], a[4:7], a[72:75]
    s_barrier
    v_add_u32 v4, 65536, v4
    v_add_u32 v5, 65536, v5
    v_add_u32 v6, 65536, v6
    v_add_u32 v7, 65536, v7
    v_add_u32 v2, 65536, v2
    v_add_u32 v3, 65536, v3
    s_waitcnt lgkmcnt(6)
    v_mfma_f32_16x16x32_bf16 v[16:19], a[48:51], a[32:35], v[16:19]
    ds_read_b64_tr_b16 a[0:1], v4 offset:0
    v_mfma_f32_16x16x32_bf16 v[32:35], a[52:55], a[32:35], v[32:35]
    ds_read_b64_tr_b16 a[2:3], v4 offset:1024
    v_mfma_f32_16x16x32_bf16 v[48:51], a[56:59], a[32:35], v[48:51]
    ds_read_b128 a[16:19], v2 offset:0
    v_mfma_f32_16x16x32_bf16 v[64:67], a[60:63], a[32:35], v[64:67]
    ds_read_b128 a[20:23], v2 offset:2048
    s_waitcnt lgkmcnt(4)
    v_mfma_f32_16x16x32_bf16 v[20:23], a[48:51], a[36:39], v[20:23]
    ds_read_b128 a[24:27], v2 offset:4096
    v_mfma_f32_16x16x32_bf16 v[36:39], a[52:55], a[36:39], v[36:39]
    ds_read_b128 a[28:31], v2 offset:6144
    v_mfma_f32_16x16x32_bf16 v[52:55], a[56:59], a[36:39], v[52:55]
    ds_read_b64_tr_b16 a[4:5], v5 offset:0
    v_mfma_f32_16x16x32_bf16 v[68:71], a[60:63], a[36:39], v[68:71]
    ds_read_b64_tr_b16 a[6:7], v5 offset:1024
    v_mfma_f32_16x16x32_bf16 v[24:27], a[48:51], a[40:43], v[24:27]
    ds_read_b64_tr_b16 a[8:9], v6 offset:0
    v_mfma_f32_16x16x32_bf16 v[40:43], a[52:55], a[40:43], v[40:43]
    ds_read_b64_tr_b16 a[10:11], v6 offset:1024
    v_mfma_f32_16x16x32_bf16 v[56:59], a[56:59], a[40:43], v[56:59]
    ds_read_b64_tr_b16 a[12:13], v7 offset:0
    v_mfma_f32_16x16x32_bf16 v[72:75], a[60:63], a[40:43], v[72:75]
    ds_read_b64_tr_b16 a[14:15], v7 offset:1024
    v_mfma_f32_16x16x32_bf16 a[68:71], a[64:67], a[32:35], a[68:71]
    v_mfma_f32_16x16x32_bf16 v[28:31], a[48:51], a[44:47], v[28:31]
    v_mfma_f32_16x16x32_bf16 v[44:47], a[52:55], a[44:47], v[44:47]
    v_mfma_f32_16x16x32_bf16 v[60:63], a[56:59], a[44:47], v[60:63]
    v_mfma_f32_16x16x32_bf16 v[76:79], a[60:63], a[44:47], v[76:79]
    v_mfma_f32_16x16x32_bf16 a[72:75], a[64:67], a[36:39], a[72:75]
    s_mov_b32 s23, 0
L_qp_4:
    s_waitcnt vmcnt(0)
    v_cmp_eq_u32 vcc, 0, v8
    s_add_u32 s23, s23, 1
    s_cmp_lt_u32 s23, 0x40000
    s_cselect_b64 vcc, vcc, 0
    s_cbranch_vccz L_qd_5
    s_sleep 4
    buffer_load_dword v8, v87, s[48:51], s20 offen sc1
    s_branch L_qp_4
L_qd_5:
    buffer_load_dwordx2 v[88:89], v84, s[12:15], s19 offen offset:0 sc1
    buffer_load_dwordx2 v[90:91], v84, s[12:15], s19 offen offset:128 sc1
    buffer_load_dwordx2 v[92:93], v84, s[12:15], s19 offen offset:256 sc1
    buffer_load_dwordx2 v[94:95], v84, s[12:15], s19 offen offset:384 sc1
    buffer_load_dwordx4 v[96:99], v86, s[12:15], s19 offen offset:1024 sc1
    buffer_load_dwordx4 v[100:103], v86, s[12:15], s19 offen offset:1088 sc1
    buffer_load_dwordx4 v[104:107], v86, s[12:15], s19 offen offset:1152 sc1
    buffer_load_dwordx4 v[108:111], v86, s[12:15], s19 offen offset:1216 sc1
    s_waitcnt lgkmcnt(6)
    v_mfma_f32_16x16x32_bf16 v[16:19], a[16:19], a[0:3], v[16:19]
    ds_read_b64_tr_b16 a[32:33], v4 offset:8192
    v_mfma_f32_16x16x32_bf16 v[32:35], a[20:23], a[0:3], v[32:35]
    ds_read_b64_tr_b16 a[34:35], v4 offset:9216
    v_mfma_f32_16x16x32_bf16 v[48:51], a[24:27], a[0:3], v[48:51]
    ds_read_b128 a[48:51], v3 offset:0
    v_mfma_f32_16x16x32_bf16 v[64:67], a[28:31], a[0:3], v[64:67]
    ds_read_b128 a[52:55], v3 offset:2048
    s_waitcnt lgkmcnt(4)
    v_mfma_f32_16x16x32_bf16 v[20:23], a[16:19], a[4:7], v[20:23]
    ds_read_b128 a[56:59], v3 offset:4096
    v_mfma_f32_16x16x32_bf16 v[36:39], a[20:23], a[4:7], v[36:39]
    ds_read_b128 a[60:63], v3 offset:6144
    v_mfma_f32_16x16x32_bf16 v[52:55], a[24:27], a[4:7], v[52:55]
    ds_read_b64_tr_b16 a[36:37], v5 offset:8192
    v_mfma_f32_16x16x32_bf16 v[68:71], a[28:31], a[4:7], v[68:71]
    ds_read_b64_tr_b16 a[38:39], v5 offset:9216
    v_mfma_f32_16x16x32_bf16 v[24:27], a[16:19], a[8:11], v[24:27]
    ds_read_b64_tr_b16 a[40:41], v6 offset:8192
    v_mfma_f32_16x16x32_bf16 v[40:43], a[20:23], a[8:11], v[40:43]
    ds_read_b64_tr_b16 a[42:43], v6 offset:9216
    v_mfma_f32_16x16x32_bf16 v[56:59], a[24:27], a[8:11], v[56:59]
    ds_read_b64_tr_b16 a[44:45], v7 offset:8192
    v_mfma_f32_16x16x32_bf16 v[72:75], a[28:31], a[8:11], v[72:75]
    ds_read_b64_tr_b16 a[46:47], v7 offset:9216
    v_mfma_f32_16x16x32_bf16 a[68:71], a[64:67], a[0:3], a[68:71]
    v_mfma_f32_16x16x32_bf16 v[28:31], a[16:19], a[12:15], v[28:31]
    v_mfma_f32_16x16x32_bf16 v[44:47], a[20:23], a[12:15], v[44:47]
    v_mfma_f32_16x16x32_bf16 v[60:63], a[24:27], a[12:15], v[60:63]
    v_mfma_f32_16x16x32_bf16 v[76:79], a[28:31], a[12:15], v[76:79]
    v_mfma_f32_16x16x32_bf16 a[72:75], a[64:67], a[4:7], a[72:75]
    s_waitcnt lgkmcnt(0)
    v_mfma_f32_16x16x32_bf16 a[68:71], a[64:67], a[32:35], a[68:71]
    v_mfma_f32_16x16x32_bf16 a[72:75], a[64:67], a[36:39], a[72:75]
    v_mfma_f32_16x16x32_bf16 v[16:19], a[48:51], a[32:35], v[16:19]
    s_lshl_b32 s22, s44, 10
    s_lshl_b32 s23, s45, 10
    v_mfma_f32_16x16x32_bf16 v[32:35], a[52:55], a[32:35], v[32:35]
    v_lshlrev_b32 v4, 4, v0
    v_add_u32 v5, s23, v4
    v_mfma_f32_16x16x32_bf16 v[48:51], a[56:59], a[32:35], v[48:51]
    v_add_u32 v4, s22, v4
    s_nop 0
    v_mfma_f32_16x16x32_bf16 v[64:67], a[60:63], a[32:35], v[64:67]
    v_accvgpr_read_b32 v6, a68
    v_cvt_pk_bf16_f32 v7, v6, v6
    v_mfma_f32_16x16x32_bf16 v[20:23], a[48:51], a[36:39], v[20:23]
    v_and_b32 v7, 0xffff0000, v7
    v_sub_f32 v6, v6, v7
    v_mfma_f32_16x16x32_bf16 v[36:39], a[52:55], a[36:39], v[36:39]
    v_cvt_pk_bf16_f32 v8, v7, v6
    v_lshrrev_b32 v9, 16, v7
    v_mfma_f32_16x16x32_bf16 v[52:55], a[56:59], a[36:39], v[52:55]
    v_accvgpr_read_b32 v6, a72
    v_cvt_pk_bf16_f32 v7, v6, v6
    v_mfma_f32_16x16x32_bf16 v[68:71], a[60:63], a[36:39], v[68:71]
    v_and_b32 v7, 0xffff0000, v7
    v_sub_f32 v6, v6, v7
    v_mfma_f32_16x16x32_bf16 v[24:27], a[48:51], a[40:43], v[24:27]
    v_cvt_pk_bf16_f32 v10, v7, v6
    v_lshrrev_b32 v11, 16, v7
    v_mfma_f32_16x16x32_bf16 v[40:43], a[52:55], a[40:43], v[40:43]
    ds_write_b128 v4, v[8:11] offset:32768
    v_mfma_f32_16x16x32_bf16 v[56:59], a[56:59], a[40:43], v[56:59]
    v_mfma_f32_16x16x32_bf16 v[72:75], a[60:63], a[40:43], v[72:75]
    s_waitcnt lgkmcnt(0)
    s_barrier
    ds_read_b128 v[12:15], v5 offset:32768
    v_mfma_f32_16x16x32_bf16 v[28:31], a[48:51], a[44:47], v[28:31]
    v_mfma_f32_16x16x32_bf16 v[44:47], a[52:55], a[44:47], v[44:47]
    v_mfma_f32_16x16x32_bf16 v[60:63], a[56:59], a[44:47], v[60:63]
    v_mfma_f32_16x16x32_bf16 v[76:79], a[60:63], a[44:47], v[76:79]
    s_waitcnt vmcnt(0) lgkmcnt(0)
    v_mfma_f32_16x16x16_bf16 v[16:19], v[88:89], v[8:9], v[16:19]
    v_mfma_f32_16x16x16_bf16 v[32:35], v[90:91], v[8:9], v[32:35]
    v_mfma_f32_16x16x16_bf16 v[48:51], v[92:93], v[8:9], v[48:51]
    v_mfma_f32_16x16x16_bf16 v[64:67], v[94:95], v[8:9], v[64:67]
    v_mfma_f32_16x16x16_bf16 v[20:23], v[88:89], v[10:11], v[20:23]
    v_mfma_f32_16x16x16_bf16 v[36:39], v[90:91], v[10:11], v[36:39]
    v_mfma_f32_16x16x16_bf16 v[52:55], v[92:93], v[10:11], v[52:55]
    s_nop 1
    v_mul_f32 v16, v96, v16
    v_mul_f32 v17, v97, v17
    v_mul_f32 v18, v98, v18
    v_mul_f32 v19, v99, v19
    v_mul_f32 v32, v100, v32
    v_mfma_f32_16x16x16_bf16 v[68:71], v[94:95], v[10:11], v[68:71]
    v_mul_f32 v33, v101, v33
    v_mul_f32 v34, v102, v34
    v_mul_f32 v35, v103, v35
    v_cvt_pk_bf16_f32 v16, v16, v17
    v_cvt_pk_bf16_f32 v17, v18, v19
    v_cvt_pk_bf16_f32 v18, v32, v33
    v_cvt_pk_bf16_f32 v19, v34, v35
    s_nop 0
    v_permlane16_swap_b32 v16, v18
    v_permlane16_swap_b32 v17, v19
    v_mfma_f32_16x16x16_bf16 v[24:27], v[88:89], v[12:13], v[24:27]
    v_mul_f32 v48, v104, v48
    v_mul_f32 v49, v105, v49
    v_mul_f32 v50, v106, v50
    v_mul_f32 v51, v107, v51
    v_mul_f32 v64, v108, v64
    v_mfma_f32_16x16x16_bf16 v[40:43], v[90:91], v[12:13], v[40:43]
    v_mul_f32 v65, v109, v65
    v_mul_f32 v66, v110, v66
    v_mul_f32 v67, v111, v67
    v_cvt_pk_bf16_f32 v48, v48, v49
    v_cvt_pk_bf16_f32 v49, v50, v51
    v_cvt_pk_bf16_f32 v50, v64, v65
    v_cvt_pk_bf16_f32 v51, v66, v67
    buffer_store_dwordx4 v[16:19], v80, s[12:15], s27 offen offset:0 sc1
    v_permlane16_swap_b32 v48, v50
    v_permlane16_swap_b32 v49, v51
    v_mfma_f32_16x16x16_bf16 v[56:59], v[92:93], v[12:13], v[56:59]
    v_mul_f32 v20, v96, v20
    v_mul_f32 v21, v97, v21
    v_mul_f32 v22, v98, v22
    v_mul_f32 v23, v99, v23
    v_mul_f32 v36, v100, v36
    v_mfma_f32_16x16x16_bf16 v[72:75], v[94:95], v[12:13], v[72:75]
    v_mul_f32 v37, v101, v37
    v_mul_f32 v38, v102, v38
    v_mul_f32 v39, v103, v39
    v_cvt_pk_bf16_f32 v20, v20, v21
    v_cvt_pk_bf16_f32 v21, v22, v23
    v_cvt_pk_bf16_f32 v22, v36, v37
    v_cvt_pk_bf16_f32 v23, v38, v39
    buffer_store_dwordx4 v[48:51], v80, s[12:15], s27 offen offset:1280 sc1
    v_permlane16_swap_b32 v20, v22
    v_permlane16_swap_b32 v21, v23
    v_mfma_f32_16x16x16_bf16 v[28:31], v[88:89], v[14:15], v[28:31]
    v_mul_f32 v52, v104, v52
    v_mul_f32 v53, v105, v53
    v_mul_f32 v54, v106, v54
    v_mul_f32 v55, v107, v55
    v_mul_f32 v68, v108, v68
    v_mfma_f32_16x16x16_bf16 v[44:47], v[90:91], v[14:15], v[44:47]
    v_mul_f32 v69, v109, v69
    v_mul_f32 v70, v110, v70
    v_mul_f32 v71, v111, v71
    v_cvt_pk_bf16_f32 v52, v52, v53
    v_cvt_pk_bf16_f32 v53, v54, v55
    v_cvt_pk_bf16_f32 v54, v68, v69
    v_cvt_pk_bf16_f32 v55, v70, v71
    buffer_store_dwordx4 v[20:23], v81, s[12:15], s27 offen offset:0 sc1
    v_permlane16_swap_b32 v52, v54
    v_permlane16_swap_b32 v53, v55
    v_mfma_f32_16x16x16_bf16 v[60:63], v[92:93], v[14:15], v[60:63]
    v_mul_f32 v24, v96, v24
    v_mul_f32 v25, v97, v25
    v_mul_f32 v26, v98, v26
    v_mul_f32 v27, v99, v27
    v_mul_f32 v40, v100, v40
    v_mfma_f32_16x16x16_bf16 v[76:79], v[94:95], v[14:15], v[76:79]
    v_mul_f32 v41, v101, v41
    v_mul_f32 v42, v102, v42
    v_mul_f32 v43, v103, v43
    v_cvt_pk_bf16_f32 v24, v24, v25
    v_cvt_pk_bf16_f32 v25, v26, v27
    v_cvt_pk_bf16_f32 v26, v40, v41
    v_cvt_pk_bf16_f32 v27, v42, v43
    buffer_store_dwordx4 v[52:55], v81, s[12:15], s27 offen offset:1280 sc1
    v_permlane16_swap_b32 v24, v26
    v_permlane16_swap_b32 v25, v27
    v_mul_f32 v56, v104, v56
    v_mul_f32 v57, v105, v57
    v_mul_f32 v58, v106, v58
    v_mul_f32 v59, v107, v59
    v_mul_f32 v72, v108, v72
    v_mul_f32 v73, v109, v73
    v_mul_f32 v74, v110, v74
    v_mul_f32 v75, v111, v75
    v_cvt_pk_bf16_f32 v56, v56, v57
    v_cvt_pk_bf16_f32 v57, v58, v59
    v_cvt_pk_bf16_f32 v58, v72, v73
    v_cvt_pk_bf16_f32 v59, v74, v75
    buffer_store_dwordx4 v[24:27], v82, s[12:15], s27 offen offset:0 sc1
    v_permlane16_swap_b32 v56, v58
    v_permlane16_swap_b32 v57, v59
    v_pk_mul_f32 v[28:29], v[28:29], v[96:97]
    v_pk_mul_f32 v[30:31], v[30:31], v[98:99]
    v_pk_mul_f32 v[44:45], v[44:45], v[100:101]
    v_pk_mul_f32 v[46:47], v[46:47], v[102:103]
    v_cvt_pk_bf16_f32 v28, v28, v29
    v_cvt_pk_bf16_f32 v29, v30, v31
    v_cvt_pk_bf16_f32 v30, v44, v45
    v_cvt_pk_bf16_f32 v31, v46, v47
    buffer_store_dwordx4 v[56:59], v82, s[12:15], s27 offen offset:1280 sc1
    v_permlane16_swap_b32 v28, v30
    v_permlane16_swap_b32 v29, v31
    v_pk_mul_f32 v[60:61], v[60:61], v[104:105]
    v_pk_mul_f32 v[62:63], v[62:63], v[106:107]
    v_pk_mul_f32 v[76:77], v[76:77], v[108:109]
    v_pk_mul_f32 v[78:79], v[78:79], v[110:111]
    v_cvt_pk_bf16_f32 v60, v60, v61
    v_cvt_pk_bf16_f32 v61, v62, v63
    v_cvt_pk_bf16_f32 v62, v76, v77
    v_cvt_pk_bf16_f32 v63, v78, v79
    buffer_store_dwordx4 v[28:31], v83, s[12:15], s27 offen offset:0 sc1
    v_permlane16_swap_b32 v60, v62
    v_permlane16_swap_b32 v61, v63
    buffer_store_dwordx4 v[60:63], v83, s[12:15], s27 offen offset:1280 sc1
L_qkv_fin:
    s_lshl_b32 s94, s18, 11
    s_lshl_b32 s22, s17, 7
    s_add_u32 s94, s94, s22
    s_add_u32 s94, s94, 0x15cc000
    s_branch L_main
L_qkv_helper:
    v_and_b32 v0, 63, v0
    s_and_b32 s17, s2, 3
    s_lshl_b32 s17, s17, 2
    s_bfe_u32 s22, s2, 0x10002
    s_lshl_b32 s22, s22, 1
    s_add_u32 s17, s17, s22
    s_lshr_b32 s22, s2, 3
    s_add_u32 s17, s17, s22
    s_lshl_b32 s19, s17, 3
    s_add_u32 s19, s19, s16
    s_mul_i32 s19, s19, 20480
    s_add_u32 s20, s19, 10240
    v_lshrrev_b32 v2, 3, v0
    v_and_b32 v3, 7, v0
    v_mul_u32_u24 v1, 1280, v2
    v_lshl_add_u32 v1, v3, 4, v1
    s_waitcnt lgkmcnt(0)
    s_and_b32 s5, s5, 0xffff
    s_mov_b32 s6, 0x280000
    s_mov_b32 s7, 0x20000
    buffer_load_dwordx4 v[16:19], v1, s[4:7], s19 offen offset:0
    buffer_load_dwordx4 v[20:23], v1, s[4:7], s19 offen offset:128
    buffer_load_dwordx4 v[24:27], v1, s[4:7], s19 offen offset:256
    buffer_load_dwordx4 v[28:31], v1, s[4:7], s19 offen offset:384
    buffer_load_dwordx4 v[32:35], v1, s[4:7], s19 offen offset:512
    buffer_load_dwordx4 v[36:39], v1, s[4:7], s19 offen offset:640
    buffer_load_dwordx4 v[40:43], v1, s[4:7], s19 offen offset:768
    buffer_load_dwordx4 v[44:47], v1, s[4:7], s19 offen offset:896
    buffer_load_dwordx4 v[48:51], v1, s[4:7], s19 offen offset:1024
    buffer_load_dwordx4 v[52:55], v1, s[4:7], s19 offen offset:1152
    buffer_load_dwordx4 v[56:59], v1, s[4:7], s20 offen offset:0
    buffer_load_dwordx4 v[60:63], v1, s[4:7], s20 offen offset:128
    buffer_load_dwordx4 v[64:67], v1, s[4:7], s20 offen offset:256
    buffer_load_dwordx4 v[68:71], v1, s[4:7], s20 offen offset:384
    buffer_load_dwordx4 v[72:75], v1, s[4:7], s20 offen offset:512
    buffer_load_dwordx4 v[76:79], v1, s[4:7], s20 offen offset:640
    buffer_load_dwordx4 v[80:83], v1, s[4:7], s20 offen offset:768
    buffer_load_dwordx4 v[84:87], v1, s[4:7], s20 offen offset:896
    buffer_load_dwordx4 v[88:91], v1, s[4:7], s20 offen offset:1024
    buffer_load_dwordx4 v[92:95], v1, s[4:7], s20 offen offset:1152
    s_mov_b32 s12, s50
    s_and_b32 s13, s51, 0xffff
    s_mov_b32 s14, 0x2000000
    s_mov_b32 s15, 0x20000
    s_and_b32 s49, s49, 0xffff
    s_mov_b32 s50, 0x100
    s_mov_b32 s51, 0x20000
    v_mov_b32 v4, 0x3f803f80
    s_lshl_b32 s22, s16, 4
    v_add_u32 v2, s22, v2
    v_lshlrev_b32 v5, 3, v2
    v_lshlrev_b32 v6, 2, v2
    s_lshl_b32 s27, s17, 11
    s_add_u32 s27, s27, 0x15e0000
    s_mov_b32 s23, 0x01010101
    s_waitcnt vmcnt(19)
    v_dot2_f32_bf16 v8, v16, v4, 0
    v_dot2_f32_bf16 v9, v16, v16, 0
    v_dot2_f32_bf16 v8, v17, v4, v8
    v_dot2_f32_bf16 v9, v17, v17, v9
    v_dot2_f32_bf16 v8, v18, v4, v8
    v_dot2_f32_bf16 v9, v18, v18, v9
    v_dot2_f32_bf16 v8, v19, v4, v8
    v_dot2_f32_bf16 v9, v19, v19, v9
    s_waitcnt vmcnt(18)
    v_dot2_f32_bf16 v8, v20, v4, v8
    v_dot2_f32_bf16 v9, v20, v20, v9
    v_dot2_f32_bf16 v8, v21, v4, v8
    v_dot2_f32_bf16 v9, v21, v21, v9
    v_dot2_f32_bf16 v8, v22, v4, v8
    v_dot2_f32_bf16 v9, v22, v22, v9
    v_dot2_f32_bf16 v8, v23, v4, v8
    v_dot2_f32_bf16 v9, v23, v23, v9
    s_waitcnt vmcnt(17)
    v_dot2_f32_bf16 v8, v24, v4, v8
    v_dot2_f32_bf16 v9, v24, v24, v9
    v_dot2_f32_bf16 v8, v25, v4, v8
    v_dot2_f32_bf16 v9, v25, v25, v9
    v_dot2_f32_bf16 v8, v26, v4, v8
    v_dot2_f32_bf16 v9, v26, v26, v9
    v_dot2_f32_bf16 v8, v27, v4, v8
    v_dot2_f32_bf16 v9, v27, v27, v9
    s_waitcnt vmcnt(16)
    v_dot2_f32_bf16 v8, v28, v4, v8
    v_dot2_f32_bf16 v9, v28, v28, v9
    v_dot2_f32_bf16 v8, v29, v4, v8
    v_dot2_f32_bf16 v9, v29, v29, v9
    v_dot2_f32_bf16 v8, v30, v4, v8
    v_dot2_f32_bf16 v9, v30, v30, v9
    v_dot2_f32_bf16 v8, v31, v4, v8
    v_dot2_f32_bf16 v9, v31, v31, v9
    s_waitcnt vmcnt(15)
    v_dot2_f32_bf16 v8, v32, v4, v8
    v_dot2_f32_bf16 v9, v32, v32, v9
    v_dot2_f32_bf16 v8, v33, v4, v8
    v_dot2_f32_bf16 v9, v33, v33, v9
    v_dot2_f32_bf16 v8, v34, v4, v8
    v_dot2_f32_bf16 v9, v34, v34, v9
    v_dot2_f32_bf16 v8, v35, v4, v8
    v_dot2_f32_bf16 v9, v35, v35, v9
    s_waitcnt vmcnt(14)
    v_dot2_f32_bf16 v8, v36, v4, v8
    v_dot2_f32_bf16 v9, v36, v36, v9
    v_dot2_f32_bf16 v8, v37, v4, v8
    v_dot2_f32_bf16 v9, v37, v37, v9
    v_dot2_f32_bf16 v8, v38, v4, v8
    v_dot2_f32_bf16 v9, v38, v38, v9
    v_dot2_f32_bf16 v8, v39, v4, v8
    v_dot2_f32_bf16 v9, v39, v39, v9
    s_waitcnt vmcnt(13)
    v_dot2_f32_bf16 v8, v40, v4, v8
    v_dot2_f32_bf16 v9, v40, v40, v9
    v_dot2_f32_bf16 v8, v41, v4, v8
    v_dot2_f32_bf16 v9, v41, v41, v9
    v_dot2_f32_bf16 v8, v42, v4, v8
    v_dot2_f32_bf16 v9, v42, v42, v9
    v_dot2_f32_bf16 v8, v43, v4, v8
    v_dot2_f32_bf16 v9, v43, v43, v9
    s_waitcnt vmcnt(12)
    v_dot2_f32_bf16 v8, v44, v4, v8
    v_dot2_f32_bf16 v9, v44, v44, v9
    v_dot2_f32_bf16 v8, v45, v4, v8
    v_dot2_f32_bf16 v9, v45, v45, v9
    v_dot2_f32_bf16 v8, v46, v4, v8
    v_dot2_f32_bf16 v9, v46, v46, v9
    v_dot2_f32_bf16 v8, v47, v4, v8
    v_dot2_f32_bf16 v9, v47, v47, v9
    s_waitcnt vmcnt(11)
    v_dot2_f32_bf16 v8, v48, v4, v8
    v_dot2_f32_bf16 v9, v48, v48, v9
    v_dot2_f32_bf16 v8, v49, v4, v8
    v_dot2_f32_bf16 v9, v49, v49, v9
    v_dot2_f32_bf16 v8, v50, v4, v8
    v_dot2_f32_bf16 v9, v50, v50, v9
    v_dot2_f32_bf16 v8, v51, v4, v8
    v_dot2_f32_bf16 v9, v51, v51, v9
    s_waitcnt vmcnt(10)
    v_dot2_f32_bf16 v8, v52, v4, v8
    v_dot2_f32_bf16 v9, v52, v52, v9
    v_dot2_f32_bf16 v8, v53, v4, v8
    v_dot2_f32_bf16 v9, v53, v53, v9
    v_dot2_f32_bf16 v8, v54, v4, v8
    v_dot2_f32_bf16 v9, v54, v54, v9
    v_dot2_f32_bf16 v8, v55, v4, v8
    v_dot2_f32_bf16 v9, v55, v55, v9
    s_nop 1
    v_add_f32_dpp v8, v8, v8 quad_perm:[1,0,3,2] row_mask:0xf bank_mask:0xf
    v_add_f32_dpp v9, v9, v9 quad_perm:[1,0,3,2] row_mask:0xf bank_mask:0xf
    s_nop 0
    v_add_f32_dpp v8, v8, v8 quad_perm:[2,3,0,1] row_mask:0xf bank_mask:0xf
    v_add_f32_dpp v9, v9, v9 quad_perm:[2,3,0,1] row_mask:0xf bank_mask:0xf
    s_nop 0
    v_add_f32_dpp v8, v8, v8 row_half_mirror row_mask:0xf bank_mask:0xf
    v_add_f32_dpp v9, v9, v9 row_half_mirror row_mask:0xf bank_mask:0xf
    v_mul_f32 v8, 0x3acccccd, v8
    v_mul_f32 v9, 0x3acccccd, v9
    v_fma_f32 v9, -v8, v8, v9
    v_max_f32 v9, 0, v9
    v_add_f32 v9, 0x3727c5ac, v9
    v_rsq_f32 v12, v9
    v_cvt_pk_bf16_f32 v10, -v8, -v8
    v_and_b32 v11, 0xffff0000, v10
    v_sub_f32 v11, -v8, v11
    v_cvt_pk_bf16_f32 v11, v11, 0
    s_mov_b32 exec_lo, s23
    s_mov_b32 exec_hi, s23
    buffer_store_dwordx2 v[10:11], v5, s[12:15], s27 offen offset:0 sc1
    buffer_store_dword v12, v6, s[12:15], s27 offen offset:1024 sc1
    s_mov_b64 exec, -1
    s_waitcnt vmcnt(11)
    v_dot2_f32_bf16 v8, v56, v4, 0
    v_dot2_f32_bf16 v9, v56, v56, 0
    v_dot2_f32_bf16 v8, v57, v4, v8
    v_dot2_f32_bf16 v9, v57, v57, v9
    v_dot2_f32_bf16 v8, v58, v4, v8
    v_dot2_f32_bf16 v9, v58, v58, v9
    v_dot2_f32_bf16 v8, v59, v4, v8
    v_dot2_f32_bf16 v9, v59, v59, v9
    s_waitcnt vmcnt(10)
    v_dot2_f32_bf16 v8, v60, v4, v8
    v_dot2_f32_bf16 v9, v60, v60, v9
    v_dot2_f32_bf16 v8, v61, v4, v8
    v_dot2_f32_bf16 v9, v61, v61, v9
    v_dot2_f32_bf16 v8, v62, v4, v8
    v_dot2_f32_bf16 v9, v62, v62, v9
    v_dot2_f32_bf16 v8, v63, v4, v8
    v_dot2_f32_bf16 v9, v63, v63, v9
    s_waitcnt vmcnt(9)
    v_dot2_f32_bf16 v8, v64, v4, v8
    v_dot2_f32_bf16 v9, v64, v64, v9
    v_dot2_f32_bf16 v8, v65, v4, v8
    v_dot2_f32_bf16 v9, v65, v65, v9
    v_dot2_f32_bf16 v8, v66, v4, v8
    v_dot2_f32_bf16 v9, v66, v66, v9
    v_dot2_f32_bf16 v8, v67, v4, v8
    v_dot2_f32_bf16 v9, v67, v67, v9
    s_waitcnt vmcnt(8)
    v_dot2_f32_bf16 v8, v68, v4, v8
    v_dot2_f32_bf16 v9, v68, v68, v9
    v_dot2_f32_bf16 v8, v69, v4, v8
    v_dot2_f32_bf16 v9, v69, v69, v9
    v_dot2_f32_bf16 v8, v70, v4, v8
    v_dot2_f32_bf16 v9, v70, v70, v9
    v_dot2_f32_bf16 v8, v71, v4, v8
    v_dot2_f32_bf16 v9, v71, v71, v9
    s_waitcnt vmcnt(7)
    v_dot2_f32_bf16 v8, v72, v4, v8
    v_dot2_f32_bf16 v9, v72, v72, v9
    v_dot2_f32_bf16 v8, v73, v4, v8
    v_dot2_f32_bf16 v9, v73, v73, v9
    v_dot2_f32_bf16 v8, v74, v4, v8
    v_dot2_f32_bf16 v9, v74, v74, v9
    v_dot2_f32_bf16 v8, v75, v4, v8
    v_dot2_f32_bf16 v9, v75, v75, v9
    s_waitcnt vmcnt(6)
    v_dot2_f32_bf16 v8, v76, v4, v8
    v_dot2_f32_bf16 v9, v76, v76, v9
    v_dot2_f32_bf16 v8, v77, v4, v8
    v_dot2_f32_bf16 v9, v77, v77, v9
    v_dot2_f32_bf16 v8, v78, v4, v8
    v_dot2_f32_bf16 v9, v78, v78, v9
    v_dot2_f32_bf16 v8, v79, v4, v8
    v_dot2_f32_bf16 v9, v79, v79, v9
    s_waitcnt vmcnt(5)
    v_dot2_f32_bf16 v8, v80, v4, v8
    v_dot2_f32_bf16 v9, v80, v80, v9
    v_dot2_f32_bf16 v8, v81, v4, v8
    v_dot2_f32_bf16 v9, v81, v81, v9
    v_dot2_f32_bf16 v8, v82, v4, v8
    v_dot2_f32_bf16 v9, v82, v82, v9
    v_dot2_f32_bf16 v8, v83, v4, v8
    v_dot2_f32_bf16 v9, v83, v83, v9
    s_waitcnt vmcnt(4)
    v_dot2_f32_bf16 v8, v84, v4, v8
    v_dot2_f32_bf16 v9, v84, v84, v9
    v_dot2_f32_bf16 v8, v85, v4, v8
    v_dot2_f32_bf16 v9, v85, v85, v9
    v_dot2_f32_bf16 v8, v86, v4, v8
    v_dot2_f32_bf16 v9, v86, v86, v9
    v_dot2_f32_bf16 v8, v87, v4, v8
    v_dot2_f32_bf16 v9, v87, v87, v9
    s_waitcnt vmcnt(3)
    v_dot2_f32_bf16 v8, v88, v4, v8
    v_dot2_f32_bf16 v9, v88, v88, v9
    v_dot2_f32_bf16 v8, v89, v4, v8
    v_dot2_f32_bf16 v9, v89, v89, v9
    v_dot2_f32_bf16 v8, v90, v4, v8
    v_dot2_f32_bf16 v9, v90, v90, v9
    v_dot2_f32_bf16 v8, v91, v4, v8
    v_dot2_f32_bf16 v9, v91, v91, v9
    s_waitcnt vmcnt(2)
    v_dot2_f32_bf16 v8, v92, v4, v8
    v_dot2_f32_bf16 v9, v92, v92, v9
    v_dot2_f32_bf16 v8, v93, v4, v8
    v_dot2_f32_bf16 v9, v93, v93, v9
    v_dot2_f32_bf16 v8, v94, v4, v8
    v_dot2_f32_bf16 v9, v94, v94, v9
    v_dot2_f32_bf16 v8, v95, v4, v8
    v_dot2_f32_bf16 v9, v95, v95, v9
    s_nop 1
    v_add_f32_dpp v8, v8, v8 quad_perm:[1,0,3,2] row_mask:0xf bank_mask:0xf
    v_add_f32_dpp v9, v9, v9 quad_perm:[1,0,3,2] row_mask:0xf bank_mask:0xf
    s_nop 0
    v_add_f32_dpp v8, v8, v8 quad_perm:[2,3,0,1] row_mask:0xf bank_mask:0xf
    v_add_f32_dpp v9, v9, v9 quad_perm:[2,3,0,1] row_mask:0xf bank_mask:0xf
    s_nop 0
    v_add_f32_dpp v8, v8, v8 row_half_mirror row_mask:0xf bank_mask:0xf
    v_add_f32_dpp v9, v9, v9 row_half_mirror row_mask:0xf bank_mask:0xf
    v_mul_f32 v8, 0x3acccccd, v8
    v_mul_f32 v9, 0x3acccccd, v9
    v_fma_f32 v9, -v8, v8, v9
    v_max_f32 v9, 0, v9
    v_add_f32 v9, 0x3727c5ac, v9
    v_rsq_f32 v12, v9
    v_cvt_pk_bf16_f32 v10, -v8, -v8
    v_and_b32 v11, 0xffff0000, v10
    v_sub_f32 v11, -v8, v11
    v_cvt_pk_bf16_f32 v11, v11, 0
    s_mov_b32 exec_lo, s23
    s_mov_b32 exec_hi, s23
    buffer_store_dwordx2 v[10:11], v5, s[12:15], s27 offen offset:64 sc1
    buffer_store_dword v12, v6, s[12:15], s27 offen offset:1056 sc1
    s_mov_b64 exec, -1
    s_lshl_b32 s22, s16, 10
    s_lshl_b32 s24, s2, 13
    s_add_u32 s22, s22, s24
    s_add_u32 s22, s22, 0x15c0000
    s_cmp_lt_u32 s2, 10
    s_cselect_b32 s22, s22, 0x2000000
    v_mov_b32 v16, 0
    v_mov_b32 v17, 0
    v_mov_b32 v18, 0
    v_mov_b32 v19, 0
    v_lshlrev_b32 v1, 4, v0
    buffer_store_dwordx4 v[16:19], v1, s[12:15], s22 offen sc1
    s_waitcnt vmcnt(0)
    s_barrier
    s_lshl_b32 s22, s17, 4
    s_cmp_eq_u32 s16, 0
    s_cselect_b32 s22, s22, 256
    v_mov_b32 v2, 1
    v_mov_b32 v3, 0
    s_mov_b64 exec, 1
    buffer_store_dword v2, v3, s[48:51], s22 offen sc1
    s_mov_b64 exec, -1
    s_load_dwordx4 s[40:43], s[0:1], 32
    s_load_dwordx2 s[52:53], s[0:1], 56
    v_lshlrev_b32 v1, 18, v0
    s_cmp_lg_u32 s16, 0
    s_cbranch_scc1 L_qkv_notlb
    s_waitcnt lgkmcnt(0)
    s_mov_b32 s36, s40
    s_and_b32 s37, s41, 0xffff
    s_mov_b32 s38, 0x1e0000
    s_mov_b32 s39, 0x20000
    buffer_load_dword v4, v1, s[36:39], 0 offen
    s_mov_b32 s36, s42
    s_and_b32 s37, s43, 0xffff
    s_mov_b32 s38, 0x1e0000
    s_mov_b32 s39, 0x20000
    buffer_load_dword v4, v1, s[36:39], 0 offen
    s_mov_b32 s36, s52
    s_and_b32 s37, s53, 0xffff
    s_mov_b32 s38, 0x280000
    s_mov_b32 s39, 0x20000
    buffer_load_dword v4, v1, s[36:39], 0 offen
    s_mov_b32 s36, s32
    s_and_b32 s37, s33, 0xffff
    s_mov_b32 s38, 0xc8000
    s_mov_b32 s39, 0x20000
    buffer_load_dword v4, v1, s[36:39], 0 offen
    s_mov_b32 s36, s34
    s_and_b32 s37, s35, 0xffff
    s_mov_b32 s38, 0x1e0000
    s_mov_b32 s39, 0x20000
    buffer_load_dword v4, v1, s[36:39], 0 offen
L_qkv_notlb:
    s_waitcnt lgkmcnt(0)
    s_cmp_lg_u32 s16, 0
    s_cbranch_scc1 L_h_join
    v_and_b32 v1, 15, v0
    v_lshlrev_b32 v1, 4, v1
    s_mov_b32 s23, 0
L_h_poll:
    s_sleep 8
    buffer_load_dword v2, v1, s[48:51], 0 offen sc1
    s_add_u32 s23, s23, 1
    s_waitcnt vmcnt(0)
    v_cmp_eq_u32 vcc, 0, v2
    s_cmp_lt_u32 s23, 0x40000
    s_cselect_b64 vcc, vcc, 0
    s_cbranch_vccnz L_h_poll
L_h_join:
    s_mov_b32 s94, 0x2000000
    s_branch L_main
L_qkv_end:
    s_endpgm
L_main:
    s_load_dwordx2 s[8:9], s[0:1], 72
    s_load_dwordx2 s[4:5], s[0:1], 0
    s_load_dwordx2 s[12:13], s[0:1], 32
    s_load_dwordx2 s[16:17], s[0:1], 40
    s_load_dwordx2 s[20:21], s[0:1], 16
    s_load_dwordx2 s[92:93], s[0:1], 48
    s_mov_b32 s24, s3
    s_and_b32 s25, s2, 7
    s_lshr_b32 s26, s2, 3
    s_lshl_b32 s97, s25, 2
    s_lshr_b32 s27, s26, 3
    s_add_u32 s97, s97, s27
    s_and_b32 s100, s26, 7
    s_lshr_b32 s27, s97, 1
    s_mul_i32 s38, s27, 163840
    s_mul_i32 s39, s97, 81920
    s_add_u32 s39, s39, 0x500000
    s_lshl_b32 s33, s100, 3
    s_add_u32 s33, s33, s24
    s_and_b32 s28, s97, 1
    v_lshlrev_b32 v4, 4, v0
    s_mul_i32 s29, s28, 1536
    v_add_u32 v6, s29, v4
    v_and_b32 v8, 31, v0
    v_lshrrev_b32 v9, 5, v0
    v_lshlrev_b32 v5, 4, v8
    v_lshl_add_u32 v5, v9, 2, v5
    s_lshl_b32 s28, s28, 3
    s_add_u32 s28, s28, 1024
    v_add_u32 v5, s28, v5
    s_mul_i32 s36, s24, 2560
    s_add_u32 s36, s36, s38
    s_mul_i32 s37, s24, 1280
    s_mul_i32 s32, s24, 2560
    v_lshlrev_b32 v7, 2, v0
    s_add_u32 s37, s37, s39
    s_add_u32 s98, s36, 163840
    s_mul_i32 s27, s100, 0
    s_add_u32 s37, s37, s27
    s_lshl_b32 s27, s27, 1
    s_add_u32 s36, s36, s27
    s_add_u32 s96, s38, s27
    s_waitcnt lgkmcnt(0)
    s_and_b32 s9, s9, 0xffff
    s_mov_b32 s10, 0x2000000
    s_mov_b32 s11, 0x20000
    s_lshl_b32 s48, s25, 10
    s_add_u32 s48, s48, 0x15c0000
    s_getreg_b32 s50, hwreg(HW_REG_XCC_ID, 0, 3)
    s_mul_i32 s50, s50, 6
    s_lshr_b32 s40, s26, 2
    s_and_b32 s27, s26, 3
    s_lshl_b32 s41, s25, 4
    s_lshl_b32 s27, s27, 2
    s_add_u32 s41, s41, s27
    s_lshl_b32 s42, s40, 1
    s_and_b32 s27, s26, 1
    s_add_u32 s42, s42, s27
    s_and_b32 s51, s24, 3
    s_mul_i32 s44, s40, 102400
    s_and_b32 s95, s51, 1
    s_lshl_b32 s95, s95, 1
    s_lshr_b32 s27, s24, 2
    s_add_u32 s95, s95, s27
    s_and_b32 s27, s40, 1
    s_lshl_b32 s27, s27, 1
    s_xor_b32 s95, s95, s27
    s_mul_i32 s27, s95, 25600
    s_add_u32 s44, s44, s27
    s_add_u32 s44, s44, 0x1280000
    s_mul_i32 s45, s40, 245760
    s_and_b32 s27, s40, 3
    s_xor_b32 s27, s27, s51
    s_mul_i32 s27, s27, 12
    s_and_b32 s28, s24, 4
    s_add_u32 s87, s27, s28
    s_mul_i32 s27, s87, 5120
    s_add_u32 s45, s45, s27
    s_add_u32 s45, s45, 0x1380000
    s_mul_i32 s46, s51, 49152
    s_mul_i32 s27, s42, 192
    s_add_u32 s46, s46, s27
    s_mul_i32 s47, s51, 3072
    s_mov_b32 s91, 0
    s_add_u32 s99, s46, 1966080
    s_mul_i32 s27, s91, 196608
    s_add_u32 s46, s46, s27
    s_and_b32 s5, s5, 0xffff
    s_mov_b32 s6, 0x280000
    s_mov_b32 s7, 0x20000
    s_and_b32 s13, s13, 0xffff
    s_mov_b32 s14, 0x1e0000
    s_mov_b32 s15, 0x20000
    s_and_b32 s17, s17, 0xffff
    s_mov_b32 s18, 0x1e0000
    s_mov_b32 s19, 0x20000
    s_waitcnt vmcnt(0)
    s_barrier
    s_cmp_eq_u32 s24, 0
    s_cselect_b32 s94, s94, 0x2000000
    s_mov_b64 exec, 1
    buffer_store_dword v5, v4, s[8:11], s94 offen sc1
    s_mov_b64 exec, -1
    v_add_u32 v1, 102400, v4
    v_add_u32 v2, 103424, v7
    v_lshrrev_b32 v10, 3, v8
    v_bfe_u32 v11, v8, 2, 1
    v_and_b32 v12, 3, v8
    v_lshl_add_u32 v13, v10, 2, v12
    v_lshl_add_u32 v14, v11, 3, v13
    v_lshl_add_u32 v15, v11, 1, v13
    v_add_u32 v15, 8, v15
    v_cmp_gt_u32 vcc, 8, v13
    s_nop 1
    v_cndmask_b32 v14, v15, v14, vcc
    v_min_u32 v14, 19, v14
    v_mul_u32_u24 v3, 320, v9
    v_lshl_add_u32 v3, v14, 4, v3
    v_add_u32 v3, 103680, v3
    v_cmp_eq_u32 vcc, 10, v13
    v_mov_b32 v15, 0x3f803f80
    s_nop 0
    v_cndmask_b32 v80, 0, v15, vcc
    v_cndmask_b32 v81, 0, v15, vcc
    v_cndmask_b32 v82, 0, v15, vcc
    v_cndmask_b32 v83, 0, v15, vcc
    v_cndmask_b32 v84, 0, v15, vcc
    v_cndmask_b32 v85, 0, v15, vcc
    v_cndmask_b32 v86, 0, v15, vcc
    v_cndmask_b32 v87, 0, v15, vcc
    v_cmp_gt_u32 vcc, 32, v0
    v_mov_b32 v14, 0x3f80
    s_nop 0
    v_cndmask_b32 v77, v14, v15, vcc
    v_mov_b32 v93, 0
    v_add_u32 v8, 0, v0
    v_mul_u32_u24 v9, 5462, v8
    v_lshrrev_b32 v9, 16, v9
    v_mul_u32_u24 v96, 2880, v9
    v_lshl_add_u32 v96, v8, 4, v96
    v_and_b32 v9, 8, v9
    v_lshlrev_b32 v9, 2, v9
    v_xor_b32 v96, v96, v9
    v_add_u32 v8, 64, v0
    v_mul_u32_u24 v9, 5462, v8
    v_lshrrev_b32 v9, 16, v9
    v_mul_u32_u24 v97, 2880, v9
    v_lshl_add_u32 v97, v8, 4, v97
    v_and_b32 v9, 8, v9
    v_lshlrev_b32 v9, 2, v9
    v_xor_b32 v97, v97, v9
    v_add_u32 v8, 128, v0
    v_mul_u32_u24 v9, 5462, v8
    v_lshrrev_b32 v9, 16, v9
    v_mul_u32_u24 v98, 2880, v9
    v_lshl_add_u32 v98, v8, 4, v98
    v_and_b32 v9, 8, v9
    v_lshlrev_b32 v9, 2, v9
    v_xor_b32 v98, v98, v9
    s_mov_b32 s34, 0x0033ffff
    s_mov_b32 s35, 0x0033ffff
    v_and_b32 v32, 15, v0
    v_lshrrev_b32 v33, 4, v0
    v_mul_u32_u24 v32, 1280, v32
    s_add_u32 s27, s51, s41
    s_mul_i32 s27, s27, 20480
    s_mul_i32 s28, s40, 160
    s_add_u32 s27, s27, s28
    v_add_u32 v32, s27, v32
    v_lshl_add_u32 v106, v33, 4, v32
    v_lshl_add_u32 v107, v33, 3, v32
    v_add_u32 v107, 128, v107
    s_and_b32 s27, s24, 4
    s_lshl_b32 s27, s27, 4
    v_add_u32 v106, s27, v106
    v_lshlrev_b32 v94, 7, v0
    v_mov_b32 v95, 0
    s_lshl_b64 s[52:53], 1, s50
    v_mov_b32 v108, s52
    v_mov_b32 v109, s53
    s_cmp_ge_u32 s24, 4
    s_cselect_b32 s52, s16, s12
    s_cselect_b32 s53, s17, s13
    s_mov_b32 s54, 0x1e0000
    s_mov_b32 s55, 0x20000
    s_cselect_b32 s49, 12320, 0
    s_add_u32 s49, s49, s47
    s_and_b32 s30, s26, 3
    s_lshl_b32 s31, s26, 2
    s_add_u32 s31, s31, s51
    s_mul_i32 s31, s31, 1536
    s_lshl_b32 s90, s25, 5
    s_add_u32 s90, s90, s26
    s_lshl_b32 s90, s90, 3
    s_add_u32 s90, s90, s24
    s_getpc_b64 s[88:89]
L_pc_6:
    s_add_u32 s88, s88, L_attn_code-L_pc_6
    s_addc_u32 s89, s89, 0
    s_and_b32 s27, s90, 255
    s_lshl_b32 s27, s27, 7
    v_lshlrev_b32 v32, 15, v0
    v_add_u32 v32, s27, v32
    v_min_u32 v99, L_code_end-L_attn_code-4, v32
    s_mul_i32 s27, s33, 40960
    s_lshr_b32 s28, s97, 3
    s_mul_i32 s28, s28, 5120
    s_add_u32 s27, s27, s28
    s_add_u32 s27, s27, 0x780000
    s_lshl_b32 s100, s100, 12
    s_lshl_b32 s29, s97, 7
    s_add_u32 s100, s100, s29
    s_add_u32 s100, s100, 0x15c2000
    s_and_b32 s29, s97, 7
    s_lshl_b32 s28, s29, 9
    s_add_u32 s28, s28, s27
    s_lshl_b32 s29, s29, 7
    s_add_u32 s27, s27, s29
    s_add_u32 s27, s27, 4096
    v_and_b32 v32, 15, v0
    v_bfe_u32 v33, v0, 4, 1
    v_lshrrev_b32 v34, 5, v0
    v_mul_u32_u24 v33, 20480, v33
    v_lshl_add_u32 v15, v32, 3, v33
    v_add_u32 v15, s27, v15
    v_lshl_add_u32 v14, v32, 4, v33
    v_lshl_add_u32 v14, v34, 8, v14
    v_add_u32 v14, s28, v14
    v_mov_b32 v79, 0xdddddddd
    v_mov_b32 v48, 0
    v_mov_b32 v49, 0
    v_mov_b32 v50, 0
    v_mov_b32 v51, 0
    v_mov_b32 v52, 0
    v_mov_b32 v53, 0
    v_mov_b32 v54, 0
    v_mov_b32 v55, 0
    v_mov_b32 v56, 0
    v_mov_b32 v57, 0
    v_mov_b32 v58, 0
    v_mov_b32 v59, 0
    v_mov_b32 v60, 0
    v_mov_b32 v61, 0
    v_mov_b32 v62, 0
    v_mov_b32 v63, 0
    s_lshl_b32 s86, s24, 8
    s_add_u32 s86, s86, s2
    s_mul_i32 s3, s24, 5120
    s_cmp_lt_u32 s86, 544
    s_cbranch_scc1 L_pp_real
    s_and_b32 s21, s21, 0xffff
    s_mov_b32 s22, 0x0
    s_mov_b32 s23, 0x20000
    s_mov_b32 s98, 0
    s_mov_b32 s101, 0x2000000
    v_mov_b32 v100, 0
    v_mov_b32 v101, 0
    v_mov_b32 v102, 0
    v_mov_b32 v103, 0
    v_mov_b32 v104, 0
    s_branch L_pp_ta
L_pp_real:
    v_add_u32 v32, 0, v0
    v_mul_u32_u24 v36, 6554, v32
    v_lshrrev_b32 v36, 16, v36
    v_mul_u32_u24 v33, 10, v36
    v_sub_u32 v32, v32, v33
    v_lshlrev_b32 v100, 4, v32
    v_add_u32 v32, 64, v0
    v_mul_u32_u24 v37, 6554, v32
    v_lshrrev_b32 v37, 16, v37
    v_mul_u32_u24 v33, 10, v37
    v_sub_u32 v32, v32, v33
    v_lshlrev_b32 v101, 4, v32
    v_add_u32 v32, 128, v0
    v_mul_u32_u24 v38, 6554, v32
    v_lshrrev_b32 v38, 16, v38
    v_mul_u32_u24 v33, 10, v38
    v_sub_u32 v32, v32, v33
    v_lshlrev_b32 v102, 4, v32
    v_add_u32 v32, 192, v0
    v_mul_u32_u24 v39, 6554, v32
    v_lshrrev_b32 v39, 16, v39
    v_mul_u32_u24 v33, 10, v39
    v_sub_u32 v32, v32, v33
    v_lshlrev_b32 v103, 4, v32
    v_add_u32 v32, 256, v0
    v_mul_u32_u24 v40, 6554, v32
    v_lshrrev_b32 v40, 16, v40
    v_mul_u32_u24 v33, 10, v40
    v_sub_u32 v32, v32, v33
    v_lshlrev_b32 v104, 4, v32
    s_cmp_ge_u32 s86, 384
    s_cbranch_scc1 L_pp_pwo
    s_mov_b32 s20, s92
    s_and_b32 s21, s93, 0xffff
    s_mov_b32 s22, 0x1e0000
    s_mov_b32 s23, 0x20000
    s_mul_i32 s27, s86, 1366
    s_lshr_b32 s27, s27, 16
    s_mul_i32 s28, s27, 48
    s_sub_u32 s28, s86, s28
    s_mul_i32 s98, s28, 40960
    s_mul_i32 s27, s27, 160
    s_add_u32 s98, s98, s27
    s_mul_i32 s101, s86, 5120
    s_add_u32 s101, s101, 0x1380000
    s_branch L_pp_pgo
L_pp_pwo:
    s_and_b32 s21, s21, 0xffff
    s_mov_b32 s22, 0xc8000
    s_mov_b32 s23, 0x20000
    s_sub_u32 s86, s86, 384
    s_mul_i32 s27, s86, 3277
    s_lshr_b32 s27, s27, 16
    s_mul_i32 s28, s27, 20
    s_sub_u32 s28, s86, s28
    s_mul_i32 s98, s27, 160
    s_mul_i32 s27, s28, 205
    s_lshr_b32 s27, s27, 10
    s_mul_i32 s29, s27, 5
    s_sub_u32 s28, s28, s29
    s_mul_i32 s27, s27, 204800
    s_add_u32 s98, s98, s27
    s_mul_i32 s101, s86, 5120
    s_add_u32 s101, s101, 0x1280000
    s_cmp_eq_u32 s28, 4
    s_cbranch_scc1 L_pp_pleft
    s_mul_i32 s28, s28, 51200
    s_add_u32 s98, s98, s28
    v_lshrrev_b32 v32, 4, v36
    v_lshl_add_u32 v36, v32, 2, v36
    v_lshrrev_b32 v32, 4, v37
    v_lshl_add_u32 v37, v32, 2, v37
    v_lshrrev_b32 v32, 4, v38
    v_lshl_add_u32 v38, v32, 2, v38
    v_lshrrev_b32 v32, 4, v39
    v_lshl_add_u32 v39, v32, 2, v39
    v_lshrrev_b32 v32, 4, v40
    v_lshl_add_u32 v40, v32, 2, v40
    s_branch L_pp_pgo
L_pp_pleft:
    v_lshrrev_b32 v32, 2, v36
    v_lshl_add_u32 v36, v32, 4, v36
    v_add_u32 v36, 16, v36
    v_lshrrev_b32 v32, 2, v37
    v_lshl_add_u32 v37, v32, 4, v37
    v_add_u32 v37, 16, v37
    v_lshrrev_b32 v32, 2, v38
    v_lshl_add_u32 v38, v32, 4, v38
    v_add_u32 v38, 16, v38
    v_lshrrev_b32 v32, 2, v39
    v_lshl_add_u32 v39, v32, 4, v39
    v_add_u32 v39, 16, v39
    v_lshrrev_b32 v32, 2, v40
    v_lshl_add_u32 v40, v32, 4, v40
    v_add_u32 v40, 16, v40
L_pp_pgo:
    v_mul_u32_u24 v32, 1280, v36
    v_add_u32 v100, v100, v32
    v_mul_u32_u24 v32, 1280, v37
    v_add_u32 v101, v101, v32
    v_mul_u32_u24 v32, 1280, v38
    v_add_u32 v102, v102, v32
    v_mul_u32_u24 v32, 1280, v39
    v_add_u32 v103, v103, v32
    v_mul_u32_u24 v32, 1280, v40
    v_add_u32 v104, v104, v32
L_pp_ta:
    v_lshrrev_b32 v32, 4, v0
    v_bfe_u32 v33, v0, 2, 2
    v_lshl_add_u32 v32, v32, 3, v33
    v_mul_u32_u24 v32, 160, v32
    v_add_u32 v32, s3, v32
    v_and_b32 v33, 3, v0
    v_lshl_add_u32 v8, v33, 4, v32
    v_lshl_add_u32 v9, v33, 3, v32
    s_mov_b32 s92, 0x2b800000
    s_mov_b32 s93, 0x5f800000
    s_lshr_b32 s27, s97, 1
    s_mul_i32 s27, s27, 5
    s_and_b32 s28, s97, 1
    s_lshl_b32 s28, s28, 1
    s_add_u32 s27, s27, s28
    s_add_u32 s28, s27, 2
    s_lshr_b32 s27, s27, 4
    s_lshr_b32 s28, s28, 4
    v_mov_b32 v33, s27
    v_mov_b32 v34, s28
    v_and_b32 v35, 16, v0
    v_cmp_eq_u32 vcc, 0, v35
    s_nop 1
    v_cndmask_b32 v32, v34, v33, vcc
    v_lshrrev_b32 v35, 5, v0
    v_mul_u32_u24 v35, 5, v35
    v_add3_u32 v32, v32, v35, 5
    v_and_b32 v35, 15, v0
    v_lshl_add_u32 v32, v32, 4, v35
    v_lshlrev_b32 v32, 7, v32
    v_and_b32 v35, 2, v0
    v_cmp_eq_u32 vcc, 0, v35
    s_nop 1
    v_cndmask_b32 v33, v34, v33, vcc
    s_lshr_b32 s27, s33, 3
    s_lshl_b32 s27, s27, 1
    v_and_b32 v35, 1, v0
    v_add_u32 v35, s27, v35
    v_lshl_add_u32 v33, v33, 4, v35
    v_lshlrev_b32 v33, 7, v33
    s_mov_b64 s[84:85], -1
    s_cmp_lg_u32 s24, 4
    s_cbranch_scc1 L_gs_done
    s_mov_b64 exec, s[84:85]
    s_mov_b32 s28, 0
    s_mov_b32 s27, 0x15cc000
L_gs_poll:
    s_sleep 4
    buffer_load_dword v36, v32, s[8:11], s27 offen sc1
    buffer_load_dword v37, v33, s[8:11], s27 offen sc1
    s_add_u32 s28, s28, 1
    s_waitcnt vmcnt(0)
    v_min_u32 v36, v36, v37
    v_cmp_eq_u32 vcc, 0, v36
    s_cmp_lt_u32 s28, 0x40000
    s_cselect_b64 vcc, vcc, 0
    s_cbranch_vccnz L_gs_poll
    s_mov_b64 exec, -1
L_gs_done:
    s_barrier
    s_mul_i32 s29, s33, 2560
    s_add_u32 s29, s29, s38
    s_add_u32 s29, s29, 0x280000
    buffer_load_dwordx4 v[88:91], v6, s[8:11], s29 offen sc1
    buffer_load_dword v92, v5, s[8:11], s29 offen sc1
    buffer_load_dwordx4 v[72:75], v6, s[8:11], s96 offen sc1
    buffer_load_dword v76, v5, s[8:11], s96 offen sc1
    s_cmp_ge_u32 s24, 3
    s_cbranch_scc1 L_p0
    s_add_u32 m0, s32, 102400
    s_nop 0
    buffer_load_dwordx4 v6, s[8:11], s36 offen sc1 lds
    s_add_u32 m0, s32, 103424
    s_nop 0
    buffer_load_dword v5, s[8:11], s36 offen sc1 lds
    s_add_u32 m0, s32, 103680
    s_add_u32 s36, s36, 20480
    buffer_load_dwordx4 v4, s[8:11], s37 offen sc1 lds
    s_add_u32 m0, s32, 104704
    s_add_u32 s27, s37, 1024
    buffer_load_dword v7, s[8:11], s27 offen sc1 lds
    s_add_u32 s37, s37, 10240
L_p0:
    s_mov_b32 s94, 0x7f000000
    s_cmp_lt_u32 s24, 3
    s_cbranch_scc1 L_p1
    s_waitcnt vmcnt(0)
    s_add_u32 m0, s32, 102400
    s_nop 0
    buffer_load_dwordx4 v6, s[8:11], s36 offen sc1 lds
    s_add_u32 m0, s32, 103424
    s_nop 0
    buffer_load_dword v5, s[8:11], s36 offen sc1 lds
    s_add_u32 m0, s32, 103680
    s_add_u32 s36, s36, 20480
    buffer_load_dwordx4 v4, s[8:11], s37 offen sc1 lds
    s_add_u32 m0, s32, 104704
    s_add_u32 s27, s37, 1024
    buffer_load_dword v7, s[8:11], s27 offen sc1 lds
    s_add_u32 s37, s37, 10240
L_p1:
    s_waitcnt vmcnt(4)
    v_mfma_f32_32x32x16_bf16 v[16:31], v[72:75], v[88:91], 0
    v_mfma_f32_32x32x8_bf16 v[16:31], v[76:77], v[92:93], v[16:31]
    s_nop 11
    v_max3_f32 v64, v16, v17, v18
    v_max_f32 v64, v64, v19
    v_max3_f32 v64, v64, v20, v21
    v_max3_f32 v64, v64, v22, v23
    v_max3_f32 v64, v64, v24, v25
    v_max3_f32 v64, v64, v26, v27
    v_max3_f32 v64, v64, v28, v29
    v_max3_f32 v64, v64, v30, v31
    v_mov_b32 v65, v64
    s_nop 1
    v_permlane32_swap_b32 v64, v65
    v_max_f32 v64, v64, v65
    v_cvt_pk_bf16_f32 v65, -v64, -v64
    v_and_b32 v65, 0xffff0000, v65
    v_sub_f32 v66, -v64, v65
    v_cvt_pk_bf16_f32 v67, v65, v66
    v_and_b32 v65, 0xffff0000, v67
    v_sub_f32 v66, v66, v65
    v_cvt_pk_bf16_f32 v66, v66, 0
    v_cmp_gt_u32 vcc, 32, v0
    s_nop 1
    v_cndmask_b32 v93, v66, v67, vcc
    v_mfma_f32_32x32x16_bf16 v[16:31], v[72:75], v[88:91], 0
    s_nop 0
    v_mfma_f32_32x32x8_bf16 v[16:31], v[76:77], v[92:93], v[16:31]
    s_cmp_ge_u32 s24, 3
    s_nop 1
    s_cbranch_scc1 L_p2
    s_waitcnt vmcnt(0)
L_p2:
    s_barrier
    ds_read_b128 v[72:75], v1 offset:2560
    ds_read_b32 v76, v2 offset:2560
    s_mov_b64 exec, s[34:35]
    ds_read_b128 v[80:83], v3
    s_mov_b64 exec, -1
    s_setprio 3
L_attn_code:
    s_waitcnt lgkmcnt(1)
    v_mfma_f32_32x32x16_bf16 v[32:47], v[72:75], v[88:91], 0
    v_exp_f32 v16, v16
    v_exp_f32 v17, v17
    s_add_u32 m0, s32, 122880
    s_nop 0
    buffer_load_dwordx4 v6, s[8:11], s36 offen sc1 lds
    v_exp_f32 v18, v18
    v_exp_f32 v19, v19
    s_waitcnt lgkmcnt(0)
    v_exp_f32 v20, v20
    v_exp_f32 v21, v21
    s_add_u32 m0, s32, 123904
    s_nop 0
    buffer_load_dword v5, s[8:11], s36 offen sc1 lds
    v_exp_f32 v22, v22
    v_exp_f32 v23, v23
    v_mfma_f32_32x32x8_bf16 v[32:47], v[76:77], v[92:93], v[32:47]
    ds_read_b128 v[72:75], v1 offset:5120
    ds_read_b32 v76, v2 offset:5120
    v_exp_f32 v64, v24
    v_exp_f32 v65, v25
    s_cmp_eq_u32 s24, 0
    s_cselect_b32 s27, s48, 0x2000000
    s_mov_b64 exec, 1
    buffer_atomic_add_x2 v[108:109], v95, s[8:11], s27 offen offset:512 sc1
    s_mov_b64 exec, -1
    v_exp_f32 v66, v26
    v_exp_f32 v67, v27
    v_smfmac_f32_32x32x32_bf16 v[48:63], v[80:83], v[16:23], v79
    s_mov_b64 exec, s[34:35]
    ds_read_b128 v[84:87], v3 offset:640
    ds_read_b128 v[80:83], v3 offset:2560
    s_mov_b64 exec, -1
    v_exp_f32 v68, v28
    v_exp_f32 v69, v29
    v_exp_f32 v70, v30
    v_exp_f32 v71, v31
    s_waitcnt vmcnt(3)
    s_barrier
    s_setprio 2
    s_waitcnt lgkmcnt(2)
    v_mfma_f32_32x32x16_bf16 v[16:31], v[72:75], v[88:91], 0
    v_exp_f32 v32, v32
    v_exp_f32 v33, v33
    s_add_u32 m0, s32, 124160
    s_add_u32 s36, s36, 20480
    buffer_load_dwordx4 v4, s[8:11], s37 offen sc1 lds
    v_exp_f32 v34, v34
    v_exp_f32 v35, v35
    s_waitcnt lgkmcnt(0)
    v_smfmac_f32_32x32x32_bf16 v[48:63], v[84:87], v[64:71], v79
    v_exp_f32 v36, v36
    v_exp_f32 v37, v37
    s_add_u32 m0, s32, 125184
    s_add_u32 s27, s37, 1024
    buffer_load_dword v7, s[8:11], s27 offen sc1 lds
    s_add_u32 s37, s37, 10240
    v_exp_f32 v38, v38
    v_exp_f32 v39, v39
    v_mfma_f32_32x32x8_bf16 v[16:31], v[76:77], v[92:93], v[16:31]
    ds_read_b128 v[72:75], v1 offset:7680
    ds_read_b32 v76, v2 offset:7680
    v_exp_f32 v64, v40
    v_exp_f32 v65, v41
    s_mov_b64 exec, 3
    global_load_dword v111, v99, s[88:89]
    s_mov_b64 exec, -1
    v_exp_f32 v66, v42
    v_exp_f32 v67, v43
    v_smfmac_f32_32x32x32_bf16 v[48:63], v[80:83], v[32:39], v79
    s_mov_b64 exec, s[34:35]
    ds_read_b128 v[84:87], v3 offset:3200
    ds_read_b128 v[80:83], v3 offset:5120
    s_mov_b64 exec, -1
    v_exp_f32 v68, v44
    v_exp_f32 v69, v45
    v_exp_f32 v70, v46
    v_exp_f32 v71, v47
    s_waitcnt lgkmcnt(2)
    v_mfma_f32_32x32x16_bf16 v[32:47], v[72:75], v[88:91], 0
    v_exp_f32 v16, v16
    v_exp_f32 v17, v17
    s_add_u32 m0, s3, 0
    s_nop 0
    buffer_load_dwordx4 v100, s[20:23], s98 offen lds
    v_exp_f32 v18, v18
    v_exp_f32 v19, v19
    s_waitcnt lgkmcnt(0)
    v_smfmac_f32_32x32x32_bf16 v[48:63], v[84:87], v[64:71], v79
    v_exp_f32 v20, v20
    v_exp_f32 v21, v21
    s_add_u32 m0, s3, 1024
    s_nop 0
    buffer_load_dwordx4 v101, s[20:23], s98 offen lds
    v_exp_f32 v22, v22
    v_exp_f32 v23, v23
    v_mfma_f32_32x32x8_bf16 v[32:47], v[76:77], v[92:93], v[32:47]
    ds_read_b128 v[72:75], v1 offset:10240
    ds_read_b32 v76, v2 offset:10240
    v_exp_f32 v64, v24
    v_exp_f32 v65, v25
    v_exp_f32 v66, v26
    v_exp_f32 v67, v27
    v_smfmac_f32_32x32x32_bf16 v[48:63], v[80:83], v[16:23], v79
    s_mov_b64 exec, s[34:35]
    ds_read_b128 v[84:87], v3 offset:5760
    ds_read_b128 v[80:83], v3 offset:7680
    s_mov_b64 exec, -1
    v_exp_f32 v68, v28
    v_exp_f32 v69, v29
    v_exp_f32 v70, v30
    v_exp_f32 v71, v31
    s_setprio 1
    s_waitcnt lgkmcnt(2)
    v_mfma_f32_32x32x16_bf16 v[16:31], v[72:75], v[88:91], 0
    v_exp_f32 v32, v32
    v_exp_f32 v33, v33
    s_add_u32 m0, s3, 2048
    s_nop 0
    buffer_load_dwordx4 v102, s[20:23], s98 offen lds
    v_exp_f32 v34, v34
    v_exp_f32 v35, v35
    s_waitcnt lgkmcnt(0)
    v_smfmac_f32_32x32x32_bf16 v[48:63], v[84:87], v[64:71], v79
    v_exp_f32 v36, v36
    v_exp_f32 v37, v37
    s_add_u32 m0, s3, 3072
    s_nop 0
    buffer_load_dwordx4 v103, s[20:23], s98 offen lds
    v_exp_f32 v38, v38
    v_exp_f32 v39, v39
    v_mfma_f32_32x32x8_bf16 v[16:31], v[76:77], v[92:93], v[16:31]
    ds_read_b128 v[72:75], v1 offset:12800
    ds_read_b32 v76, v2 offset:12800
    v_exp_f32 v64, v40
    v_exp_f32 v65, v41
    v_exp_f32 v66, v42
    v_exp_f32 v67, v43
    v_smfmac_f32_32x32x32_bf16 v[48:63], v[80:83], v[32:39], v79
    s_mov_b64 exec, s[34:35]
    ds_read_b128 v[84:87], v3 offset:8320
    ds_read_b128 v[80:83], v3 offset:10240
    s_mov_b64 exec, -1
    v_exp_f32 v68, v44
    v_exp_f32 v69, v45
    v_exp_f32 v70, v46
    v_exp_f32 v71, v47
    s_waitcnt lgkmcnt(2)
    v_mfma_f32_32x32x16_bf16 v[32:47], v[72:75], v[88:91], 0
    v_exp_f32 v16, v16
    v_exp_f32 v17, v17
    s_add_u32 m0, s3, 4096
    s_nop 0
    buffer_load_dwordx4 v104, s[20:23], s98 offen lds
    v_exp_f32 v18, v18
    v_exp_f32 v19, v19
    s_waitcnt lgkmcnt(0)
    v_smfmac_f32_32x32x32_bf16 v[48:63], v[84:87], v[64:71], v79
    v_exp_f32 v20, v20
    v_exp_f32 v21, v21
    v_exp_f32 v22, v22
    v_exp_f32 v23, v23
    v_mfma_f32_32x32x8_bf16 v[32:47], v[76:77], v[92:93], v[32:47]
    ds_read_b128 v[72:75], v1 offset:15360
    ds_read_b32 v76, v2 offset:15360
    v_exp_f32 v64, v24
    v_exp_f32 v65, v25
    v_exp_f32 v66, v26
    v_exp_f32 v67, v27
    v_smfmac_f32_32x32x32_bf16 v[48:63], v[80:83], v[16:23], v79
    s_mov_b64 exec, s[34:35]
    ds_read_b128 v[84:87], v3 offset:10880
    ds_read_b128 v[80:83], v3 offset:12800
    s_mov_b64 exec, -1
    v_exp_f32 v68, v28
    v_exp_f32 v69, v29
    v_exp_f32 v70, v30
    v_exp_f32 v71, v31
    s_setprio 0
    s_waitcnt lgkmcnt(2)
    v_mfma_f32_32x32x16_bf16 v[16:31], v[72:75], v[88:91], 0
    v_exp_f32 v32, v32
    v_exp_f32 v33, v33
    s_lshr_b32 s27, s90, 3
    s_lshl_b32 s27, s27, 2
    s_add_u32 s27, s27, s51
    s_mul_i32 s27, s27, 1920
    s_bfm_b64 exec, 15, 0
    buffer_load_dword v111, v94, s[52:55], s27 offen
    s_mov_b64 exec, -1
    v_exp_f32 v34, v34
    v_exp_f32 v35, v35
    s_waitcnt lgkmcnt(0)
    v_smfmac_f32_32x32x32_bf16 v[48:63], v[84:87], v[64:71], v79
    v_exp_f32 v36, v36
    v_exp_f32 v37, v37
    v_exp_f32 v38, v38
    v_exp_f32 v39, v39
    v_mfma_f32_32x32x8_bf16 v[16:31], v[76:77], v[92:93], v[16:31]
    ds_read_b128 v[72:75], v1 offset:17920
    ds_read_b32 v76, v2 offset:17920
    v_exp_f32 v64, v40
    v_exp_f32 v65, v41
    v_exp_f32 v66, v42
    v_exp_f32 v67, v43
    v_smfmac_f32_32x32x32_bf16 v[48:63], v[80:83], v[32:39], v79
    s_mov_b64 exec, s[34:35]
    ds_read_b128 v[84:87], v3 offset:13440
    ds_read_b128 v[80:83], v3 offset:15360
    s_mov_b64 exec, -1
    v_exp_f32 v68, v44
    v_exp_f32 v69, v45
    v_exp_f32 v70, v46
    v_exp_f32 v71, v47
    s_waitcnt vmcnt(7)
    s_barrier
    s_setprio 3
    s_waitcnt lgkmcnt(2)
    v_mfma_f32_32x32x16_bf16 v[32:47], v[72:75], v[88:91], 0
    v_exp_f32 v16, v16
    v_exp_f32 v17, v17
    s_add_u32 m0, s32, 143360
    s_nop 0
    buffer_load_dwordx4 v6, s[8:11], s36 offen sc1 lds
    v_exp_f32 v18, v18
    v_exp_f32 v19, v19
    s_waitcnt lgkmcnt(0)
    v_smfmac_f32_32x32x32_bf16 v[48:63], v[84:87], v[64:71], v79
    v_exp_f32 v20, v20
    v_exp_f32 v21, v21
    s_add_u32 m0, s32, 144384
    s_nop 0
    buffer_load_dword v5, s[8:11], s36 offen sc1 lds
    v_exp_f32 v22, v22
    v_exp_f32 v23, v23
    v_mfma_f32_32x32x8_bf16 v[32:47], v[76:77], v[92:93], v[32:47]
    ds_read_b128 v[72:75], v1 offset:20480
    ds_read_b32 v76, v2 offset:20480
    v_exp_f32 v64, v24
    v_exp_f32 v65, v25
    v_exp_f32 v66, v26
    v_exp_f32 v67, v27
    v_smfmac_f32_32x32x32_bf16 v[48:63], v[80:83], v[16:23], v79
    s_mov_b64 exec, s[34:35]
    ds_read_b128 v[84:87], v3 offset:16000
    ds_read_b128 v[80:83], v3 offset:17920
    s_mov_b64 exec, -1
    v_exp_f32 v68, v28
    v_exp_f32 v69, v29
    v_exp_f32 v70, v30
    v_exp_f32 v71, v31
    s_waitcnt lgkmcnt(2)
    v_mfma_f32_32x32x16_bf16 v[16:31], v[72:75], v[88:91], 0
    v_exp_f32 v32, v32
    v_exp_f32 v33, v33
    s_add_u32 m0, s32, 144640
    s_add_u32 s36, s36, 20480
    buffer_load_dwordx4 v4, s[8:11], s37 offen sc1 lds
    v_exp_f32 v34, v34
    v_exp_f32 v35, v35
    s_waitcnt lgkmcnt(0)
    v_smfmac_f32_32x32x32_bf16 v[48:63], v[84:87], v[64:71], v79
    v_exp_f32 v36, v36
    v_exp_f32 v37, v37
    s_add_u32 m0, s32, 145664
    s_add_u32 s27, s37, 1024
    buffer_load_dword v7, s[8:11], s27 offen sc1 lds
    s_add_u32 s37, s37, 10240
    v_exp_f32 v38, v38
    v_exp_f32 v39, v39
    v_mfma_f32_32x32x8_bf16 v[16:31], v[76:77], v[92:93], v[16:31]
    ds_read_b128 v[72:75], v1 offset:23040
    ds_read_b32 v76, v2 offset:23040
    v_exp_f32 v64, v40
    v_exp_f32 v65, v41
    v_exp_f32 v66, v42
    v_exp_f32 v67, v43
    v_smfmac_f32_32x32x32_bf16 v[48:63], v[80:83], v[32:39], v79
    s_mov_b64 exec, s[34:35]
    ds_read_b128 v[84:87], v3 offset:18560
    ds_read_b128 v[80:83], v3 offset:20480
    s_mov_b64 exec, -1
    v_exp_f32 v68, v44
    v_exp_f32 v69, v45
    v_exp_f32 v70, v46
    v_exp_f32 v71, v47
    s_waitcnt lgkmcnt(2)
    v_mfma_f32_32x32x16_bf16 v[32:47], v[72:75], v[88:91], 0
    v_exp_f32 v16, v16
    v_exp_f32 v17, v17
    v_exp_f32 v18, v18
    v_exp_f32 v19, v19
    s_waitcnt lgkmcnt(0)
    v_smfmac_f32_32x32x32_bf16 v[48:63], v[84:87], v[64:71], v79
    s_waitcnt vmcnt(5)
    ds_read_b64_tr_b16 a[0:1], v8 offset:0
    ds_read_b64_tr_b16 a[2:3], v8 offset:640
    v_exp_f32 v20, v20
    ds_read_b64_tr_b16 a[4:5], v8 offset:8
    ds_read_b64_tr_b16 a[6:7], v8 offset:648
    v_exp_f32 v21, v21
    v_exp_f32 v22, v22
    ds_read_b64_tr_b16 a[8:9], v8 offset:64
    v_exp_f32 v23, v23
    v_mfma_f32_32x32x8_bf16 v[32:47], v[76:77], v[92:93], v[32:47]
    ds_read_b128 v[72:75], v1 offset:25600
    ds_read_b32 v76, v2 offset:25600
    v_exp_f32 v64, v24
    v_exp_f32 v65, v25
    v_exp_f32 v66, v26
    v_exp_f32 v67, v27
    v_smfmac_f32_32x32x32_bf16 v[48:63], v[80:83], v[16:23], v79
    s_mov_b64 exec, s[34:35]
    ds_read_b128 v[84:87], v3 offset:21120
    ds_read_b128 v[80:83], v3 offset:23040
    s_mov_b64 exec, -1
    v_exp_f32 v68, v28
    v_exp_f32 v69, v29
    v_exp_f32 v70, v30
    v_exp_f32 v71, v31
    s_setprio 2
    s_waitcnt lgkmcnt(2)
    v_mfma_f32_32x32x16_bf16 v[16:31], v[72:75], v[88:91], 0
    v_exp_f32 v32, v32
    v_exp_f32 v33, v33
    v_exp_f32 v34, v34
    v_exp_f32 v35, v35
    s_waitcnt lgkmcnt(0)
    v_smfmac_f32_32x32x32_bf16 v[48:63], v[84:87], v[64:71], v79
    ds_read_b64_tr_b16 a[10:11], v8 offset:704
    ds_read_b64_tr_b16 a[12:13], v8 offset:72
    v_exp_f32 v36, v36
    ds_read_b64_tr_b16 a[14:15], v8 offset:712
    ds_read_b64_tr_b16 a[16:17], v9 offset:128
    v_exp_f32 v37, v37
    v_exp_f32 v38, v38
    ds_read_b64_tr_b16 a[18:19], v9 offset:768
    v_exp_f32 v39, v39
    v_mfma_f32_32x32x8_bf16 v[16:31], v[76:77], v[92:93], v[16:31]
    ds_read_b128 v[72:75], v1 offset:28160
    ds_read_b32 v76, v2 offset:28160
    v_exp_f32 v64, v40
    v_exp_f32 v65, v41
    v_exp_f32 v66, v42
    v_exp_f32 v67, v43
    v_smfmac_f32_32x32x32_bf16 v[48:63], v[80:83], v[32:39], v79
    s_mov_b64 exec, s[34:35]
    ds_read_b128 v[84:87], v3 offset:23680
    ds_read_b128 v[80:83], v3 offset:25600
    s_mov_b64 exec, -1
    v_exp_f32 v68, v44
    v_exp_f32 v69, v45
    v_exp_f32 v70, v46
    v_exp_f32 v71, v47
    s_waitcnt lgkmcnt(2)
    v_mfma_f32_32x32x16_bf16 v[32:47], v[72:75], v[88:91], 0
    v_exp_f32 v16, v16
    v_exp_f32 v17, v17
    s_add_u32 s27, s101, 0
    buffer_store_dwordx4 a[0:3], v4, s[8:11], s27 offen sc1
    v_exp_f32 v18, v18
    v_exp_f32 v19, v19
    s_waitcnt lgkmcnt(0)
    v_smfmac_f32_32x32x32_bf16 v[48:63], v[84:87], v[64:71], v79
    v_exp_f32 v20, v20
    v_exp_f32 v21, v21
    s_add_u32 s27, s101, 1024
    buffer_store_dwordx4 a[4:7], v4, s[8:11], s27 offen sc1
    v_exp_f32 v22, v22
    v_exp_f32 v23, v23
    v_mfma_f32_32x32x8_bf16 v[32:47], v[76:77], v[92:93], v[32:47]
    ds_read_b128 v[72:75], v1 offset:30720
    ds_read_b32 v76, v2 offset:30720
    v_exp_f32 v64, v24
    v_exp_f32 v65, v25
    s_add_u32 s27, s101, 2048
    buffer_store_dwordx4 a[8:11], v4, s[8:11], s27 offen sc1
    v_exp_f32 v66, v26
    v_exp_f32 v67, v27
    v_smfmac_f32_32x32x32_bf16 v[48:63], v[80:83], v[16:23], v79
    s_mov_b64 exec, s[34:35]
    ds_read_b128 v[84:87], v3 offset:26240
    ds_read_b128 v[80:83], v3 offset:28160
    s_mov_b64 exec, -1
    v_exp_f32 v68, v28
    v_exp_f32 v69, v29
    v_exp_f32 v70, v30
    v_exp_f32 v71, v31
    s_setprio 1
    s_waitcnt lgkmcnt(2)
    v_mfma_f32_32x32x16_bf16 v[16:31], v[72:75], v[88:91], 0
    v_exp_f32 v32, v32
    v_exp_f32 v33, v33
    s_add_u32 s27, s101, 3072
    buffer_store_dwordx4 a[12:15], v4, s[8:11], s27 offen sc1
    v_exp_f32 v34, v34
    v_exp_f32 v35, v35
    s_waitcnt lgkmcnt(0)
    v_smfmac_f32_32x32x32_bf16 v[48:63], v[84:87], v[64:71], v79
    v_exp_f32 v36, v36
    v_exp_f32 v37, v37
    s_add_u32 s27, s101, 4096
    buffer_store_dwordx4 a[16:19], v4, s[8:11], s27 offen sc1
    v_exp_f32 v38, v38
    v_exp_f32 v39, v39
    v_mfma_f32_32x32x8_bf16 v[16:31], v[76:77], v[92:93], v[16:31]
    ds_read_b128 v[72:75], v1 offset:33280
    ds_read_b32 v76, v2 offset:33280
    v_exp_f32 v64, v40
    v_exp_f32 v65, v41
    buffer_load_dwordx2 v[108:109], v95, s[8:11], s48 offen offset:512 sc1
    v_exp_f32 v66, v42
    v_exp_f32 v67, v43
    v_smfmac_f32_32x32x32_bf16 v[48:63], v[80:83], v[32:39], v79
    s_mov_b64 exec, s[34:35]
    ds_read_b128 v[84:87], v3 offset:28800
    ds_read_b128 v[80:83], v3 offset:30720
    s_mov_b64 exec, -1
    v_exp_f32 v68, v44
    v_exp_f32 v69, v45
    v_exp_f32 v70, v46
    v_exp_f32 v71, v47
    s_waitcnt lgkmcnt(2)
    v_mfma_f32_32x32x16_bf16 v[32:47], v[72:75], v[88:91], 0
    v_exp_f32 v16, v16
    v_exp_f32 v17, v17
    buffer_load_dwordx4 v[100:103], v106, s[4:7], 0 offen
    v_exp_f32 v18, v18
    v_exp_f32 v19, v19
    s_waitcnt lgkmcnt(0)
    v_smfmac_f32_32x32x32_bf16 v[48:63], v[84:87], v[64:71], v79
    v_exp_f32 v20, v20
    v_exp_f32 v21, v21
    v_exp_f32 v22, v22
    v_exp_f32 v23, v23
    v_mfma_f32_32x32x8_bf16 v[32:47], v[76:77], v[92:93], v[32:47]
    ds_read_b128 v[72:75], v1 offset:35840
    ds_read_b32 v76, v2 offset:35840
    v_exp_f32 v64, v24
    v_exp_f32 v65, v25
    v_exp_f32 v66, v26
    v_exp_f32 v67, v27
    v_smfmac_f32_32x32x32_bf16 v[48:63], v[80:83], v[16:23], v79
    s_mov_b64 exec, s[34:35]
    ds_read_b128 v[84:87], v3 offset:31360
    ds_read_b128 v[80:83], v3 offset:33280
    s_mov_b64 exec, -1
    v_exp_f32 v68, v28
    v_exp_f32 v69, v29
    v_exp_f32 v70, v30
    v_exp_f32 v71, v31
    s_setprio 0
    s_waitcnt lgkmcnt(2)
    v_mfma_f32_32x32x16_bf16 v[16:31], v[72:75], v[88:91], 0
    v_exp_f32 v32, v32
    v_exp_f32 v33, v33
    v_exp_f32 v34, v34
    v_exp_f32 v35, v35
    s_waitcnt lgkmcnt(0)
    v_smfmac_f32_32x32x32_bf16 v[48:63], v[84:87], v[64:71], v79
    v_exp_f32 v36, v36
    v_exp_f32 v37, v37
    v_exp_f32 v38, v38
    v_exp_f32 v39, v39
    v_mfma_f32_32x32x8_bf16 v[16:31], v[76:77], v[92:93], v[16:31]
    ds_read_b128 v[72:75], v1 offset:38400
    ds_read_b32 v76, v2 offset:38400
    v_exp_f32 v64, v40
    v_exp_f32 v65, v41
    v_exp_f32 v66, v42
    v_exp_f32 v67, v43
    v_smfmac_f32_32x32x32_bf16 v[48:63], v[80:83], v[32:39], v79
    s_mov_b64 exec, s[34:35]
    ds_read_b128 v[84:87], v3 offset:33920
    ds_read_b128 v[80:83], v3 offset:35840
    s_mov_b64 exec, -1
    v_exp_f32 v68, v44
    v_exp_f32 v69, v45
    v_exp_f32 v70, v46
    v_exp_f32 v71, v47
    s_waitcnt vmcnt(2)
    s_waitcnt vmcnt(7)
    s_barrier
    s_setprio 3
    s_waitcnt lgkmcnt(2)
    v_mfma_f32_32x32x16_bf16 v[32:47], v[72:75], v[88:91], 0
    v_exp_f32 v16, v16
    v_exp_f32 v17, v17
    s_add_u32 m0, s32, 102400
    s_nop 0
    buffer_load_dwordx4 v6, s[8:11], s36 offen sc1 lds
    v_exp_f32 v18, v18
    v_exp_f32 v19, v19
    s_waitcnt lgkmcnt(0)
    v_smfmac_f32_32x32x32_bf16 v[48:63], v[84:87], v[64:71], v79
    v_exp_f32 v20, v20
    v_exp_f32 v21, v21
    s_add_u32 m0, s32, 103424
    s_nop 0
    buffer_load_dword v5, s[8:11], s36 offen sc1 lds
    v_exp_f32 v22, v22
    v_exp_f32 v23, v23
    v_mfma_f32_32x32x8_bf16 v[32:47], v[76:77], v[92:93], v[32:47]
    ds_read_b128 v[72:75], v1 offset:40960
    ds_read_b32 v76, v2 offset:40960
    v_exp_f32 v64, v24
    v_exp_f32 v65, v25
    s_lshl_b32 s27, s25, 5
    s_add_u32 s27, s27, s26
    s_lshl_b32 s27, s27, 2
    s_add_u32 s27, s27, 0x15ca000
    s_cmp_eq_u32 s24, 0
    s_cselect_b32 s27, s27, 0x2000000
    s_mov_b64 exec, 1
    buffer_store_dword v77, v95, s[8:11], s27 offen sc1
    s_mov_b64 exec, -1
    v_exp_f32 v66, v26
    v_exp_f32 v67, v27
    v_smfmac_f32_32x32x32_bf16 v[48:63], v[80:83], v[16:23], v79
    s_mov_b64 exec, s[34:35]
    ds_read_b128 v[84:87], v3 offset:36480
    ds_read_b128 v[80:83], v3 offset:38400
    s_mov_b64 exec, -1
    v_exp_f32 v68, v28
    v_exp_f32 v69, v29
    v_exp_f32 v70, v30
    v_exp_f32 v71, v31
    s_waitcnt lgkmcnt(2)
    v_mfma_f32_32x32x16_bf16 v[16:31], v[72:75], v[88:91], 0
    v_exp_f32 v32, v32
    v_exp_f32 v33, v33
    s_add_u32 m0, s32, 103680
    s_add_u32 s36, s36, 20480
    buffer_load_dwordx4 v4, s[8:11], s37 offen sc1 lds
    v_exp_f32 v34, v34
    v_exp_f32 v35, v35
    s_waitcnt lgkmcnt(0)
    v_smfmac_f32_32x32x32_bf16 v[48:63], v[84:87], v[64:71], v79
    v_exp_f32 v36, v36
    v_exp_f32 v37, v37
    s_add_u32 m0, s32, 104704
    s_add_u32 s27, s37, 1024
    buffer_load_dword v7, s[8:11], s27 offen sc1 lds
    s_add_u32 s37, s37, 10240
    v_exp_f32 v38, v38
    v_exp_f32 v39, v39
    v_mfma_f32_32x32x8_bf16 v[16:31], v[76:77], v[92:93], v[16:31]
    ds_read_b128 v[72:75], v1 offset:43520
    ds_read_b32 v76, v2 offset:43520
    v_exp_f32 v64, v40
    v_exp_f32 v65, v41
    v_exp_f32 v66, v42
    v_exp_f32 v67, v43
    v_smfmac_f32_32x32x32_bf16 v[48:63], v[80:83], v[32:39], v79
    s_mov_b64 exec, s[34:35]
    ds_read_b128 v[84:87], v3 offset:39040
    ds_read_b128 v[80:83], v3 offset:40960
    s_mov_b64 exec, -1
    v_exp_f32 v68, v44
    v_exp_f32 v69, v45
    v_exp_f32 v70, v46
    v_exp_f32 v71, v47
    s_waitcnt lgkmcnt(2)
    v_mfma_f32_32x32x16_bf16 v[32:47], v[72:75], v[88:91], 0
    v_exp_f32 v16, v16
    v_exp_f32 v17, v17
    s_add_u32 m0, s49, 0
    s_nop 0
    buffer_load_dwordx4 v96, s[52:55], s46 offen lds
    v_exp_f32 v18, v18
    v_exp_f32 v19, v19
    s_waitcnt lgkmcnt(0)
    v_smfmac_f32_32x32x32_bf16 v[48:63], v[84:87], v[64:71], v79
    v_exp_f32 v20, v20
    v_exp_f32 v21, v21
    buffer_load_dwordx2 v[104:105], v107, s[4:7], 0 offen
    v_exp_f32 v22, v22
    v_exp_f32 v23, v23
    v_mfma_f32_32x32x8_bf16 v[32:47], v[76:77], v[92:93], v[32:47]
    ds_read_b128 v[72:75], v1 offset:46080
    ds_read_b32 v76, v2 offset:46080
    v_exp_f32 v64, v24
    v_exp_f32 v65, v25
    v_exp_f32 v66, v26
    v_exp_f32 v67, v27
    v_smfmac_f32_32x32x32_bf16 v[48:63], v[80:83], v[16:23], v79
    s_mov_b64 exec, s[34:35]
    ds_read_b128 v[84:87], v3 offset:41600
    ds_read_b128 v[80:83], v3 offset:43520
    s_mov_b64 exec, -1
    v_exp_f32 v68, v28
    v_exp_f32 v69, v29
    v_exp_f32 v70, v30
    v_exp_f32 v71, v31
    s_setprio 2
    s_waitcnt lgkmcnt(2)
    v_mfma_f32_32x32x16_bf16 v[16:31], v[72:75], v[88:91], 0
    v_exp_f32 v32, v32
    v_exp_f32 v33, v33
    s_add_u32 m0, s49, 1024
    s_nop 0
    buffer_load_dwordx4 v97, s[52:55], s46 offen lds
    v_exp_f32 v34, v34
    v_exp_f32 v35, v35
    s_waitcnt lgkmcnt(0)
    v_smfmac_f32_32x32x32_bf16 v[48:63], v[84:87], v[64:71], v79
    v_exp_f32 v36, v36
    v_exp_f32 v37, v37
    v_exp_f32 v38, v38
    v_exp_f32 v39, v39
    v_mfma_f32_32x32x8_bf16 v[16:31], v[76:77], v[92:93], v[16:31]
    ds_read_b128 v[72:75], v1 offset:48640
    ds_read_b32 v76, v2 offset:48640
    v_exp_f32 v64, v40
    v_exp_f32 v65, v41
    v_exp_f32 v66, v42
    v_exp_f32 v67, v43
    v_smfmac_f32_32x32x32_bf16 v[48:63], v[80:83], v[32:39], v79
    s_mov_b64 exec, s[34:35]
    ds_read_b128 v[84:87], v3 offset:44160
    ds_read_b128 v[80:83], v3 offset:46080
    s_mov_b64 exec, -1
    v_exp_f32 v68, v44
    v_exp_f32 v69, v45
    v_exp_f32 v70, v46
    v_exp_f32 v71, v47
    s_waitcnt lgkmcnt(2)
    v_mfma_f32_32x32x16_bf16 v[32:47], v[72:75], v[88:91], 0
    v_exp_f32 v16, v16
    v_exp_f32 v17, v17
    s_add_u32 m0, s49, 2048
    s_nop 0
    buffer_load_dwordx4 v98, s[52:55], s46 offen lds
    s_add_u32 s46, s46, 196608
    s_cmp_eq_u32 s46, s99
    s_cselect_b32 s27, 1966080, 0
    s_sub_u32 s46, s46, s27
    v_exp_f32 v18, v18
    v_exp_f32 v19, v19
    s_waitcnt lgkmcnt(0)
    v_smfmac_f32_32x32x32_bf16 v[48:63], v[84:87], v[64:71], v79
    v_exp_f32 v20, v20
    v_exp_f32 v21, v21
    v_exp_f32 v22, v22
    v_exp_f32 v23, v23
    v_mfma_f32_32x32x8_bf16 v[32:47], v[76:77], v[92:93], v[32:47]
    ds_read_b128 v[72:75], v1 offset:51200
    ds_read_b32 v76, v2 offset:51200
    v_exp_f32 v64, v24
    v_exp_f32 v65, v25
    v_exp_f32 v66, v26
    v_exp_f32 v67, v27
    v_smfmac_f32_32x32x32_bf16 v[48:63], v[80:83], v[16:23], v79
    s_mov_b64 exec, s[34:35]
    ds_read_b128 v[84:87], v3 offset:46720
    ds_read_b128 v[80:83], v3 offset:48640
    s_mov_b64 exec, -1
    v_exp_f32 v68, v28
    v_exp_f32 v69, v29
    v_exp_f32 v70, v30
    v_exp_f32 v71, v31
    s_setprio 1
    s_waitcnt lgkmcnt(2)
    v_mfma_f32_32x32x16_bf16 v[16:31], v[72:75], v[88:91], 0
    v_exp_f32 v32, v32
    v_exp_f32 v33, v33
    s_add_u32 m0, s49, 24608
    s_nop 0
    buffer_load_dwordx4 v96, s[52:55], s46 offen lds
    v_exp_f32 v34, v34
    v_exp_f32 v35, v35
    s_waitcnt lgkmcnt(0)
    v_smfmac_f32_32x32x32_bf16 v[48:63], v[84:87], v[64:71], v79
    v_exp_f32 v36, v36
    v_exp_f32 v37, v37
    v_exp_f32 v38, v38
    v_exp_f32 v39, v39
    v_mfma_f32_32x32x8_bf16 v[16:31], v[76:77], v[92:93], v[16:31]
    ds_read_b128 v[72:75], v1 offset:53760
    ds_read_b32 v76, v2 offset:53760
    v_exp_f32 v64, v40
    v_exp_f32 v65, v41
    v_exp_f32 v66, v42
    v_exp_f32 v67, v43
    v_smfmac_f32_32x32x32_bf16 v[48:63], v[80:83], v[32:39], v79
    s_mov_b64 exec, s[34:35]
    ds_read_b128 v[84:87], v3 offset:49280
    ds_read_b128 v[80:83], v3 offset:51200
    s_mov_b64 exec, -1
    v_exp_f32 v68, v44
    v_exp_f32 v69, v45
    v_exp_f32 v70, v46
    v_exp_f32 v71, v47
    s_waitcnt lgkmcnt(2)
    v_mfma_f32_32x32x16_bf16 v[32:47], v[72:75], v[88:91], 0
    v_exp_f32 v16, v16
    v_exp_f32 v17, v17
    s_add_u32 m0, s49, 25632
    s_nop 0
    buffer_load_dwordx4 v97, s[52:55], s46 offen lds
    v_exp_f32 v18, v18
    v_exp_f32 v19, v19
    s_waitcnt lgkmcnt(0)
    v_smfmac_f32_32x32x32_bf16 v[48:63], v[84:87], v[64:71], v79
    v_exp_f32 v20, v20
    v_exp_f32 v21, v21
    v_exp_f32 v22, v22
    v_exp_f32 v23, v23
    v_mfma_f32_32x32x8_bf16 v[32:47], v[76:77], v[92:93], v[32:47]
    ds_read_b128 v[72:75], v1 offset:56320
    ds_read_b32 v76, v2 offset:56320
    v_exp_f32 v64, v24
    v_exp_f32 v65, v25
    v_exp_f32 v66, v26
    v_exp_f32 v67, v27
    v_smfmac_f32_32x32x32_bf16 v[48:63], v[80:83], v[16:23], v79
    s_mov_b64 exec, s[34:35]
    ds_read_b128 v[84:87], v3 offset:51840
    ds_read_b128 v[80:83], v3 offset:53760
    s_mov_b64 exec, -1
    v_exp_f32 v68, v28
    v_exp_f32 v69, v29
    v_exp_f32 v70, v30
    v_exp_f32 v71, v31
    s_setprio 0
    s_waitcnt lgkmcnt(2)
    v_mfma_f32_32x32x16_bf16 v[16:31], v[72:75], v[88:91], 0
    v_exp_f32 v32, v32
    v_exp_f32 v33, v33
    s_add_u32 m0, s49, 26656
    s_nop 0
    buffer_load_dwordx4 v98, s[52:55], s46 offen lds
    s_add_u32 s46, s46, 196608
    s_cmp_eq_u32 s46, s99
    s_cselect_b32 s27, 1966080, 0
    s_sub_u32 s46, s46, s27
    v_exp_f32 v34, v34
    v_exp_f32 v35, v35
    s_waitcnt lgkmcnt(0)
    v_smfmac_f32_32x32x32_bf16 v[48:63], v[84:87], v[64:71], v79
    v_exp_f32 v36, v36
    v_exp_f32 v37, v37
    v_exp_f32 v38, v38
    v_exp_f32 v39, v39
    v_mfma_f32_32x32x8_bf16 v[16:31], v[76:77], v[92:93], v[16:31]
    ds_read_b128 v[72:75], v1 offset:58880
    ds_read_b32 v76, v2 offset:58880
    v_exp_f32 v64, v40
    v_exp_f32 v65, v41
    v_exp_f32 v66, v42
    v_exp_f32 v67, v43
    v_smfmac_f32_32x32x32_bf16 v[48:63], v[80:83], v[32:39], v79
    s_mov_b64 exec, s[34:35]
    ds_read_b128 v[84:87], v3 offset:54400
    ds_read_b128 v[80:83], v3 offset:56320
    s_mov_b64 exec, -1
    v_exp_f32 v68, v44
    v_exp_f32 v69, v45
    v_exp_f32 v70, v46
    v_exp_f32 v71, v47
    s_waitcnt vmcnt(7)
    s_barrier
    s_setprio 3
    s_waitcnt lgkmcnt(2)
    v_mfma_f32_32x32x16_bf16 v[32:47], v[72:75], v[88:91], 0
    v_exp_f32 v16, v16
    v_exp_f32 v17, v17
    s_add_u32 m0, s32, 122880
    s_nop 0
    buffer_load_dwordx4 v6, s[8:11], s36 offen sc1 lds
    v_exp_f32 v18, v18
    v_exp_f32 v19, v19
    s_waitcnt lgkmcnt(0)
    v_smfmac_f32_32x32x32_bf16 v[48:63], v[84:87], v[64:71], v79
    v_exp_f32 v20, v20
    v_exp_f32 v21, v21
    s_add_u32 m0, s32, 123904
    s_nop 0
    buffer_load_dword v5, s[8:11], s36 offen sc1 lds
    v_exp_f32 v22, v22
    v_exp_f32 v23, v23
    v_mfma_f32_32x32x8_bf16 v[32:47], v[76:77], v[92:93], v[32:47]
    ds_read_b128 v[72:75], v1 offset:0
    ds_read_b32 v76, v2 offset:0
    v_exp_f32 v64, v24
    v_exp_f32 v65, v25
    v_exp_f32 v66, v26
    v_exp_f32 v67, v27
    v_smfmac_f32_32x32x32_bf16 v[48:63], v[80:83], v[16:23], v79
    s_mov_b64 exec, s[34:35]
    ds_read_b128 v[84:87], v3 offset:56960
    ds_read_b128 v[80:83], v3 offset:58880
    s_mov_b64 exec, -1
    v_exp_f32 v68, v28
    v_exp_f32 v69, v29
    v_exp_f32 v70, v30
    v_exp_f32 v71, v31
    s_waitcnt lgkmcnt(2)
    v_mfma_f32_32x32x16_bf16 v[16:31], v[72:75], v[88:91], 0
    v_exp_f32 v32, v32
    v_exp_f32 v33, v33
    s_add_u32 m0, s32, 124160
    s_add_u32 s36, s36, 20480
    buffer_load_dwordx4 v4, s[8:11], s37 offen sc1 lds
    v_exp_f32 v34, v34
    v_exp_f32 v35, v35
    s_waitcnt lgkmcnt(0)
    v_smfmac_f32_32x32x32_bf16 v[48:63], v[84:87], v[64:71], v79
    s_waitcnt vmcnt(16)
    s_mov_b32 s28, s42
    v_readfirstlane_b32 s42, v108
    v_readfirstlane_b32 s43, v109
    s_nop 0
    s_lshr_b64 s[42:43], s[42:43], s50
    s_and_b32 s43, s42, 63
    s_mov_b32 s42, s28
    s_cmp_eq_u32 s43, 32
    s_cselect_b32 s43, 1, 0
    v_exp_f32 v36, v36
    v_exp_f32 v37, v37
    s_add_u32 m0, s32, 125184
    s_add_u32 s27, s37, 1024
    buffer_load_dword v7, s[8:11], s27 offen sc1 lds
    s_add_u32 s37, s37, 10240
    v_exp_f32 v38, v38
    v_exp_f32 v39, v39
    v_mfma_f32_32x32x8_bf16 v[16:31], v[76:77], v[92:93], v[16:31]
    ds_read_b128 v[72:75], v1 offset:2560
    ds_read_b32 v76, v2 offset:2560
    v_exp_f32 v64, v40
    v_exp_f32 v65, v41
    s_add_u32 m0, s49, 49216
    s_nop 0
    buffer_load_dwordx4 v96, s[52:55], s46 offen lds
    v_exp_f32 v66, v42
    v_exp_f32 v67, v43
    v_smfmac_f32_32x32x32_bf16 v[48:63], v[80:83], v[32:39], v79
    s_mov_b64 exec, s[34:35]
    ds_read_b128 v[84:87], v3 offset:59520
    ds_read_b128 v[80:83], v3 offset:0
    s_mov_b64 exec, -1
    v_exp_f32 v68, v44
    v_exp_f32 v69, v45
    v_exp_f32 v70, v46
    v_exp_f32 v71, v47
    s_waitcnt lgkmcnt(2)
    v_mfma_f32_32x32x16_bf16 v[32:47], v[72:75], v[88:91], 0
    v_exp_f32 v16, v16
    v_exp_f32 v17, v17
    s_add_u32 m0, s49, 50240
    s_nop 0
    buffer_load_dwordx4 v97, s[52:55], s46 offen lds
    v_exp_f32 v18, v18
    v_exp_f32 v19, v19
    s_waitcnt lgkmcnt(0)
    v_smfmac_f32_32x32x32_bf16 v[48:63], v[84:87], v[64:71], v79
    v_exp_f32 v20, v20
    v_exp_f32 v21, v21
    v_exp_f32 v22, v22
    v_exp_f32 v23, v23
    v_mfma_f32_32x32x8_bf16 v[32:47], v[76:77], v[92:93], v[32:47]
    ds_read_b128 v[72:75], v1 offset:5120
    ds_read_b32 v76, v2 offset:5120
    v_exp_f32 v64, v24
    v_exp_f32 v65, v25
    v_exp_f32 v66, v26
    v_exp_f32 v67, v27
    v_smfmac_f32_32x32x32_bf16 v[48:63], v[80:83], v[16:23], v79
    s_mov_b64 exec, s[34:35]
    ds_read_b128 v[84:87], v3 offset:640
    ds_read_b128 v[80:83], v3 offset:2560
    s_mov_b64 exec, -1
    v_exp_f32 v68, v28
    v_exp_f32 v69, v29
    v_exp_f32 v70, v30
    v_exp_f32 v71, v31
    s_setprio 2
    s_waitcnt lgkmcnt(2)
    v_mfma_f32_32x32x16_bf16 v[16:31], v[72:75], v[88:91], 0
    v_exp_f32 v32, v32
    v_exp_f32 v33, v33
    s_mov_b32 s98, 0x15ca000
    s_cmp_eq_u32 s24, 0
    s_cselect_b32 s98, s98, 0x2000000
    buffer_load_dwordx4 v[8:11], v4, s[8:11], s98 offen sc1
    v_exp_f32 v34, v34
    v_exp_f32 v35, v35
    s_waitcnt lgkmcnt(0)
    v_smfmac_f32_32x32x32_bf16 v[48:63], v[84:87], v[64:71], v79
    v_exp_f32 v36, v36
    v_exp_f32 v37, v37
    s_add_u32 m0, s49, 51264
    s_nop 0
    buffer_load_dwordx4 v98, s[52:55], s46 offen lds
    s_add_u32 s46, s46, 196608
    s_cmp_eq_u32 s46, s99
    s_cselect_b32 s27, 1966080, 0
    s_sub_u32 s46, s46, s27
    v_exp_f32 v38, v38
    v_exp_f32 v39, v39
    v_mfma_f32_32x32x8_bf16 v[16:31], v[76:77], v[92:93], v[16:31]
    ds_read_b128 v[72:75], v1 offset:7680
    ds_read_b32 v76, v2 offset:7680
    v_exp_f32 v64, v40
    v_exp_f32 v65, v41
    v_exp_f32 v66, v42
    v_exp_f32 v67, v43
    v_smfmac_f32_32x32x32_bf16 v[48:63], v[80:83], v[32:39], v79
    s_mov_b64 exec, s[34:35]
    ds_read_b128 v[84:87], v3 offset:3200
    ds_read_b128 v[80:83], v3 offset:5120
    s_mov_b64 exec, -1
    v_exp_f32 v68, v44
    v_exp_f32 v69, v45
    v_exp_f32 v70, v46
    v_exp_f32 v71, v47
    s_waitcnt lgkmcnt(2)
    v_mfma_f32_32x32x16_bf16 v[32:47], v[72:75], v[88:91], 0
    v_exp_f32 v16, v16
    v_exp_f32 v17, v17
    s_add_u32 m0, s49, 73824
    s_nop 0
    buffer_load_dwordx4 v96, s[52:55], s46 offen lds
    v_exp_f32 v18, v18
    v_exp_f32 v19, v19
    s_waitcnt lgkmcnt(0)
    v_smfmac_f32_32x32x32_bf16 v[48:63], v[84:87], v[64:71], v79
    v_exp_f32 v20, v20
    v_exp_f32 v21, v21
    v_exp_f32 v22, v22
    v_exp_f32 v23, v23
    v_mfma_f32_32x32x8_bf16 v[32:47], v[76:77], v[92:93], v[32:47]
    ds_read_b128 v[72:75], v1 offset:10240
    ds_read_b32 v76, v2 offset:10240
    v_exp_f32 v64, v24
    v_exp_f32 v65, v25
    v_exp_f32 v66, v26
    v_exp_f32 v67, v27
    v_smfmac_f32_32x32x32_bf16 v[48:63], v[80:83], v[16:23], v79
    s_mov_b64 exec, s[34:35]
    ds_read_b128 v[84:87], v3 offset:5760
    ds_read_b128 v[80:83], v3 offset:7680
    s_mov_b64 exec, -1
    v_exp_f32 v68, v28
    v_exp_f32 v69, v29
    v_exp_f32 v70, v30
    v_exp_f32 v71, v31
    s_setprio 1
    s_waitcnt lgkmcnt(2)
    v_mfma_f32_32x32x16_bf16 v[16:31], v[72:75], v[88:91], 0
    v_exp_f32 v32, v32
    v_exp_f32 v33, v33
    s_add_u32 m0, s49, 74848
    s_nop 0
    buffer_load_dwordx4 v97, s[52:55], s46 offen lds
    v_exp_f32 v34, v34
    v_exp_f32 v35, v35
    s_waitcnt lgkmcnt(0)
    v_smfmac_f32_32x32x32_bf16 v[48:63], v[84:87], v[64:71], v79
    v_exp_f32 v36, v36
    v_exp_f32 v37, v37
    v_exp_f32 v38, v38
    v_exp_f32 v39, v39
    v_mfma_f32_32x32x8_bf16 v[16:31], v[76:77], v[92:93], v[16:31]
    ds_read_b128 v[72:75], v1 offset:12800
    ds_read_b32 v76, v2 offset:12800
    v_exp_f32 v64, v40
    v_exp_f32 v65, v41
    v_exp_f32 v66, v42
    v_exp_f32 v67, v43
    v_smfmac_f32_32x32x32_bf16 v[48:63], v[80:83], v[32:39], v79
    s_mov_b64 exec, s[34:35]
    ds_read_b128 v[84:87], v3 offset:8320
    ds_read_b128 v[80:83], v3 offset:10240
    s_mov_b64 exec, -1
    v_exp_f32 v68, v44
    v_exp_f32 v69, v45
    v_exp_f32 v70, v46
    v_exp_f32 v71, v47
    s_waitcnt lgkmcnt(2)
    v_mfma_f32_32x32x16_bf16 v[32:47], v[72:75], v[88:91], 0
    v_exp_f32 v16, v16
    v_exp_f32 v17, v17
    s_add_u32 m0, s49, 75872
    s_nop 0
    buffer_load_dwordx4 v98, s[52:55], s46 offen lds
    s_add_u32 s46, s46, 196608
    s_cmp_eq_u32 s46, s99
    s_cselect_b32 s27, 1966080, 0
    s_sub_u32 s46, s46, s27
    v_exp_f32 v18, v18
    v_exp_f32 v19, v19
    s_waitcnt lgkmcnt(0)
    v_smfmac_f32_32x32x32_bf16 v[48:63], v[84:87], v[64:71], v79
    v_exp_f32 v20, v20
    v_exp_f32 v21, v21
    v_exp_f32 v22, v22
    v_exp_f32 v23, v23
    v_mfma_f32_32x32x8_bf16 v[32:47], v[76:77], v[92:93], v[32:47]
    ds_read_b128 v[72:75], v1 offset:15360
    ds_read_b32 v76, v2 offset:15360
    v_exp_f32 v64, v24
    v_exp_f32 v65, v25
    v_exp_f32 v66, v26
    v_exp_f32 v67, v27
    v_smfmac_f32_32x32x32_bf16 v[48:63], v[80:83], v[16:23], v79
    s_mov_b64 exec, s[34:35]
    ds_read_b128 v[84:87], v3 offset:10880
    ds_read_b128 v[80:83], v3 offset:12800
    s_mov_b64 exec, -1
    v_exp_f32 v68, v28
    v_exp_f32 v69, v29
    v_exp_f32 v70, v30
    v_exp_f32 v71, v31
    s_setprio 0
    s_waitcnt lgkmcnt(2)
    v_mfma_f32_32x32x16_bf16 v[16:31], v[72:75], v[88:91], 0
    v_exp_f32 v32, v32
    v_exp_f32 v33, v33
    v_exp_f32 v34, v34
    v_exp_f32 v35, v35
    s_waitcnt lgkmcnt(0)
    v_smfmac_f32_32x32x32_bf16 v[48:63], v[84:87], v[64:71], v79
    v_exp_f32 v36, v36
    v_exp_f32 v37, v37
    v_exp_f32 v38, v38
    v_exp_f32 v39, v39
    v_mfma_f32_32x32x8_bf16 v[16:31], v[76:77], v[92:93], v[16:31]
    ds_read_b128 v[72:75], v1 offset:17920
    ds_read_b32 v76, v2 offset:17920
    v_exp_f32 v64, v40
    v_exp_f32 v65, v41
    v_exp_f32 v66, v42
    v_exp_f32 v67, v43
    v_smfmac_f32_32x32x32_bf16 v[48:63], v[80:83], v[32:39], v79
    s_mov_b64 exec, s[34:35]
    ds_read_b128 v[84:87], v3 offset:13440
    ds_read_b128 v[80:83], v3 offset:15360
    s_mov_b64 exec, -1
    v_exp_f32 v68, v44
    v_exp_f32 v69, v45
    v_exp_f32 v70, v46
    v_exp_f32 v71, v47
    s_cmp_lg_u32 s24, 0
    s_cbranch_scc1 L_pck_done
    s_waitcnt vmcnt(4)
    s_mov_b32 s28, 0
L_pck:
    v_min_u32 v8, v8, v9
    v_min3_u32 v8, v8, v10, v11
    v_cmp_eq_u32 vcc, 0, v8
    s_add_u32 s28, s28, 1
    s_cmp_lt_u32 s28, 0x40000
    s_cselect_b64 vcc, vcc, 0
    s_cbranch_vccz L_pck_done
    s_sleep 4
    buffer_load_dwordx4 v[8:11], v4, s[8:11], s98 offen sc1
    s_waitcnt vmcnt(0)
    s_branch L_pck
L_pck_done:
    s_waitcnt vmcnt(7)
    s_barrier
    s_setprio 3
    s_waitcnt lgkmcnt(2)
    v_mfma_f32_32x32x16_bf16 v[32:47], v[72:75], v[88:91], 0
    v_exp_f32 v16, v16
    v_exp_f32 v17, v17
    s_add_u32 m0, s32, 143360
    s_nop 0
    buffer_load_dwordx4 v6, s[8:11], s36 offen sc1 lds
    v_exp_f32 v18, v18
    v_exp_f32 v19, v19
    s_waitcnt lgkmcnt(0)
    v_smfmac_f32_32x32x32_bf16 v[48:63], v[84:87], v[64:71], v79
    v_exp_f32 v20, v20
    v_exp_f32 v21, v21
    s_add_u32 m0, s32, 144384
    s_nop 0
    buffer_load_dword v5, s[8:11], s36 offen sc1 lds
    v_exp_f32 v22, v22
    v_exp_f32 v23, v23
    v_mfma_f32_32x32x8_bf16 v[32:47], v[76:77], v[92:93], v[32:47]
    ds_read_b128 v[72:75], v1 offset:20480
    ds_read_b32 v76, v2 offset:20480
    v_exp_f32 v64, v24
    v_exp_f32 v65, v25
    s_add_u32 s86, s45, 0
    buffer_load_dwordx4 a[100:103], v4, s[8:11], s86 offen offset:0 sc1
    v_exp_f32 v66, v26
    v_exp_f32 v67, v27
    v_smfmac_f32_32x32x32_bf16 v[48:63], v[80:83], v[16:23], v79
    s_mov_b64 exec, s[34:35]
    ds_read_b128 v[84:87], v3 offset:16000
    ds_read_b128 v[80:83], v3 offset:17920
    s_mov_b64 exec, -1
    v_exp_f32 v68, v28
    v_exp_f32 v69, v29
    v_exp_f32 v70, v30
    v_exp_f32 v71, v31
    s_waitcnt lgkmcnt(2)
    v_mfma_f32_32x32x16_bf16 v[16:31], v[72:75], v[88:91], 0
    v_exp_f32 v32, v32
    v_exp_f32 v33, v33
    s_add_u32 m0, s32, 144640
    s_add_u32 s36, s36, 20480
    buffer_load_dwordx4 v4, s[8:11], s37 offen sc1 lds
    v_exp_f32 v34, v34
    v_exp_f32 v35, v35
    s_waitcnt lgkmcnt(0)
    v_smfmac_f32_32x32x32_bf16 v[48:63], v[84:87], v[64:71], v79
    v_exp_f32 v36, v36
    v_exp_f32 v37, v37
    s_add_u32 m0, s32, 145664
    s_add_u32 s27, s37, 1024
    buffer_load_dword v7, s[8:11], s27 offen sc1 lds
    s_add_u32 s37, s37, 10240
    v_exp_f32 v38, v38
    v_exp_f32 v39, v39
    v_mfma_f32_32x32x8_bf16 v[16:31], v[76:77], v[92:93], v[16:31]
    ds_read_b128 v[72:75], v1 offset:23040
    ds_read_b32 v76, v2 offset:23040
    v_exp_f32 v64, v40
    v_exp_f32 v65, v41
    buffer_load_dwordx4 a[104:107], v4, s[8:11], s86 offen offset:1024 sc1
    v_exp_f32 v66, v42
    v_exp_f32 v67, v43
    v_smfmac_f32_32x32x32_bf16 v[48:63], v[80:83], v[32:39], v79
    s_mov_b64 exec, s[34:35]
    ds_read_b128 v[84:87], v3 offset:18560
    ds_read_b128 v[80:83], v3 offset:20480
    s_mov_b64 exec, -1
    v_exp_f32 v68, v44
    v_exp_f32 v69, v45
    v_exp_f32 v70, v46
    v_exp_f32 v71, v47
    s_waitcnt lgkmcnt(2)
    v_mfma_f32_32x32x16_bf16 v[32:47], v[72:75], v[88:91], 0
    v_exp_f32 v16, v16
    v_exp_f32 v17, v17
    buffer_load_dwordx4 a[108:111], v4, s[8:11], s86 offen offset:2048 sc1
    v_exp_f32 v18, v18
    v_exp_f32 v19, v19
    s_waitcnt lgkmcnt(0)
    v_smfmac_f32_32x32x32_bf16 v[48:63], v[84:87], v[64:71], v79
    v_exp_f32 v20, v20
    v_exp_f32 v21, v21
    buffer_load_dwordx4 a[112:115], v4, s[8:11], s86 offen offset:3072 sc1
    v_exp_f32 v22, v22
    v_exp_f32 v23, v23
    v_mfma_f32_32x32x8_bf16 v[32:47], v[76:77], v[92:93], v[32:47]
    ds_read_b128 v[72:75], v1 offset:25600
    ds_read_b32 v76, v2 offset:25600
    v_exp_f32 v64, v24
    v_exp_f32 v65, v25
    v_exp_f32 v66, v26
    v_exp_f32 v67, v27
    v_smfmac_f32_32x32x32_bf16 v[48:63], v[80:83], v[16:23], v79
    s_mov_b64 exec, s[34:35]
    ds_read_b128 v[84:87], v3 offset:21120
    ds_read_b128 v[80:83], v3 offset:23040
    s_mov_b64 exec, -1
    v_exp_f32 v68, v28
    v_exp_f32 v69, v29
    v_exp_f32 v70, v30
    v_exp_f32 v71, v31
    s_setprio 2
    s_waitcnt lgkmcnt(2)
    v_mfma_f32_32x32x16_bf16 v[16:31], v[72:75], v[88:91], 0
    v_exp_f32 v32, v32
    v_exp_f32 v33, v33
    s_add_u32 s86, s45, 4096
    buffer_load_dwordx4 a[116:119], v4, s[8:11], s86 offen offset:0 sc1
    v_exp_f32 v34, v34
    v_exp_f32 v35, v35
    s_waitcnt lgkmcnt(0)
    v_smfmac_f32_32x32x32_bf16 v[48:63], v[84:87], v[64:71], v79
    v_exp_f32 v36, v36
    v_exp_f32 v37, v37
    v_exp_f32 v38, v38
    v_exp_f32 v39, v39
    v_mfma_f32_32x32x8_bf16 v[16:31], v[76:77], v[92:93], v[16:31]
    ds_read_b128 v[72:75], v1 offset:28160
    ds_read_b32 v76, v2 offset:28160
    v_exp_f32 v64, v40
    v_exp_f32 v65, v41
    v_exp_f32 v66, v42
    v_exp_f32 v67, v43
    v_smfmac_f32_32x32x32_bf16 v[48:63], v[80:83], v[32:39], v79
    s_mov_b64 exec, s[34:35]
    ds_read_b128 v[84:87], v3 offset:23680
    ds_read_b128 v[80:83], v3 offset:25600
    s_mov_b64 exec, -1
    v_exp_f32 v68, v44
    v_exp_f32 v69, v45
    v_exp_f32 v70, v46
    v_exp_f32 v71, v47
    s_waitcnt lgkmcnt(2)
    v_mfma_f32_32x32x16_bf16 v[32:47], v[72:75], v[88:91], 0
    v_exp_f32 v16, v16
    v_exp_f32 v17, v17
    buffer_load_dwordx4 a[120:123], v4, s[8:11], s86 offen offset:1024 sc1
    v_exp_f32 v18, v18
    v_exp_f32 v19, v19
    s_waitcnt lgkmcnt(0)
    v_smfmac_f32_32x32x32_bf16 v[48:63], v[84:87], v[64:71], v79
    v_exp_f32 v20, v20
    v_exp_f32 v21, v21
    v_exp_f32 v22, v22
    v_exp_f32 v23, v23
    v_mfma_f32_32x32x8_bf16 v[32:47], v[76:77], v[92:93], v[32:47]
    ds_read_b128 v[72:75], v1 offset:30720
    ds_read_b32 v76, v2 offset:30720
    v_exp_f32 v64, v24
    v_exp_f32 v65, v25
    v_exp_f32 v66, v26
    v_exp_f32 v67, v27
    v_smfmac_f32_32x32x32_bf16 v[48:63], v[80:83], v[16:23], v79
    s_mov_b64 exec, s[34:35]
    ds_read_b128 v[84:87], v3 offset:26240
    ds_read_b128 v[80:83], v3 offset:28160
    s_mov_b64 exec, -1
    v_exp_f32 v68, v28
    v_exp_f32 v69, v29
    v_exp_f32 v70, v30
    v_exp_f32 v71, v31
    s_setprio 1
    s_waitcnt lgkmcnt(2)
    v_mfma_f32_32x32x16_bf16 v[16:31], v[72:75], v[88:91], 0
    v_exp_f32 v32, v32
    v_exp_f32 v33, v33
    buffer_load_dwordx4 a[124:127], v4, s[8:11], s86 offen offset:2048 sc1
    v_exp_f32 v34, v34
    v_exp_f32 v35, v35
    s_waitcnt lgkmcnt(0)
    v_smfmac_f32_32x32x32_bf16 v[48:63], v[84:87], v[64:71], v79
    v_exp_f32 v36, v36
    v_exp_f32 v37, v37
    v_exp_f32 v38, v38
    v_exp_f32 v39, v39
    v_mfma_f32_32x32x8_bf16 v[16:31], v[76:77], v[92:93], v[16:31]
    ds_read_b128 v[72:75], v1 offset:33280
    ds_read_b32 v76, v2 offset:33280
    v_exp_f32 v64, v40
    v_exp_f32 v65, v41
    v_exp_f32 v66, v42
    v_exp_f32 v67, v43
    v_smfmac_f32_32x32x32_bf16 v[48:63], v[80:83], v[32:39], v79
    s_mov_b64 exec, s[34:35]
    ds_read_b128 v[84:87], v3 offset:28800
    ds_read_b128 v[80:83], v3 offset:30720
    s_mov_b64 exec, -1
    v_exp_f32 v68, v44
    v_exp_f32 v69, v45
    v_exp_f32 v70, v46
    v_exp_f32 v71, v47
    s_waitcnt lgkmcnt(2)
    v_mfma_f32_32x32x16_bf16 v[32:47], v[72:75], v[88:91], 0
    v_exp_f32 v16, v16
    v_exp_f32 v17, v17
    buffer_load_dwordx4 a[128:131], v4, s[8:11], s86 offen offset:3072 sc1
    v_exp_f32 v18, v18
    v_exp_f32 v19, v19
    s_waitcnt lgkmcnt(0)
    v_smfmac_f32_32x32x32_bf16 v[48:63], v[84:87], v[64:71], v79
    v_exp_f32 v20, v20
    v_exp_f32 v21, v21
    s_add_u32 s86, s45, 8192
    buffer_load_dwordx4 a[132:135], v4, s[8:11], s86 offen offset:0 sc1
    v_exp_f32 v22, v22
    v_exp_f32 v23, v23
    v_mfma_f32_32x32x8_bf16 v[32:47], v[76:77], v[92:93], v[32:47]
    ds_read_b128 v[72:75], v1 offset:35840
    ds_read_b32 v76, v2 offset:35840
    v_exp_f32 v64, v24
    v_exp_f32 v65, v25
    v_exp_f32 v66, v26
    v_exp_f32 v67, v27
    v_smfmac_f32_32x32x32_bf16 v[48:63], v[80:83], v[16:23], v79
    s_mov_b64 exec, s[34:35]
    ds_read_b128 v[84:87], v3 offset:31360
    ds_read_b128 v[80:83], v3 offset:33280
    s_mov_b64 exec, -1
    v_exp_f32 v68, v28
    v_exp_f32 v69, v29
    v_exp_f32 v70, v30
    v_exp_f32 v71, v31
    s_setprio 0
    s_waitcnt lgkmcnt(2)
    v_mfma_f32_32x32x16_bf16 v[16:31], v[72:75], v[88:91], 0
    v_exp_f32 v32, v32
    v_exp_f32 v33, v33
    buffer_load_dwordx4 a[136:139], v4, s[8:11], s86 offen offset:1024 sc1
    v_exp_f32 v34, v34
    v_exp_f32 v35, v35
    s_waitcnt lgkmcnt(0)
    v_smfmac_f32_32x32x32_bf16 v[48:63], v[84:87], v[64:71], v79
    v_exp_f32 v36, v36
    v_exp_f32 v37, v37
    v_exp_f32 v38, v38
    v_exp_f32 v39, v39
    v_mfma_f32_32x32x8_bf16 v[16:31], v[76:77], v[92:93], v[16:31]
    ds_read_b128 v[72:75], v1 offset:38400
    ds_read_b32 v76, v2 offset:38400
    v_exp_f32 v64, v40
    v_exp_f32 v65, v41
    v_exp_f32 v66, v42
    v_exp_f32 v67, v43
    v_smfmac_f32_32x32x32_bf16 v[48:63], v[80:83], v[32:39], v79
    s_mov_b64 exec, s[34:35]
    ds_read_b128 v[84:87], v3 offset:33920
    ds_read_b128 v[80:83], v3 offset:35840
    s_mov_b64 exec, -1
    v_exp_f32 v68, v44
    v_exp_f32 v69, v45
    v_exp_f32 v70, v46
    v_exp_f32 v71, v47
    s_waitcnt vmcnt(9)
    s_barrier
    s_setprio 3
    s_waitcnt lgkmcnt(2)
    v_mfma_f32_32x32x16_bf16 v[32:47], v[72:75], v[88:91], 0
    v_exp_f32 v16, v16
    v_exp_f32 v17, v17
    s_add_u32 m0, s32, 102400
    s_nop 0
    buffer_load_dwordx4 v6, s[8:11], s36 offen sc1 lds
    v_exp_f32 v18, v18
    v_exp_f32 v19, v19
    s_waitcnt lgkmcnt(0)
    v_smfmac_f32_32x32x32_bf16 v[48:63], v[84:87], v[64:71], v79
    v_exp_f32 v20, v20
    v_exp_f32 v21, v21
    s_add_u32 m0, s32, 103424
    s_nop 0
    buffer_load_dword v5, s[8:11], s36 offen sc1 lds
    v_exp_f32 v22, v22
    v_exp_f32 v23, v23
    v_mfma_f32_32x32x8_bf16 v[32:47], v[76:77], v[92:93], v[32:47]
    ds_read_b128 v[72:75], v1 offset:40960
    ds_read_b32 v76, v2 offset:40960
    v_exp_f32 v64, v24
    v_exp_f32 v65, v25
    s_add_u32 s86, s44, 0
    buffer_load_dwordx4 a[0:3], v4, s[8:11], s86 offen offset:0 sc1
    v_exp_f32 v66, v26
    v_exp_f32 v67, v27
    v_smfmac_f32_32x32x32_bf16 v[48:63], v[80:83], v[16:23], v79
    s_mov_b64 exec, s[34:35]
    ds_read_b128 v[84:87], v3 offset:36480
    ds_read_b128 v[80:83], v3 offset:38400
    s_mov_b64 exec, -1
    v_exp_f32 v68, v28
    v_exp_f32 v69, v29
    v_exp_f32 v70, v30
    v_exp_f32 v71, v31
    s_waitcnt lgkmcnt(2)
    v_mfma_f32_32x32x16_bf16 v[16:31], v[72:75], v[88:91], 0
    v_exp_f32 v32, v32
    v_exp_f32 v33, v33
    s_add_u32 m0, s32, 103680
    s_add_u32 s36, s36, 20480
    buffer_load_dwordx4 v4, s[8:11], s37 offen sc1 lds
    v_exp_f32 v34, v34
    v_exp_f32 v35, v35
    s_waitcnt lgkmcnt(0)
    v_smfmac_f32_32x32x32_bf16 v[48:63], v[84:87], v[64:71], v79
    v_exp_f32 v36, v36
    v_exp_f32 v37, v37
    s_add_u32 m0, s32, 104704
    s_add_u32 s27, s37, 1024
    buffer_load_dword v7, s[8:11], s27 offen sc1 lds
    s_add_u32 s37, s37, 10240
    v_exp_f32 v38, v38
    v_exp_f32 v39, v39
    v_mfma_f32_32x32x8_bf16 v[16:31], v[76:77], v[92:93], v[16:31]
    ds_read_b128 v[72:75], v1 offset:43520
    ds_read_b32 v76, v2 offset:43520
    v_exp_f32 v64, v40
    v_exp_f32 v65, v41
    buffer_load_dwordx4 a[4:7], v4, s[8:11], s86 offen offset:1024 sc1
    v_exp_f32 v66, v42
    v_exp_f32 v67, v43
    v_smfmac_f32_32x32x32_bf16 v[48:63], v[80:83], v[32:39], v79
    s_mov_b64 exec, s[34:35]
    ds_read_b128 v[84:87], v3 offset:39040
    ds_read_b128 v[80:83], v3 offset:40960
    s_mov_b64 exec, -1
    v_exp_f32 v68, v44
    v_exp_f32 v69, v45
    v_exp_f32 v70, v46
    v_exp_f32 v71, v47
    s_waitcnt lgkmcnt(2)
    v_mfma_f32_32x32x16_bf16 v[32:47], v[72:75], v[88:91], 0
    v_exp_f32 v16, v16
    v_exp_f32 v17, v17
    buffer_load_dwordx4 a[8:11], v4, s[8:11], s86 offen offset:2048 sc1
    v_exp_f32 v18, v18
    v_exp_f32 v19, v19
    s_waitcnt lgkmcnt(0)
    v_smfmac_f32_32x32x32_bf16 v[48:63], v[84:87], v[64:71], v79
    v_exp_f32 v20, v20
    v_exp_f32 v21, v21
    v_exp_f32 v22, v22
    v_exp_f32 v23, v23
    v_mfma_f32_32x32x8_bf16 v[32:47], v[76:77], v[92:93], v[32:47]
    ds_read_b128 v[72:75], v1 offset:46080
    ds_read_b32 v76, v2 offset:46080
    v_exp_f32 v64, v24
    v_exp_f32 v65, v25
    v_exp_f32 v66, v26
    v_exp_f32 v67, v27
    v_smfmac_f32_32x32x32_bf16 v[48:63], v[80:83], v[16:23], v79
    s_mov_b64 exec, s[34:35]
    ds_read_b128 v[84:87], v3 offset:41600
    ds_read_b128 v[80:83], v3 offset:43520
    s_mov_b64 exec, -1
    v_exp_f32 v68, v28
    v_exp_f32 v69, v29
    v_exp_f32 v70, v30
    v_exp_f32 v71, v31
    s_setprio 2
    s_waitcnt lgkmcnt(2)
    v_mfma_f32_32x32x16_bf16 v[16:31], v[72:75], v[88:91], 0
    v_exp_f32 v32, v32
    v_exp_f32 v33, v33
    buffer_load_dwordx4 a[12:15], v4, s[8:11], s86 offen offset:3072 sc1
    v_exp_f32 v34, v34
    v_exp_f32 v35, v35
    s_waitcnt lgkmcnt(0)
    v_smfmac_f32_32x32x32_bf16 v[48:63], v[84:87], v[64:71], v79
    v_exp_f32 v36, v36
    v_exp_f32 v37, v37
    v_exp_f32 v38, v38
    v_exp_f32 v39, v39
    v_mfma_f32_32x32x8_bf16 v[16:31], v[76:77], v[92:93], v[16:31]
    ds_read_b128 v[72:75], v1 offset:48640
    ds_read_b32 v76, v2 offset:48640
    v_exp_f32 v64, v40
    v_exp_f32 v65, v41
    v_exp_f32 v66, v42
    v_exp_f32 v67, v43
    v_smfmac_f32_32x32x32_bf16 v[48:63], v[80:83], v[32:39], v79
    s_mov_b64 exec, s[34:35]
    ds_read_b128 v[84:87], v3 offset:44160
    ds_read_b128 v[80:83], v3 offset:46080
    s_mov_b64 exec, -1
    v_exp_f32 v68, v44
    v_exp_f32 v69, v45
    v_exp_f32 v70, v46
    v_exp_f32 v71, v47
    s_waitcnt lgkmcnt(2)
    v_mfma_f32_32x32x16_bf16 v[32:47], v[72:75], v[88:91], 0
    v_exp_f32 v16, v16
    v_exp_f32 v17, v17
    s_add_u32 s86, s86, 4096
    buffer_load_dwordx4 a[16:19], v4, s[8:11], s86 offen offset:0 sc1
    v_exp_f32 v18, v18
    v_exp_f32 v19, v19
    s_waitcnt lgkmcnt(0)
    v_smfmac_f32_32x32x32_bf16 v[48:63], v[84:87], v[64:71], v79
    v_exp_f32 v20, v20
    v_exp_f32 v21, v21
    s_add_u32 s86, s44, 5120
    buffer_load_dwordx4 a[20:23], v4, s[8:11], s86 offen offset:0 sc1
    v_exp_f32 v22, v22
    v_exp_f32 v23, v23
    v_mfma_f32_32x32x8_bf16 v[32:47], v[76:77], v[92:93], v[32:47]
    ds_read_b128 v[72:75], v1 offset:51200
    ds_read_b32 v76, v2 offset:51200
    v_exp_f32 v64, v24
    v_exp_f32 v65, v25
    v_exp_f32 v66, v26
    v_exp_f32 v67, v27
    v_smfmac_f32_32x32x32_bf16 v[48:63], v[80:83], v[16:23], v79
    s_mov_b64 exec, s[34:35]
    ds_read_b128 v[84:87], v3 offset:46720
    ds_read_b128 v[80:83], v3 offset:48640
    s_mov_b64 exec, -1
    v_exp_f32 v68, v28
    v_exp_f32 v69, v29
    v_exp_f32 v70, v30
    v_exp_f32 v71, v31
    s_setprio 1
    s_waitcnt lgkmcnt(2)
    v_mfma_f32_32x32x16_bf16 v[16:31], v[72:75], v[88:91], 0
    v_exp_f32 v32, v32
    v_exp_f32 v33, v33
    buffer_load_dwordx4 a[24:27], v4, s[8:11], s86 offen offset:1024 sc1
    v_exp_f32 v34, v34
    v_exp_f32 v35, v35
    s_waitcnt lgkmcnt(0)
    v_smfmac_f32_32x32x32_bf16 v[48:63], v[84:87], v[64:71], v79
    v_exp_f32 v36, v36
    v_exp_f32 v37, v37
    v_exp_f32 v38, v38
    v_exp_f32 v39, v39
    v_mfma_f32_32x32x8_bf16 v[16:31], v[76:77], v[92:93], v[16:31]
    ds_read_b128 v[72:75], v1 offset:53760
    ds_read_b32 v76, v2 offset:53760
    v_exp_f32 v64, v40
    v_exp_f32 v65, v41
    v_exp_f32 v66, v42
    v_exp_f32 v67, v43
    v_smfmac_f32_32x32x32_bf16 v[48:63], v[80:83], v[32:39], v79
    s_mov_b64 exec, s[34:35]
    ds_read_b128 v[84:87], v3 offset:49280
    ds_read_b128 v[80:83], v3 offset:51200
    s_mov_b64 exec, -1
    v_exp_f32 v68, v44
    v_exp_f32 v69, v45
    v_exp_f32 v70, v46
    v_exp_f32 v71, v47
    s_waitcnt lgkmcnt(2)
    v_mfma_f32_32x32x16_bf16 v[32:47], v[72:75], v[88:91], 0
    v_exp_f32 v16, v16
    v_exp_f32 v17, v17
    buffer_load_dwordx4 a[28:31], v4, s[8:11], s86 offen offset:2048 sc1
    v_exp_f32 v18, v18
    v_exp_f32 v19, v19
    s_waitcnt lgkmcnt(0)
    v_smfmac_f32_32x32x32_bf16 v[48:63], v[84:87], v[64:71], v79
    v_exp_f32 v20, v20
    v_exp_f32 v21, v21
    s_mul_i32 s27, s90, 1280
    s_add_u32 s27, s27, 0xa00000
    s_cmp_lg_u32 s43, 0
    s_cselect_b32 s27, s27, 0x2000000
    s_bfm_b64 exec, 10, 0
    buffer_load_dword v111, v94, s[8:11], s27 offen
    s_mov_b64 exec, -1
    v_exp_f32 v22, v22
    v_exp_f32 v23, v23
    v_mfma_f32_32x32x8_bf16 v[32:47], v[76:77], v[92:93], v[32:47]
    ds_read_b128 v[72:75], v1 offset:56320
    ds_read_b32 v76, v2 offset:56320
    v_exp_f32 v64, v24
    v_exp_f32 v65, v25
    v_exp_f32 v66, v26
    v_exp_f32 v67, v27
    v_smfmac_f32_32x32x32_bf16 v[48:63], v[80:83], v[16:23], v79
    s_mov_b64 exec, s[34:35]
    ds_read_b128 v[84:87], v3 offset:51840
    ds_read_b128 v[80:83], v3 offset:53760
    s_mov_b64 exec, -1
    v_exp_f32 v68, v28
    v_exp_f32 v69, v29
    v_exp_f32 v70, v30
    v_exp_f32 v71, v31
    s_setprio 0
    s_waitcnt lgkmcnt(2)
    v_mfma_f32_32x32x16_bf16 v[16:31], v[72:75], v[88:91], 0
    v_exp_f32 v32, v32
    v_exp_f32 v33, v33
    buffer_load_dwordx4 a[32:35], v4, s[8:11], s86 offen offset:3072 sc1
    v_exp_f32 v34, v34
    v_exp_f32 v35, v35
    s_waitcnt lgkmcnt(0)
    v_smfmac_f32_32x32x32_bf16 v[48:63], v[84:87], v[64:71], v79
    v_exp_f32 v36, v36
    v_exp_f32 v37, v37
    v_exp_f32 v38, v38
    v_exp_f32 v39, v39
    v_mfma_f32_32x32x8_bf16 v[16:31], v[76:77], v[92:93], v[16:31]
    ds_read_b128 v[72:75], v1 offset:58880
    ds_read_b32 v76, v2 offset:58880
    v_exp_f32 v64, v40
    v_exp_f32 v65, v41
    v_exp_f32 v66, v42
    v_exp_f32 v67, v43
    v_smfmac_f32_32x32x32_bf16 v[48:63], v[80:83], v[32:39], v79
    s_mov_b64 exec, s[34:35]
    ds_read_b128 v[84:87], v3 offset:54400
    ds_read_b128 v[80:83], v3 offset:56320
    s_mov_b64 exec, -1
    v_exp_f32 v68, v44
    v_exp_f32 v69, v45
    v_exp_f32 v70, v46
    v_exp_f32 v71, v47
    s_waitcnt vmcnt(9)
    s_barrier
    s_setprio 3
    s_waitcnt lgkmcnt(2)
    v_mfma_f32_32x32x16_bf16 v[32:47], v[72:75], v[88:91], 0
    v_exp_f32 v16, v16
    v_exp_f32 v17, v17
    s_add_u32 m0, s32, 122880
    s_nop 0
    buffer_load_dwordx4 v6, s[8:11], s36 offen sc1 lds
    v_exp_f32 v18, v18
    v_exp_f32 v19, v19
    s_waitcnt lgkmcnt(0)
    v_smfmac_f32_32x32x32_bf16 v[48:63], v[84:87], v[64:71], v79
    v_exp_f32 v20, v20
    v_exp_f32 v21, v21
    s_add_u32 m0, s32, 123904
    s_nop 0
    buffer_load_dword v5, s[8:11], s36 offen sc1 lds
    v_exp_f32 v22, v22
    v_exp_f32 v23, v23
    v_mfma_f32_32x32x8_bf16 v[32:47], v[76:77], v[92:93], v[32:47]
    ds_read_b128 v[72:75], v1 offset:0
    ds_read_b32 v76, v2 offset:0
    v_exp_f32 v64, v24
    v_exp_f32 v65, v25
    s_add_u32 s86, s86, 4096
    buffer_load_dwordx4 a[36:39], v4, s[8:11], s86 offen offset:0 sc1
    v_exp_f32 v66, v26
    v_exp_f32 v67, v27
    v_smfmac_f32_32x32x32_bf16 v[48:63], v[80:83], v[16:23], v79
    s_mov_b64 exec, s[34:35]
    ds_read_b128 v[84:87], v3 offset:56960
    ds_read_b128 v[80:83], v3 offset:58880
    s_mov_b64 exec, -1
    v_exp_f32 v68, v28
    v_exp_f32 v69, v29
    v_exp_f32 v70, v30
    v_exp_f32 v71, v31
    s_waitcnt lgkmcnt(2)
    v_mfma_f32_32x32x16_bf16 v[16:31], v[72:75], v[88:91], 0
    v_exp_f32 v32, v32
    v_exp_f32 v33, v33
    s_add_u32 m0, s32, 124160
    s_add_u32 s36, s36, 20480
    buffer_load_dwordx4 v4, s[8:11], s37 offen sc1 lds
    v_exp_f32 v34, v34
    v_exp_f32 v35, v35
    s_waitcnt lgkmcnt(0)
    v_smfmac_f32_32x32x32_bf16 v[48:63], v[84:87], v[64:71], v79
    v_exp_f32 v36, v36
    v_exp_f32 v37, v37
    s_add_u32 m0, s32, 125184
    s_add_u32 s27, s37, 1024
    buffer_load_dword v7, s[8:11], s27 offen sc1 lds
    s_add_u32 s37, s37, 10240
    v_exp_f32 v38, v38
    v_exp_f32 v39, v39
    v_mfma_f32_32x32x8_bf16 v[16:31], v[76:77], v[92:93], v[16:31]
    ds_read_b128 v[72:75], v1 offset:2560
    ds_read_b32 v76, v2 offset:2560
    v_exp_f32 v64, v40
    v_exp_f32 v65, v41
    s_add_u32 s86, s44, 10240
    buffer_load_dwordx4 a[40:43], v4, s[8:11], s86 offen offset:0 sc1
    v_exp_f32 v66, v42
    v_exp_f32 v67, v43
    v_smfmac_f32_32x32x32_bf16 v[48:63], v[80:83], v[32:39], v79
    s_mov_b64 exec, s[34:35]
    ds_read_b128 v[84:87], v3 offset:59520
    ds_read_b128 v[80:83], v3 offset:0
    s_mov_b64 exec, -1
    v_exp_f32 v68, v44
    v_exp_f32 v69, v45
    v_exp_f32 v70, v46
    v_exp_f32 v71, v47
    s_waitcnt lgkmcnt(2)
    v_mfma_f32_32x32x16_bf16 v[32:47], v[72:75], v[88:91], 0
    v_exp_f32 v16, v16
    v_exp_f32 v17, v17
    buffer_load_dwordx4 a[44:47], v4, s[8:11], s86 offen offset:1024 sc1
    v_exp_f32 v18, v18
    v_exp_f32 v19, v19
    s_waitcnt lgkmcnt(0)
    v_smfmac_f32_32x32x32_bf16 v[48:63], v[84:87], v[64:71], v79
    v_exp_f32 v20, v20
    v_exp_f32 v21, v21
    buffer_load_dwordx4 a[48:51], v4, s[8:11], s86 offen offset:2048 sc1
    v_exp_f32 v22, v22
    v_exp_f32 v23, v23
    v_mfma_f32_32x32x8_bf16 v[32:47], v[76:77], v[92:93], v[32:47]
    ds_read_b128 v[72:75], v1 offset:5120
    ds_read_b32 v76, v2 offset:5120
    v_exp_f32 v64, v24
    v_exp_f32 v65, v25
    v_exp_f32 v66, v26
    v_exp_f32 v67, v27
    v_smfmac_f32_32x32x32_bf16 v[48:63], v[80:83], v[16:23], v79
    s_mov_b64 exec, s[34:35]
    ds_read_b128 v[84:87], v3 offset:640
    ds_read_b128 v[80:83], v3 offset:2560
    s_mov_b64 exec, -1
    v_exp_f32 v68, v28
    v_exp_f32 v69, v29
    v_exp_f32 v70, v30
    v_exp_f32 v71, v31
    s_setprio 2
    s_waitcnt lgkmcnt(2)
    v_mfma_f32_32x32x16_bf16 v[16:31], v[72:75], v[88:91], 0
    v_exp_f32 v32, v32
    v_exp_f32 v33, v33
    buffer_load_dwordx4 a[52:55], v4, s[8:11], s86 offen offset:3072 sc1
    v_exp_f32 v34, v34
    v_exp_f32 v35, v35
    s_waitcnt lgkmcnt(0)
    v_smfmac_f32_32x32x32_bf16 v[48:63], v[84:87], v[64:71], v79
    v_exp_f32 v36, v36
    v_exp_f32 v37, v37
    v_exp_f32 v38, v38
    v_exp_f32 v39, v39
    v_mfma_f32_32x32x8_bf16 v[16:31], v[76:77], v[92:93], v[16:31]
    ds_read_b128 v[72:75], v1 offset:7680
    ds_read_b32 v76, v2 offset:7680
    v_exp_f32 v64, v40
    v_exp_f32 v65, v41
    v_exp_f32 v66, v42
    v_exp_f32 v67, v43
    v_smfmac_f32_32x32x32_bf16 v[48:63], v[80:83], v[32:39], v79
    s_mov_b64 exec, s[34:35]
    ds_read_b128 v[84:87], v3 offset:3200
    ds_read_b128 v[80:83], v3 offset:5120
    s_mov_b64 exec, -1
    v_exp_f32 v68, v44
    v_exp_f32 v69, v45
    v_exp_f32 v70, v46
    v_exp_f32 v71, v47
    s_waitcnt lgkmcnt(2)
    v_mfma_f32_32x32x16_bf16 v[32:47], v[72:75], v[88:91], 0
    v_exp_f32 v16, v16
    v_exp_f32 v17, v17
    s_add_u32 s86, s86, 4096
    buffer_load_dwordx4 a[56:59], v4, s[8:11], s86 offen offset:0 sc1
    v_exp_f32 v18, v18
    v_exp_f32 v19, v19
    s_waitcnt lgkmcnt(0)
    v_smfmac_f32_32x32x32_bf16 v[48:63], v[84:87], v[64:71], v79
    v_exp_f32 v20, v20
    v_exp_f32 v21, v21
    s_mul_i32 s27, s90, 128
    s_add_u32 s27, s27, 0x1580000
    s_cmp_lg_u32 s43, 0
    s_cselect_b32 s27, s27, 0x2000000
    s_bfm_b64 exec, 1, 0
    buffer_load_dword v111, v94, s[8:11], s27 offen
    s_mov_b64 exec, -1
    v_exp_f32 v22, v22
    v_exp_f32 v23, v23
    v_mfma_f32_32x32x8_bf16 v[32:47], v[76:77], v[92:93], v[32:47]
    ds_read_b128 v[72:75], v1 offset:10240
    ds_read_b32 v76, v2 offset:10240
    v_exp_f32 v64, v24
    v_exp_f32 v65, v25
    v_exp_f32 v66, v26
    v_exp_f32 v67, v27
    v_smfmac_f32_32x32x32_bf16 v[48:63], v[80:83], v[16:23], v79
    s_mov_b64 exec, s[34:35]
    ds_read_b128 v[84:87], v3 offset:5760
    ds_read_b128 v[80:83], v3 offset:7680
    s_mov_b64 exec, -1
    v_exp_f32 v68, v28
    v_exp_f32 v69, v29
    v_exp_f32 v70, v30
    v_exp_f32 v71, v31
    s_setprio 1
    s_waitcnt lgkmcnt(2)
    v_mfma_f32_32x32x16_bf16 v[16:31], v[72:75], v[88:91], 0
    v_exp_f32 v32, v32
    v_exp_f32 v33, v33
    s_add_u32 s86, s44, 15360
    buffer_load_dwordx4 a[60:63], v4, s[8:11], s86 offen offset:0 sc1
    v_exp_f32 v34, v34
    v_exp_f32 v35, v35
    s_waitcnt lgkmcnt(0)
    v_smfmac_f32_32x32x32_bf16 v[48:63], v[84:87], v[64:71], v79
    v_exp_f32 v36, v36
    v_exp_f32 v37, v37
    v_exp_f32 v38, v38
    v_exp_f32 v39, v39
    v_mfma_f32_32x32x8_bf16 v[16:31], v[76:77], v[92:93], v[16:31]
    ds_read_b128 v[72:75], v1 offset:12800
    ds_read_b32 v76, v2 offset:12800
    v_exp_f32 v64, v40
    v_exp_f32 v65, v41
    v_exp_f32 v66, v42
    v_exp_f32 v67, v43
    v_smfmac_f32_32x32x32_bf16 v[48:63], v[80:83], v[32:39], v79
    s_mov_b64 exec, s[34:35]
    ds_read_b128 v[84:87], v3 offset:8320
    ds_read_b128 v[80:83], v3 offset:10240
    s_mov_b64 exec, -1
    v_exp_f32 v68, v44
    v_exp_f32 v69, v45
    v_exp_f32 v70, v46
    v_exp_f32 v71, v47
    s_waitcnt lgkmcnt(2)
    v_mfma_f32_32x32x16_bf16 v[32:47], v[72:75], v[88:91], 0
    v_exp_f32 v16, v16
    v_exp_f32 v17, v17
    buffer_load_dwordx4 a[64:67], v4, s[8:11], s86 offen offset:1024 sc1
    v_exp_f32 v18, v18
    v_exp_f32 v19, v19
    s_waitcnt lgkmcnt(0)
    v_smfmac_f32_32x32x32_bf16 v[48:63], v[84:87], v[64:71], v79
    v_exp_f32 v20, v20
    v_exp_f32 v21, v21
    s_mov_b64 exec, 3
    global_load_dword v111, v99, s[88:89]
    s_mov_b64 exec, -1
    v_exp_f32 v22, v22
    v_exp_f32 v23, v23
    v_mfma_f32_32x32x8_bf16 v[32:47], v[76:77], v[92:93], v[32:47]
    ds_read_b128 v[72:75], v1 offset:15360
    ds_read_b32 v76, v2 offset:15360
    v_exp_f32 v64, v24
    v_exp_f32 v65, v25
    v_exp_f32 v66, v26
    v_exp_f32 v67, v27
    v_smfmac_f32_32x32x32_bf16 v[48:63], v[80:83], v[16:23], v79
    s_mov_b64 exec, s[34:35]
    ds_read_b128 v[84:87], v3 offset:10880
    ds_read_b128 v[80:83], v3 offset:12800
    s_mov_b64 exec, -1
    v_exp_f32 v68, v28
    v_exp_f32 v69, v29
    v_exp_f32 v70, v30
    v_exp_f32 v71, v31
    s_setprio 0
    s_waitcnt lgkmcnt(2)
    v_mfma_f32_32x32x16_bf16 v[16:31], v[72:75], v[88:91], 0
    v_exp_f32 v32, v32
    v_exp_f32 v33, v33
    buffer_load_dwordx4 a[68:71], v4, s[8:11], s86 offen offset:2048 sc1
    v_exp_f32 v34, v34
    v_exp_f32 v35, v35
    s_waitcnt lgkmcnt(0)
    v_smfmac_f32_32x32x32_bf16 v[48:63], v[84:87], v[64:71], v79
    v_exp_f32 v36, v36
    v_exp_f32 v37, v37
    v_exp_f32 v38, v38
    v_exp_f32 v39, v39
    v_mfma_f32_32x32x8_bf16 v[16:31], v[76:77], v[92:93], v[16:31]
    ds_read_b128 v[72:75], v1 offset:17920
    ds_read_b32 v76, v2 offset:17920
    v_exp_f32 v64, v40
    v_exp_f32 v65, v41
    v_exp_f32 v66, v42
    v_exp_f32 v67, v43
    v_smfmac_f32_32x32x32_bf16 v[48:63], v[80:83], v[32:39], v79
    s_mov_b64 exec, s[34:35]
    ds_read_b128 v[84:87], v3 offset:13440
    ds_read_b128 v[80:83], v3 offset:15360
    s_mov_b64 exec, -1
    v_exp_f32 v68, v44
    v_exp_f32 v69, v45
    v_exp_f32 v70, v46
    v_exp_f32 v71, v47
    s_waitcnt vmcnt(10)
    s_barrier
    s_setprio 3
    s_waitcnt lgkmcnt(2)
    v_mfma_f32_32x32x16_bf16 v[32:47], v[72:75], v[88:91], 0
    v_exp_f32 v16, v16
    v_exp_f32 v17, v17
    buffer_load_dwordx4 a[72:75], v4, s[8:11], s86 offen offset:3072 sc1
    v_exp_f32 v18, v18
    v_exp_f32 v19, v19
    s_waitcnt lgkmcnt(0)
    v_smfmac_f32_32x32x32_bf16 v[48:63], v[84:87], v[64:71], v79
    v_exp_f32 v20, v20
    v_exp_f32 v21, v21
    s_add_u32 s86, s86, 4096
    buffer_load_dwordx4 a[76:79], v4, s[8:11], s86 offen offset:0 sc1
    v_exp_f32 v22, v22
    v_exp_f32 v23, v23
    v_mfma_f32_32x32x8_bf16 v[32:47], v[76:77], v[92:93], v[32:47]
    ds_read_b128 v[72:75], v1 offset:20480
    ds_read_b32 v76, v2 offset:20480
    v_exp_f32 v64, v24
    v_exp_f32 v65, v25
    v_exp_f32 v66, v26
    v_exp_f32 v67, v27
    v_smfmac_f32_32x32x32_bf16 v[48:63], v[80:83], v[16:23], v79
    s_mov_b64 exec, s[34:35]
    ds_read_b128 v[84:87], v3 offset:16000
    ds_read_b128 v[80:83], v3 offset:17920
    s_mov_b64 exec, -1
    v_exp_f32 v68, v28
    v_exp_f32 v69, v29
    v_exp_f32 v70, v30
    v_exp_f32 v71, v31
    s_waitcnt lgkmcnt(2)
    v_mfma_f32_32x32x16_bf16 v[16:31], v[72:75], v[88:91], 0
    v_exp_f32 v32, v32
    v_exp_f32 v33, v33
    s_add_u32 s86, s44, 20480
    buffer_load_dwordx4 a[80:83], v4, s[8:11], s86 offen offset:0 sc1
    v_exp_f32 v34, v34
    v_exp_f32 v35, v35
    s_waitcnt lgkmcnt(0)
    v_smfmac_f32_32x32x32_bf16 v[48:63], v[84:87], v[64:71], v79
    v_exp_f32 v36, v36
    v_exp_f32 v37, v37
    v_exp_f32 v38, v38
    v_exp_f32 v39, v39
    v_mfma_f32_32x32x8_bf16 v[16:31], v[76:77], v[92:93], v[16:31]
    ds_read_b128 v[72:75], v1 offset:23040
    ds_read_b32 v76, v2 offset:23040
    v_exp_f32 v64, v40
    v_exp_f32 v65, v41
    v_exp_f32 v66, v42
    v_exp_f32 v67, v43
    v_smfmac_f32_32x32x32_bf16 v[48:63], v[80:83], v[32:39], v79
    s_mov_b64 exec, s[34:35]
    ds_read_b128 v[84:87], v3 offset:18560
    ds_read_b128 v[80:83], v3 offset:20480
    s_mov_b64 exec, -1
    v_exp_f32 v68, v44
    v_exp_f32 v69, v45
    v_exp_f32 v70, v46
    v_exp_f32 v71, v47
    s_waitcnt lgkmcnt(2)
    v_mfma_f32_32x32x16_bf16 v[32:47], v[72:75], v[88:91], 0
    v_exp_f32 v16, v16
    v_exp_f32 v17, v17
    buffer_load_dwordx4 a[84:87], v4, s[8:11], s86 offen offset:1024 sc1
    v_exp_f32 v18, v18
    v_exp_f32 v19, v19
    s_waitcnt lgkmcnt(0)
    v_smfmac_f32_32x32x32_bf16 v[48:63], v[84:87], v[64:71], v79
    v_exp_f32 v20, v20
    v_exp_f32 v21, v21
    v_exp_f32 v22, v22
    v_exp_f32 v23, v23
    v_mfma_f32_32x32x8_bf16 v[32:47], v[76:77], v[92:93], v[32:47]
    ds_read_b128 v[72:75], v1 offset:25600
    ds_read_b32 v76, v2 offset:25600
    v_exp_f32 v64, v24
    v_exp_f32 v65, v25
    v_exp_f32 v66, v26
    v_exp_f32 v67, v27
    v_smfmac_f32_32x32x32_bf16 v[48:63], v[80:83], v[16:23], v79
    s_mov_b64 exec, s[34:35]
    ds_read_b128 v[84:87], v3 offset:21120
    ds_read_b128 v[80:83], v3 offset:23040
    s_mov_b64 exec, -1
    v_exp_f32 v68, v28
    v_exp_f32 v69, v29
    v_exp_f32 v70, v30
    v_exp_f32 v71, v31
    s_waitcnt lgkmcnt(2)
    v_mfma_f32_32x32x16_bf16 v[16:31], v[72:75], v[88:91], 0
    v_exp_f32 v32, v32
    v_exp_f32 v33, v33
    buffer_load_dwordx4 a[88:91], v4, s[8:11], s86 offen offset:2048 sc1
    v_exp_f32 v34, v34
    v_exp_f32 v35, v35
    s_waitcnt lgkmcnt(0)
    v_smfmac_f32_32x32x32_bf16 v[48:63], v[84:87], v[64:71], v79
    v_exp_f32 v36, v36
    v_exp_f32 v37, v37
    v_exp_f32 v38, v38
    v_exp_f32 v39, v39
    v_mfma_f32_32x32x8_bf16 v[16:31], v[76:77], v[92:93], v[16:31]
    ds_read_b128 v[72:75], v1 offset:28160
    ds_read_b32 v76, v2 offset:28160
    v_exp_f32 v64, v40
    v_exp_f32 v65, v41
    v_exp_f32 v66, v42
    v_exp_f32 v67, v43
    v_smfmac_f32_32x32x32_bf16 v[48:63], v[80:83], v[32:39], v79
    s_mov_b64 exec, s[34:35]
    ds_read_b128 v[84:87], v3 offset:23680
    ds_read_b128 v[80:83], v3 offset:25600
    s_mov_b64 exec, -1
    v_exp_f32 v68, v44
    v_exp_f32 v69, v45
    v_exp_f32 v70, v46
    v_exp_f32 v71, v47
    s_waitcnt lgkmcnt(2)
    v_mfma_f32_32x32x16_bf16 v[32:47], v[72:75], v[88:91], 0
    v_exp_f32 v16, v16
    v_exp_f32 v17, v17
    buffer_load_dwordx4 a[92:95], v4, s[8:11], s86 offen offset:3072 sc1
    v_exp_f32 v18, v18
    v_exp_f32 v19, v19
    s_waitcnt lgkmcnt(0)
    v_smfmac_f32_32x32x32_bf16 v[48:63], v[84:87], v[64:71], v79
    v_exp_f32 v20, v20
    v_exp_f32 v21, v21
    v_exp_f32 v22, v22
    v_exp_f32 v23, v23
    v_mfma_f32_32x32x8_bf16 v[32:47], v[76:77], v[92:93], v[32:47]
    ds_read_b128 v[72:75], v1 offset:30720
    ds_read_b32 v76, v2 offset:30720
    v_exp_f32 v64, v24
    v_exp_f32 v65, v25
    v_exp_f32 v66, v26
    v_exp_f32 v67, v27
    v_smfmac_f32_32x32x32_bf16 v[48:63], v[80:83], v[16:23], v79
    s_mov_b64 exec, s[34:35]
    ds_read_b128 v[84:87], v3 offset:26240
    ds_read_b128 v[80:83], v3 offset:28160
    s_mov_b64 exec, -1
    v_exp_f32 v68, v28
    v_exp_f32 v69, v29
    v_exp_f32 v70, v30
    v_exp_f32 v71, v31
    s_setprio 2
    s_waitcnt lgkmcnt(2)
    v_mfma_f32_32x32x16_bf16 v[16:31], v[72:75], v[88:91], 0
    v_exp_f32 v32, v32
    v_exp_f32 v33, v33
    s_add_u32 s86, s86, 4096
    buffer_load_dwordx4 a[96:99], v4, s[8:11], s86 offen offset:0 sc1
    v_exp_f32 v34, v34
    v_exp_f32 v35, v35
    s_waitcnt lgkmcnt(0)
    v_smfmac_f32_32x32x32_bf16 v[48:63], v[84:87], v[64:71], v79
    v_exp_f32 v36, v36
    v_exp_f32 v37, v37
    v_exp_f32 v38, v38
    v_exp_f32 v39, v39
    v_mfma_f32_32x32x8_bf16 v[16:31], v[76:77], v[92:93], v[16:31]
    ds_read_b128 v[72:75], v1 offset:33280
    ds_read_b32 v76, v2 offset:33280
    v_exp_f32 v64, v40
    v_exp_f32 v65, v41
    v_exp_f32 v66, v42
    v_exp_f32 v67, v43
    v_smfmac_f32_32x32x32_bf16 v[48:63], v[80:83], v[32:39], v79
    s_mov_b64 exec, s[34:35]
    ds_read_b128 v[84:87], v3 offset:28800
    ds_read_b128 v[80:83], v3 offset:30720
    s_mov_b64 exec, -1
    v_exp_f32 v68, v44
    v_exp_f32 v69, v45
    v_exp_f32 v70, v46
    v_exp_f32 v71, v47
    s_waitcnt lgkmcnt(2)
    v_mfma_f32_32x32x16_bf16 v[32:47], v[72:75], v[88:91], 0
    v_exp_f32 v16, v16
    v_exp_f32 v17, v17
    v_exp_f32 v18, v18
    v_exp_f32 v19, v19
    s_waitcnt lgkmcnt(0)
    v_smfmac_f32_32x32x32_bf16 v[48:63], v[84:87], v[64:71], v79
    v_exp_f32 v20, v20
    v_exp_f32 v21, v21
    v_exp_f32 v22, v22
    v_exp_f32 v23, v23
    v_mfma_f32_32x32x8_bf16 v[32:47], v[76:77], v[92:93], v[32:47]
    ds_read_b128 v[72:75], v1 offset:35840
    ds_read_b32 v76, v2 offset:35840
    v_exp_f32 v64, v24
    v_exp_f32 v65, v25
    v_exp_f32 v66, v26
    v_exp_f32 v67, v27
    v_smfmac_f32_32x32x32_bf16 v[48:63], v[80:83], v[16:23], v79
    s_mov_b64 exec, s[34:35]
    ds_read_b128 v[84:87], v3 offset:31360
    ds_read_b128 v[80:83], v3 offset:33280
    s_mov_b64 exec, -1
    v_exp_f32 v68, v28
    v_exp_f32 v69, v29
    v_exp_f32 v70, v30
    v_exp_f32 v71, v31
    s_setprio 1
    s_waitcnt lgkmcnt(2)
    v_mfma_f32_32x32x16_bf16 v[16:31], v[72:75], v[88:91], 0
    v_exp_f32 v32, v32
    v_exp_f32 v33, v33
    v_exp_f32 v34, v34
    v_exp_f32 v35, v35
    s_waitcnt lgkmcnt(0)
    v_smfmac_f32_32x32x32_bf16 v[48:63], v[84:87], v[64:71], v79
    v_exp_f32 v36, v36
    v_exp_f32 v37, v37
    v_exp_f32 v38, v38
    v_exp_f32 v39, v39
    v_mfma_f32_32x32x8_bf16 v[16:31], v[76:77], v[92:93], v[16:31]
    ds_read_b128 v[72:75], v1 offset:38400
    ds_read_b32 v76, v2 offset:38400
    v_exp_f32 v64, v40
    v_exp_f32 v65, v41
    v_exp_f32 v66, v42
    v_exp_f32 v67, v43
    v_smfmac_f32_32x32x32_bf16 v[48:63], v[80:83], v[32:39], v79
    s_mov_b64 exec, s[34:35]
    ds_read_b128 v[84:87], v3 offset:33920
    ds_read_b128 v[80:83], v3 offset:35840
    s_mov_b64 exec, -1
    v_exp_f32 v68, v44
    v_exp_f32 v69, v45
    v_exp_f32 v70, v46
    v_exp_f32 v71, v47
    s_waitcnt lgkmcnt(2)
    v_mfma_f32_32x32x16_bf16 v[32:47], v[72:75], v[88:91], 0
    v_exp_f32 v16, v16
    v_exp_f32 v17, v17
    v_exp_f32 v18, v18
    v_exp_f32 v19, v19
    s_waitcnt lgkmcnt(0)
    v_smfmac_f32_32x32x32_bf16 v[48:63], v[84:87], v[64:71], v79
    v_exp_f32 v20, v20
    v_exp_f32 v21, v21
    v_exp_f32 v22, v22
    v_exp_f32 v23, v23
    v_mfma_f32_32x32x8_bf16 v[32:47], v[76:77], v[92:93], v[32:47]
    v_exp_f32 v64, v24
    v_exp_f32 v65, v25
    v_exp_f32 v66, v26
    v_exp_f32 v67, v27
    v_smfmac_f32_32x32x32_bf16 v[48:63], v[80:83], v[16:23], v79
    s_mov_b64 exec, s[34:35]
    ds_read_b128 v[84:87], v3 offset:36480
    ds_read_b128 v[80:83], v3 offset:38400
    s_mov_b64 exec, -1
    v_exp_f32 v68, v28
    v_exp_f32 v69, v29
    v_exp_f32 v70, v30
    v_exp_f32 v71, v31
    s_setprio 0
    v_exp_f32 v32, v32
    v_exp_f32 v33, v33
    v_exp_f32 v34, v34
    v_exp_f32 v35, v35
    s_waitcnt lgkmcnt(0)
    v_smfmac_f32_32x32x32_bf16 v[48:63], v[84:87], v[64:71], v79
    v_exp_f32 v36, v36
    v_exp_f32 v37, v37
    v_exp_f32 v38, v38
    v_exp_f32 v39, v39
    v_exp_f32 v64, v40
    v_exp_f32 v65, v41
    v_exp_f32 v66, v42
    v_exp_f32 v67, v43
    v_smfmac_f32_32x32x32_bf16 v[48:63], v[80:83], v[32:39], v79
    s_mov_b64 exec, s[34:35]
    ds_read_b128 v[84:87], v3 offset:39040
    s_mov_b64 exec, -1
    v_exp_f32 v68, v44
    v_exp_f32 v69, v45
    v_exp_f32 v70, v46
    v_exp_f32 v71, v47
    s_waitcnt lgkmcnt(0)
    s_nop 0
    v_smfmac_f32_32x32x32_bf16 v[48:63], v[84:87], v[64:71], v79
L_post_attn:
    s_setprio 0
    s_nop 10
    v_rcp_f32 v8, v58
    v_max3_f32 v9, abs(v48), abs(v49), abs(v50)
    v_cmp_le_f32 vcc, s92, v58
    v_cmp_ge_f32 s[52:53], s93, v58
    v_max3_f32 v9, v9, abs(v51), abs(v52)
    v_max3_f32 v9, v9, abs(v53), abs(v54)
    v_max3_f32 v9, v9, abs(v55), abs(v56)
    v_max_f32_e64 v9, v9, abs(v57)
    s_and_b64 vcc, vcc, s[52:53]
    v_cmp_ge_f32 s[54:55], s94, v9
    v_mul_f32 v24, v8, v56
    v_mul_f32 v25, v8, v57
    v_mul_f32 v16, v8, v48
    v_mul_f32 v17, v8, v49
    v_mul_f32 v18, v8, v50
    v_mul_f32 v19, v8, v51
    v_mul_f32 v20, v8, v52
    v_mul_f32 v21, v8, v53
    v_mul_f32 v22, v8, v54
    v_mul_f32 v23, v8, v55
    s_and_b64 vcc, vcc, s[54:55]
    s_cmp_eq_u64 vcc, -1
    s_cbranch_scc0 L_attn_slow
L_attn_norm:
    v_cvt_pk_bf16_f32 v26, v24, v25
    v_cvt_pk_bf16_f32 v27, v24, v25
    v_cvt_pk_bf16_f32 v16, v16, v17
    v_cvt_pk_bf16_f32 v17, v18, v19
    v_cvt_pk_bf16_f32 v18, v20, v21
    v_cvt_pk_bf16_f32 v19, v22, v23
    v_permlane32_swap_b32 v26, v27
    buffer_store_dwordx4 v[16:19], v14, s[8:11], 0 offen sc1
    s_mov_b32 exec_hi, 0
    buffer_store_dwordx2 v[26:27], v15, s[8:11], 0 offen sc1
    s_mov_b32 exec_hi, -1
    v_and_b32 v12, 15, v0
    v_lshrrev_b32 v11, 5, v0
    v_lshlrev_b32 v9, 4, v12
    v_lshl_add_u32 v9, v11, 8, v9
    v_lshrrev_b32 v13, 4, v0
    v_lshlrev_b32 v13, 8, v13
    v_lshl_add_u32 v7, v12, 3, v13
    v_add_u32 v7, 4096, v7
    s_lshr_b32 s29, s24, 2
    s_mul_i32 s28, s95, 5120
    s_add_u32 s28, s28, 0x780000
    s_add_u32 s96, s51, s41
    s_xor_b32 s49, s96, 1
    s_mul_i32 s49, s49, 20480
    s_add_u32 s49, s49, s28
    s_mul_i32 s96, s96, 20480
    s_add_u32 s96, s96, s28
    s_xor_b32 s27, s51, 1
    s_mul_i32 s27, s27, 5120
    s_add_u32 s27, s27, 98432
    v_add_u32 v3, s27, v4
    s_mul_i32 s27, s51, 5120
    s_add_u32 s27, s27, 98432
    v_add_u32 v6, s27, v4
    s_add_u32 s27, s51, s41
    s_lshl_b32 s30, s27, 11
    s_mul_i32 s27, s27, 20480
    s_mul_i32 s28, s40, 2560
    s_add_u32 s27, s27, s28
    s_add_u32 s27, s27, 0xa00000
    v_add_u32 v9, 2048, v9
    v_add_u32 v109, s27, v9
    s_lshl_b32 s28, s29, 10
    s_add_u32 s27, s27, s28
    v_add_u32 v108, s27, v4
    s_lshl_b32 s28, s40, 1
    s_add_u32 s28, s28, s29
    s_lshl_b32 s28, s28, 7
    s_add_u32 s30, s30, s28
    s_add_u32 s30, s30, 0x1580000
    s_mul_i32 s27, s51, 5120
    s_and_b32 s28, s24, 4
    s_lshl_b32 s28, s28, 9
    s_add_u32 s27, s27, s28
    s_add_u32 s27, s27, 98432
    v_add_u32 v5, s27, v4
    s_and_b32 s33, s41, -8
    s_lshl_b32 s27, s51, 1
    s_add_u32 s33, s33, s27
    s_mul_i32 s38, s33, 20480
    s_add_u32 s38, s38, 0xa00000
    s_lshl_b32 s39, s51, 12
    s_add_u32 s90, s38, 20480
    s_lshl_b32 s27, s91, 11
    s_add_u32 s38, s38, s27
    s_bfe_u32 s27, s40, 0x00001
    s_xor_b32 s27, s27, 0
    s_lshl_b32 s27, s27, 10
    v_add_u32 v10, s27, v4
    s_bfe_u32 s27, s40, 0x00001
    s_xor_b32 s27, s27, 1
    s_lshl_b32 s27, s27, 10
    v_add_u32 v11, s27, v4
    s_bfe_u32 s27, s40, 0x00001
    s_xor_b32 s27, s27, 2
    s_lshl_b32 s27, s27, 10
    v_add_u32 v12, s27, v4
    s_bfe_u32 s27, s40, 0x00001
    s_xor_b32 s27, s27, 3
    s_lshl_b32 s27, s27, 10
    v_add_u32 v13, s27, v4
    s_waitcnt vmcnt(0)
    s_barrier
    s_cmp_lg_u32 s24, 0
    s_cbranch_scc1 L_sy_7
    s_lshl_b32 s27, s26, 2
    s_add_u32 s27, s27, s48
    v_mov_b32 v8, 1
    v_mov_b32 v9, 0
    s_mov_b64 exec, 1
    buffer_store_dword v8, v9, s[8:11], s100 offen sc1
    s_mov_b32 exec_lo, -1
    v_lshlrev_b32 v9, 7, v0
    s_mov_b32 s28, 0
    s_lshl_b32 s27, s25, 12
    s_add_u32 s27, s27, 0x15c2000
L_poll_8:
    s_sleep 4
    buffer_load_dword v8, v9, s[8:11], s27 offen sc1
    s_add_u32 s28, s28, 1
    s_waitcnt vmcnt(0)
    v_cmp_eq_u32 vcc, 0, v8
    s_cmp_lt_u32 s28, 0x40000
    s_cselect_b64 vcc, vcc, 0
    s_cbranch_vccnz L_poll_8
    s_mov_b64 exec, -1
L_sy_7:
    s_barrier
    buffer_load_dwordx2 v[32:33], v7, s[8:11], s49 offen offset:0 sc1
    buffer_load_dwordx2 v[34:35], v7, s[8:11], s49 offen offset:128 sc1
    buffer_load_dwordx4 v[16:19], v10, s[8:11], s49 offen sc1
    buffer_load_dwordx4 v[20:23], v11, s[8:11], s49 offen sc1
    buffer_load_dwordx4 v[24:27], v12, s[8:11], s49 offen sc1
    s_cmp_ge_u32 s24, 4
    s_cbranch_scc1 L_gu_loader
    s_waitcnt vmcnt(3)
    buffer_load_dwordx4 v[28:31], v13, s[8:11], s49 offen sc1
    v_mfma_f32_16x16x32_bf16 v[64:67], a[88:91], v[32:35], 0
    v_mfma_f32_16x16x32_bf16 v[68:71], a[92:95], v[32:35], 0
    v_mfma_f32_16x16x32_bf16 v[56:59], a[80:83], v[32:35], 0
    v_mfma_f32_16x16x32_bf16 v[60:63], a[84:87], v[32:35], 0
    v_mfma_f32_16x16x32_bf16 v[72:75], a[96:99], v[32:35], 0
    s_waitcnt vmcnt(3)
    buffer_load_dwordx2 v[52:53], v7, s[8:11], s96 offen offset:0 sc1
    buffer_load_dwordx2 v[54:55], v7, s[8:11], s96 offen offset:128 sc1
    v_mfma_f32_16x16x32_bf16 v[64:67], a[8:11], v[16:19], v[64:67]
    v_mfma_f32_16x16x32_bf16 v[68:71], a[12:15], v[16:19], v[68:71]
    v_mfma_f32_16x16x32_bf16 v[56:59], a[0:3], v[16:19], v[56:59]
    v_mfma_f32_16x16x32_bf16 v[60:63], a[4:7], v[16:19], v[60:63]
    v_mfma_f32_16x16x32_bf16 v[72:75], a[16:19], v[16:19], v[72:75]
    s_waitcnt vmcnt(4)
    buffer_load_dwordx4 v[36:39], v10, s[8:11], s96 offen sc1
    v_mfma_f32_16x16x32_bf16 v[64:67], a[28:31], v[20:23], v[64:67]
    v_mfma_f32_16x16x32_bf16 v[68:71], a[32:35], v[20:23], v[68:71]
    v_mfma_f32_16x16x32_bf16 v[56:59], a[20:23], v[20:23], v[56:59]
    v_mfma_f32_16x16x32_bf16 v[60:63], a[24:27], v[20:23], v[60:63]
    v_mfma_f32_16x16x32_bf16 v[72:75], a[36:39], v[20:23], v[72:75]
    s_waitcnt vmcnt(4)
    buffer_load_dwordx4 v[40:43], v11, s[8:11], s96 offen sc1
    v_mfma_f32_16x16x32_bf16 v[64:67], a[48:51], v[24:27], v[64:67]
    v_mfma_f32_16x16x32_bf16 v[68:71], a[52:55], v[24:27], v[68:71]
    v_mfma_f32_16x16x32_bf16 v[56:59], a[40:43], v[24:27], v[56:59]
    v_mfma_f32_16x16x32_bf16 v[60:63], a[44:47], v[24:27], v[60:63]
    v_mfma_f32_16x16x32_bf16 v[72:75], a[56:59], v[24:27], v[72:75]
    s_waitcnt vmcnt(4)
    buffer_load_dwordx4 v[44:47], v12, s[8:11], s96 offen sc1
    v_mfma_f32_16x16x32_bf16 v[64:67], a[68:71], v[28:31], v[64:67]
    v_mfma_f32_16x16x32_bf16 v[68:71], a[72:75], v[28:31], v[68:71]
    v_mfma_f32_16x16x32_bf16 v[56:59], a[60:63], v[28:31], v[56:59]
    v_mfma_f32_16x16x32_bf16 v[60:63], a[64:67], v[28:31], v[60:63]
    v_mfma_f32_16x16x32_bf16 v[72:75], a[76:79], v[28:31], v[72:75]
    s_waitcnt vmcnt(3)
    buffer_load_dwordx4 v[48:51], v13, s[8:11], s96 offen sc1
    v_mfma_f32_16x16x32_bf16 v[84:87], a[88:91], v[52:55], 0
    v_mfma_f32_16x16x32_bf16 v[88:91], a[92:95], v[52:55], 0
    v_mfma_f32_16x16x32_bf16 v[76:79], a[80:83], v[52:55], 0
    v_mfma_f32_16x16x32_bf16 v[80:83], a[84:87], v[52:55], 0
    v_mfma_f32_16x16x32_bf16 v[92:95], a[96:99], v[52:55], 0
    ds_write_b128 v3, v[64:67] offset:43008
    s_waitcnt vmcnt(3)
    v_mfma_f32_16x16x32_bf16 v[84:87], a[8:11], v[36:39], v[84:87]
    v_mfma_f32_16x16x32_bf16 v[88:91], a[12:15], v[36:39], v[88:91]
    v_mfma_f32_16x16x32_bf16 v[76:79], a[0:3], v[36:39], v[76:79]
    v_mfma_f32_16x16x32_bf16 v[80:83], a[4:7], v[36:39], v[80:83]
    v_mfma_f32_16x16x32_bf16 v[92:95], a[16:19], v[36:39], v[92:95]
    ds_write_b128 v3, v[68:71] offset:44032
    s_waitcnt vmcnt(2)
    v_mfma_f32_16x16x32_bf16 v[84:87], a[28:31], v[40:43], v[84:87]
    v_mfma_f32_16x16x32_bf16 v[88:91], a[32:35], v[40:43], v[88:91]
    v_mfma_f32_16x16x32_bf16 v[76:79], a[20:23], v[40:43], v[76:79]
    v_mfma_f32_16x16x32_bf16 v[80:83], a[24:27], v[40:43], v[80:83]
    v_mfma_f32_16x16x32_bf16 v[92:95], a[36:39], v[40:43], v[92:95]
    ds_write_b128 v3, v[56:59] offset:20480
    s_waitcnt vmcnt(1)
    v_mfma_f32_16x16x32_bf16 v[84:87], a[48:51], v[44:47], v[84:87]
    v_mfma_f32_16x16x32_bf16 v[88:91], a[52:55], v[44:47], v[88:91]
    v_mfma_f32_16x16x32_bf16 v[76:79], a[40:43], v[44:47], v[76:79]
    v_mfma_f32_16x16x32_bf16 v[80:83], a[44:47], v[44:47], v[80:83]
    v_mfma_f32_16x16x32_bf16 v[92:95], a[56:59], v[44:47], v[92:95]
    ds_write_b128 v3, v[60:63] offset:21504
    s_waitcnt vmcnt(0)
    v_mfma_f32_16x16x32_bf16 v[84:87], a[68:71], v[48:51], v[84:87]
    v_mfma_f32_16x16x32_bf16 v[88:91], a[72:75], v[48:51], v[88:91]
    v_mfma_f32_16x16x32_bf16 v[76:79], a[60:63], v[48:51], v[76:79]
    v_mfma_f32_16x16x32_bf16 v[80:83], a[64:67], v[48:51], v[80:83]
    v_mfma_f32_16x16x32_bf16 v[92:95], a[76:79], v[48:51], v[92:95]
    ds_write_b128 v3, v[72:75] offset:24576
    s_nop 2
    ds_write_b128 v6, v[84:87] offset:2048
    ds_write_b128 v6, v[88:91] offset:3072
    s_add_u32 s27, s45, 10240
    buffer_load_dwordx4 a[80:83], v4, s[8:11], s27 offen sc1
    s_add_u32 s27, s45, 11264
    buffer_load_dwordx4 a[84:87], v4, s[8:11], s27 offen sc1
    s_add_u32 s27, s45, 12288
    buffer_load_dwordx4 a[88:91], v4, s[8:11], s27 offen sc1
    s_add_u32 s27, s45, 13312
    buffer_load_dwordx4 a[92:95], v4, s[8:11], s27 offen sc1
    s_waitcnt lgkmcnt(0)
    s_barrier
    ds_read_b128 v[16:19], v5 offset:0
    ds_read_b128 v[20:23], v5 offset:1024
    ds_read_b128 v[24:27], v5 offset:4096
    ds_read_b128 v[28:31], v5 offset:20480
    ds_read_b128 v[32:35], v5 offset:21504
    ds_read_b128 v[36:39], v5 offset:24576
    ds_read_b128 v[40:43], v5 offset:40960
    ds_read_b128 v[44:47], v5 offset:41984
    ds_read_b128 v[48:51], v5 offset:45056
    s_add_u32 s27, s45, 14336
    buffer_load_dwordx4 a[96:99], v4, s[8:11], s27 offen sc1
    v_lshlrev_b32 v56, 16, v100
    v_and_b32 v57, 0xffff0000, v100
    v_lshlrev_b32 v58, 16, v101
    v_and_b32 v59, 0xffff0000, v101
    v_lshlrev_b32 v60, 16, v102
    v_and_b32 v61, 0xffff0000, v102
    v_lshlrev_b32 v62, 16, v103
    v_and_b32 v63, 0xffff0000, v103
    v_lshlrev_b32 v64, 16, v104
    v_and_b32 v65, 0xffff0000, v104
    v_lshlrev_b32 v66, 16, v105
    v_and_b32 v67, 0xffff0000, v105
    v_pk_add_f32 v[76:77], v[76:77], v[56:57]
    v_pk_add_f32 v[78:79], v[78:79], v[58:59]
    v_pk_add_f32 v[80:81], v[80:81], v[60:61]
    v_pk_add_f32 v[82:83], v[82:83], v[62:63]
    v_pk_add_f32 v[92:93], v[92:93], v[64:65]
    v_pk_add_f32 v[94:95], v[94:95], v[66:67]
    v_mov_b32 v10, 0x3f803f80
    v_lshlrev_b32 v11, 3, v0
    s_waitcnt lgkmcnt(6)
    v_pk_add_f32 v[76:77], v[76:77], v[16:17]
    v_pk_add_f32 v[78:79], v[78:79], v[18:19]
    v_pk_add_f32 v[80:81], v[80:81], v[20:21]
    v_pk_add_f32 v[82:83], v[82:83], v[22:23]
    v_pk_add_f32 v[92:93], v[92:93], v[24:25]
    v_pk_add_f32 v[94:95], v[94:95], v[26:27]
    s_waitcnt lgkmcnt(3)
    v_pk_add_f32 v[76:77], v[76:77], v[28:29]
    v_pk_add_f32 v[78:79], v[78:79], v[30:31]
    v_pk_add_f32 v[80:81], v[80:81], v[32:33]
    v_pk_add_f32 v[82:83], v[82:83], v[34:35]
    v_pk_add_f32 v[92:93], v[92:93], v[36:37]
    v_pk_add_f32 v[94:95], v[94:95], v[38:39]
    s_waitcnt lgkmcnt(0)
    v_pk_add_f32 v[76:77], v[76:77], v[40:41]
    v_pk_add_f32 v[78:79], v[78:79], v[42:43]
    v_pk_add_f32 v[80:81], v[80:81], v[44:45]
    v_pk_add_f32 v[82:83], v[82:83], v[46:47]
    v_pk_add_f32 v[92:93], v[92:93], v[48:49]
    v_pk_add_f32 v[94:95], v[94:95], v[50:51]
    v_cvt_pk_bf16_f32 v16, v76, v77
    v_cvt_pk_bf16_f32 v17, v78, v79
    v_cvt_pk_bf16_f32 v18, v80, v81
    v_cvt_pk_bf16_f32 v19, v82, v83
    s_cmp_lg_u32 s43, 0
    s_cbranch_scc1 L_stf_9
    buffer_store_dwordx4 v[16:19], v108, s[8:11], 0 offen sc1
    s_branch L_ste_10
L_stf_9:
    buffer_store_dwordx4 v[16:19], v108, s[8:11], 0 offen
L_ste_10:
    v_cvt_pk_bf16_f32 v28, v92, v93
    v_cvt_pk_bf16_f32 v29, v94, v95
    v_cvt_pk_bf16_f32 v30, v92, v93
    v_cvt_pk_bf16_f32 v31, v94, v95
    v_cvt_pk_bf16_f32 v20, v92, v93
    v_cvt_pk_bf16_f32 v21, v94, v95
    v_permlane16_swap_b32 v28, v30
    v_permlane16_swap_b32 v29, v31
    s_cmp_lg_u32 s43, 0
    s_cbranch_scc1 L_stf_11
    s_mov_b32 exec_lo, 0xffff
    s_mov_b32 exec_hi, 0xffff
    buffer_store_dwordx4 v[28:31], v109, s[8:11], 0 offen sc1
    s_mov_b64 exec, -1
    s_branch L_ste_12
L_stf_11:
    s_mov_b32 exec_lo, 0xffff
    s_mov_b32 exec_hi, 0xffff
    buffer_store_dwordx4 v[28:31], v109, s[8:11], 0 offen
    s_mov_b64 exec, -1
L_ste_12:
    v_dot2_f32_bf16 v24, v16, v10, 0
    v_dot2_f32_bf16 v25, v16, v16, 0
    v_dot2_f32_bf16 v24, v17, v10, v24
    v_dot2_f32_bf16 v25, v17, v17, v25
    v_dot2_f32_bf16 v24, v18, v10, v24
    v_dot2_f32_bf16 v25, v18, v18, v25
    v_dot2_f32_bf16 v24, v19, v10, v24
    v_dot2_f32_bf16 v25, v19, v19, v25
    v_dot2_f32_bf16 v24, v20, v10, v24
    v_dot2_f32_bf16 v25, v20, v20, v25
    v_dot2_f32_bf16 v24, v21, v10, v24
    v_dot2_f32_bf16 v25, v21, v21, v25
    v_accvgpr_write_b32 a140, v16
    v_accvgpr_write_b32 a141, v17
    v_accvgpr_write_b32 a142, v18
    v_mov_b32 v8, v24
    v_mov_b32 v9, v25
    s_nop 0
    v_permlane16_swap_b32 v24, v8
    v_permlane16_swap_b32 v25, v9
    v_pk_add_f32 v[24:25], v[24:25], v[8:9]
    v_mov_b32 v8, v24
    v_mov_b32 v9, v25
    s_nop 0
    v_permlane32_swap_b32 v24, v8
    v_permlane32_swap_b32 v25, v9
    v_pk_add_f32 v[24:25], v[24:25], v[8:9]
    s_mov_b64 exec, 0xffff
    s_cmp_lg_u32 s43, 0
    s_cbranch_scc1 L_stf_13
    buffer_store_dwordx2 v[24:25], v11, s[8:11], s30 offen sc1
    s_branch L_ste_14
L_stf_13:
    buffer_store_dwordx2 v[24:25], v11, s[8:11], s30 offen
L_ste_14:
    s_mov_b64 exec, -1
    v_accvgpr_write_b32 a143, v19
    v_accvgpr_write_b32 a58, v20
    v_accvgpr_write_b32 a59, v21
    v_bfe_u32 v10, v0, 4, 1
    v_lshrrev_b32 v11, 5, v0
    s_and_b32 s36, s24, 1
    s_lshr_b32 s37, s24, 1
    v_lshrrev_b32 v8, 4, v0
    v_bfe_u32 v9, v0, 2, 2
    v_lshl_add_u32 v8, v8, 3, v9
    v_mul_u32_u24 v8, 192, v8
    v_and_b32 v9, 3, v0
    v_lshl_add_u32 v8, v9, 3, v8
    s_mul_i32 s28, s36, 6144
    s_mul_i32 s27, s37, 3
    s_add_u32 s27, s27, 0
    v_xor_b32 v9, s27, v10
    v_lshl_add_u32 v9, v9, 5, v8
    v_add_u32 v1, s28, v9
    v_subrev_u32 v5, s28, v9
    s_mul_i32 s27, s37, 3
    s_add_u32 s27, s27, 1
    v_xor_b32 v9, s27, v10
    v_lshl_add_u32 v9, v9, 5, v8
    v_add_u32 v2, s28, v9
    v_subrev_u32 v6, s28, v9
    s_mul_i32 s27, s37, 3
    s_add_u32 s27, s27, 2
    v_xor_b32 v9, s27, v10
    v_lshl_add_u32 v9, v9, 5, v8
    v_add_u32 v3, s28, v9
    v_subrev_u32 v7, s28, v9
    v_mov_b32 v8, 0x3f803f80
    v_accvgpr_write_b32 a48, v8
    v_accvgpr_write_b32 a49, v8
    v_accvgpr_write_b32 a50, v8
    v_accvgpr_write_b32 a51, v8
    s_mul_i32 s27, s36, 9216
    s_add_u32 s27, s27, 98432
    v_add_u32 v12, s27, v4
    s_mul_i32 s27, s36, 7168
    s_add_u32 s27, s27, 98432
    v_add_u32 v13, s27, v4
    v_and_b32 v8, 15, v0
    v_lshlrev_b32 v8, 4, v8
    v_lshl_add_u32 v8, v11, 8, v8
    v_lshl_add_u32 v14, v10, 9, v8
    v_mul_u32_u24 v9, 49152, v10
    v_add3_u32 v15, v8, v9, 0
    ds_read_b64_tr_b16 a[32:33], v1 offset:0
    ds_read_b64_tr_b16 a[34:35], v1 offset:768
    ds_read_b64_tr_b16 a[36:37], v1 offset:12320
    ds_read_b64_tr_b16 a[38:39], v1 offset:13088
    ds_read_b64_tr_b16 a[40:41], v2 offset:0
    ds_read_b64_tr_b16 a[42:43], v2 offset:768
    s_waitcnt vmcnt(0)
    s_barrier
    s_cmp_lg_u32 s24, 0
    s_cbranch_scc1 L_sy_15
    s_lshl_b32 s27, s26, 2
    s_add_u32 s27, s27, s48
    v_mov_b32 v8, 1
    v_mov_b32 v9, 0
    s_mov_b64 exec, 1
    s_cmp_lg_u32 s43, 0
    s_cbranch_scc1 L_stf_17
    buffer_store_dword v8, v9, s[8:11], s27 offen offset:128 sc1
    s_branch L_ste_18
L_stf_17:
    buffer_store_dword v8, v9, s[8:11], s27 offen offset:128
L_ste_18:
    s_and_b32 s27, s26, 2
    s_lshl_b32 s27, 0x33333333, s27
    s_mov_b32 exec_lo, s27
    v_lshlrev_b32 v9, 2, v0
    s_mov_b32 s28, 0
L_poll_16:
    buffer_load_dword v8, v9, s[8:11], s48 offen offset:128 sc1
    s_add_u32 s28, s28, 1
    s_waitcnt vmcnt(0)
    v_cmp_eq_u32 vcc, 0, v8
    s_cmp_lt_u32 s28, 0x40000
    s_cselect_b64 vcc, vcc, 0
    s_cbranch_vccnz L_poll_16
    s_mov_b64 exec, -1
L_sy_15:
    s_barrier
    s_add_u32 m0, s39, 98432
    s_add_u32 s27, s38, 0
    buffer_load_dwordx4 v4, s[8:11], s27 offen sc1 lds
    s_add_u32 m0, s39, 99456
    s_add_u32 s27, s38, 1024
    buffer_load_dwordx4 v4, s[8:11], s27 offen sc1 lds
    s_waitcnt vmcnt(0)
    s_barrier
    ds_read_b128 a[0:3], v12 offset:0
    ds_read_b128 a[4:7], v12 offset:2048
    ds_read_b128 a[8:11], v12 offset:4096
    ds_read_b128 a[12:15], v12 offset:6144
    s_waitcnt lgkmcnt(0)
    v_mfma_f32_16x16x32_bf16 a[52:55], a[48:51], a[32:35], 0
    ds_read_b64_tr_b16 a[44:45], v2 offset:12320
    v_mfma_f32_16x16x32_bf16 v[16:19], a[32:35], a[0:3], 0
    ds_read_b64_tr_b16 a[46:47], v2 offset:13088
    v_mfma_f32_16x16x32_bf16 v[40:43], a[32:35], a[4:7], 0
    v_mfma_f32_16x16x32_bf16 v[64:67], a[32:35], a[8:11], 0
    v_mfma_f32_16x16x32_bf16 v[88:91], a[32:35], a[12:15], 0
    s_waitcnt lgkmcnt(8)
    v_mfma_f32_16x16x32_bf16 a[60:63], a[48:51], a[36:39], 0
    ds_read_b64_tr_b16 a[32:33], v3 offset:0
    v_mfma_f32_16x16x32_bf16 v[20:23], a[36:39], a[0:3], 0
    ds_read_b64_tr_b16 a[34:35], v3 offset:768
    v_mfma_f32_16x16x32_bf16 v[44:47], a[36:39], a[4:7], 0
    ds_read_b128 a[16:19], v13 offset:1024
    v_mfma_f32_16x16x32_bf16 v[68:71], a[36:39], a[8:11], 0
    v_mfma_f32_16x16x32_bf16 v[92:95], a[36:39], a[12:15], 0
    s_waitcnt lgkmcnt(9)
    v_mfma_f32_16x16x32_bf16 a[64:67], a[48:51], a[40:43], 0
    ds_read_b64_tr_b16 a[36:37], v3 offset:12320
    v_mfma_f32_16x16x32_bf16 v[24:27], a[40:43], a[0:3], 0
    ds_read_b64_tr_b16 a[38:39], v3 offset:13088
    v_mfma_f32_16x16x32_bf16 v[48:51], a[40:43], a[4:7], 0
    ds_read_b128 a[20:23], v13 offset:3072
    v_mfma_f32_16x16x32_bf16 v[72:75], a[40:43], a[8:11], 0
    v_mfma_f32_16x16x32_bf16 v[96:99], a[40:43], a[12:15], 0
    s_waitcnt lgkmcnt(6)
    v_mfma_f32_16x16x32_bf16 a[68:71], a[48:51], a[44:47], 0
    ds_read_b64_tr_b16 a[40:41], v5 offset:6144
    v_mfma_f32_16x16x32_bf16 v[28:31], a[44:47], a[0:3], 0
    ds_read_b64_tr_b16 a[42:43], v5 offset:6912
    v_mfma_f32_16x16x32_bf16 v[52:55], a[44:47], a[4:7], 0
    ds_read_b128 a[24:27], v13 offset:5120
    v_mfma_f32_16x16x32_bf16 v[76:79], a[44:47], a[8:11], 0
    v_mfma_f32_16x16x32_bf16 v[100:103], a[44:47], a[12:15], 0
    s_waitcnt lgkmcnt(7)
    v_mfma_f32_16x16x32_bf16 a[72:75], a[48:51], a[32:35], 0
    ds_read_b64_tr_b16 a[44:45], v5 offset:18464
    v_mfma_f32_16x16x32_bf16 v[32:35], a[32:35], a[0:3], 0
    ds_read_b64_tr_b16 a[46:47], v5 offset:19232
    v_mfma_f32_16x16x32_bf16 v[56:59], a[32:35], a[4:7], 0
    ds_read_b128 a[28:31], v13 offset:7168
    v_mfma_f32_16x16x32_bf16 v[80:83], a[32:35], a[8:11], 0
    v_mfma_f32_16x16x32_bf16 v[104:107], a[32:35], a[12:15], 0
    s_waitcnt lgkmcnt(7)
    v_mfma_f32_16x16x32_bf16 a[76:79], a[48:51], a[36:39], 0
    ds_read_b64_tr_b16 a[32:33], v6 offset:6144
    v_mfma_f32_16x16x32_bf16 v[36:39], a[36:39], a[0:3], 0
    ds_read_b64_tr_b16 a[34:35], v6 offset:6912
    v_mfma_f32_16x16x32_bf16 v[60:63], a[36:39], a[4:7], 0
    v_mfma_f32_16x16x32_bf16 v[84:87], a[36:39], a[8:11], 0
    v_mfma_f32_16x16x32_bf16 v[108:111], a[36:39], a[12:15], 0
    s_waitcnt lgkmcnt(2)
    v_mfma_f32_16x16x32_bf16 v[16:19], a[40:43], a[16:19], v[16:19]
    ds_read_b64_tr_b16 a[36:37], v6 offset:18464
    v_mfma_f32_16x16x32_bf16 v[40:43], a[40:43], a[20:23], v[40:43]
    ds_read_b64_tr_b16 a[38:39], v6 offset:19232
    v_mfma_f32_16x16x32_bf16 v[64:67], a[40:43], a[24:27], v[64:67]
    v_mfma_f32_16x16x32_bf16 v[88:91], a[40:43], a[28:31], v[88:91]
    s_waitcnt lgkmcnt(5)
    v_mfma_f32_16x16x32_bf16 v[20:23], a[44:47], a[16:19], v[20:23]
    ds_read_b64_tr_b16 a[40:41], v7 offset:6144
    v_mfma_f32_16x16x32_bf16 v[44:47], a[44:47], a[20:23], v[44:47]
    ds_read_b64_tr_b16 a[42:43], v7 offset:6912
    v_mfma_f32_16x16x32_bf16 v[68:71], a[44:47], a[24:27], v[68:71]
    v_mfma_f32_16x16x32_bf16 v[92:95], a[44:47], a[28:31], v[92:95]
    s_waitcnt lgkmcnt(4)
    v_mfma_f32_16x16x32_bf16 v[24:27], a[32:35], a[16:19], v[24:27]
    ds_read_b64_tr_b16 a[44:45], v7 offset:18464
    v_mfma_f32_16x16x32_bf16 v[48:51], a[32:35], a[20:23], v[48:51]
    ds_read_b64_tr_b16 a[46:47], v7 offset:19232
    v_mfma_f32_16x16x32_bf16 v[72:75], a[32:35], a[24:27], v[72:75]
    v_mfma_f32_16x16x32_bf16 v[96:99], a[32:35], a[28:31], v[96:99]
    s_waitcnt lgkmcnt(4)
    s_barrier
    v_add_u32 v1, 24608, v1
    v_add_u32 v2, 24608, v2
    v_add_u32 v3, 24608, v3
    v_mfma_f32_16x16x32_bf16 v[28:31], a[36:39], a[16:19], v[28:31]
    ds_read_b64_tr_b16 a[32:33], v1 offset:0
    v_mfma_f32_16x16x32_bf16 v[52:55], a[36:39], a[20:23], v[52:55]
    ds_read_b64_tr_b16 a[34:35], v1 offset:768
    v_mfma_f32_16x16x32_bf16 v[76:79], a[36:39], a[24:27], v[76:79]
    ds_read_b128 a[0:3], v12 offset:16384
    v_mfma_f32_16x16x32_bf16 v[100:103], a[36:39], a[28:31], v[100:103]
    ds_read_b128 a[4:7], v12 offset:18432
    s_waitcnt lgkmcnt(6)
    v_mfma_f32_16x16x32_bf16 v[32:35], a[40:43], a[16:19], v[32:35]
    ds_read_b64_tr_b16 a[36:37], v1 offset:12320
    v_mfma_f32_16x16x32_bf16 v[56:59], a[40:43], a[20:23], v[56:59]
    ds_read_b64_tr_b16 a[38:39], v1 offset:13088
    v_mfma_f32_16x16x32_bf16 v[80:83], a[40:43], a[24:27], v[80:83]
    ds_read_b128 a[8:11], v12 offset:20480
    v_mfma_f32_16x16x32_bf16 v[104:107], a[40:43], a[28:31], v[104:107]
    ds_read_b128 a[12:15], v12 offset:22528
    s_waitcnt lgkmcnt(8)
    v_mfma_f32_16x16x32_bf16 v[36:39], a[44:47], a[16:19], v[36:39]
    ds_read_b64_tr_b16 a[40:41], v2 offset:0
    v_mfma_f32_16x16x32_bf16 v[60:63], a[44:47], a[20:23], v[60:63]
    ds_read_b64_tr_b16 a[42:43], v2 offset:768
    v_mfma_f32_16x16x32_bf16 v[84:87], a[44:47], a[24:27], v[84:87]
    v_mfma_f32_16x16x32_bf16 v[108:111], a[44:47], a[28:31], v[108:111]
    s_waitcnt lgkmcnt(2)
    v_add_u32 v5, 24608, v5
    v_add_u32 v6, 24608, v6
    v_add_u32 v7, 24608, v7
    v_mfma_f32_16x16x32_bf16 a[52:55], a[48:51], a[32:35], a[52:55]
    ds_read_b64_tr_b16 a[44:45], v2 offset:12320
    v_mfma_f32_16x16x32_bf16 v[16:19], a[32:35], a[0:3], v[16:19]
    ds_read_b64_tr_b16 a[46:47], v2 offset:13088
    v_mfma_f32_16x16x32_bf16 v[40:43], a[32:35], a[4:7], v[40:43]
    v_mfma_f32_16x16x32_bf16 v[64:67], a[32:35], a[8:11], v[64:67]
    v_mfma_f32_16x16x32_bf16 v[88:91], a[32:35], a[12:15], v[88:91]
    s_waitcnt lgkmcnt(6)
    v_mfma_f32_16x16x32_bf16 a[60:63], a[48:51], a[36:39], a[60:63]
    ds_read_b64_tr_b16 a[32:33], v3 offset:0
    v_mfma_f32_16x16x32_bf16 v[20:23], a[36:39], a[0:3], v[20:23]
    ds_read_b64_tr_b16 a[34:35], v3 offset:768
    v_mfma_f32_16x16x32_bf16 v[44:47], a[36:39], a[4:7], v[44:47]
    ds_read_b128 a[16:19], v13 offset:17408
    v_mfma_f32_16x16x32_bf16 v[68:71], a[36:39], a[8:11], v[68:71]
    v_mfma_f32_16x16x32_bf16 v[92:95], a[36:39], a[12:15], v[92:95]
    s_waitcnt lgkmcnt(5)
    v_mfma_f32_16x16x32_bf16 a[64:67], a[48:51], a[40:43], a[64:67]
    ds_read_b64_tr_b16 a[36:37], v3 offset:12320
    v_mfma_f32_16x16x32_bf16 v[24:27], a[40:43], a[0:3], v[24:27]
    ds_read_b64_tr_b16 a[38:39], v3 offset:13088
    v_mfma_f32_16x16x32_bf16 v[48:51], a[40:43], a[4:7], v[48:51]
    ds_read_b128 a[20:23], v13 offset:19456
    v_mfma_f32_16x16x32_bf16 v[72:75], a[40:43], a[8:11], v[72:75]
    v_mfma_f32_16x16x32_bf16 v[96:99], a[40:43], a[12:15], v[96:99]
    s_waitcnt lgkmcnt(6)
    v_mfma_f32_16x16x32_bf16 a[68:71], a[48:51], a[44:47], a[68:71]
    ds_read_b64_tr_b16 a[40:41], v5 offset:6144
    v_mfma_f32_16x16x32_bf16 v[28:31], a[44:47], a[0:3], v[28:31]
    ds_read_b64_tr_b16 a[42:43], v5 offset:6912
    v_mfma_f32_16x16x32_bf16 v[52:55], a[44:47], a[4:7], v[52:55]
    ds_read_b128 a[24:27], v13 offset:21504
    v_mfma_f32_16x16x32_bf16 v[76:79], a[44:47], a[8:11], v[76:79]
    v_mfma_f32_16x16x32_bf16 v[100:103], a[44:47], a[12:15], v[100:103]
    s_waitcnt lgkmcnt(7)
    v_mfma_f32_16x16x32_bf16 a[72:75], a[48:51], a[32:35], a[72:75]
    ds_read_b64_tr_b16 a[44:45], v5 offset:18464
    v_mfma_f32_16x16x32_bf16 v[32:35], a[32:35], a[0:3], v[32:35]
    ds_read_b64_tr_b16 a[46:47], v5 offset:19232
    v_mfma_f32_16x16x32_bf16 v[56:59], a[32:35], a[4:7], v[56:59]
    ds_read_b128 a[28:31], v13 offset:23552
    v_mfma_f32_16x16x32_bf16 v[80:83], a[32:35], a[8:11], v[80:83]
    v_mfma_f32_16x16x32_bf16 v[104:107], a[32:35], a[12:15], v[104:107]
    s_waitcnt lgkmcnt(7)
    v_mfma_f32_16x16x32_bf16 a[76:79], a[48:51], a[36:39], a[76:79]
    ds_read_b64_tr_b16 a[32:33], v6 offset:6144
    v_mfma_f32_16x16x32_bf16 v[36:39], a[36:39], a[0:3], v[36:39]
    ds_read_b64_tr_b16 a[34:35], v6 offset:6912
    v_mfma_f32_16x16x32_bf16 v[60:63], a[36:39], a[4:7], v[60:63]
    v_mfma_f32_16x16x32_bf16 v[84:87], a[36:39], a[8:11], v[84:87]
    v_mfma_f32_16x16x32_bf16 v[108:111], a[36:39], a[12:15], v[108:111]
    s_waitcnt lgkmcnt(2)
    v_mfma_f32_16x16x32_bf16 v[16:19], a[40:43], a[16:19], v[16:19]
    ds_read_b64_tr_b16 a[36:37], v6 offset:18464
    v_mfma_f32_16x16x32_bf16 v[40:43], a[40:43], a[20:23], v[40:43]
    ds_read_b64_tr_b16 a[38:39], v6 offset:19232
    v_mfma_f32_16x16x32_bf16 v[64:67], a[40:43], a[24:27], v[64:67]
    v_mfma_f32_16x16x32_bf16 v[88:91], a[40:43], a[28:31], v[88:91]
    s_waitcnt lgkmcnt(5)
    v_mfma_f32_16x16x32_bf16 v[20:23], a[44:47], a[16:19], v[20:23]
    ds_read_b64_tr_b16 a[40:41], v7 offset:6144
    v_mfma_f32_16x16x32_bf16 v[44:47], a[44:47], a[20:23], v[44:47]
    ds_read_b64_tr_b16 a[42:43], v7 offset:6912
    v_mfma_f32_16x16x32_bf16 v[68:71], a[44:47], a[24:27], v[68:71]
    v_mfma_f32_16x16x32_bf16 v[92:95], a[44:47], a[28:31], v[92:95]
    s_waitcnt lgkmcnt(4)
    v_mfma_f32_16x16x32_bf16 v[24:27], a[32:35], a[16:19], v[24:27]
    ds_read_b64_tr_b16 a[44:45], v7 offset:18464
    v_mfma_f32_16x16x32_bf16 v[48:51], a[32:35], a[20:23], v[48:51]
    ds_read_b64_tr_b16 a[46:47], v7 offset:19232
    v_mfma_f32_16x16x32_bf16 v[72:75], a[32:35], a[24:27], v[72:75]
    v_mfma_f32_16x16x32_bf16 v[96:99], a[32:35], a[28:31], v[96:99]
    s_waitcnt lgkmcnt(4)
    s_barrier
    v_add_u32 v1, 24608, v1
    v_add_u32 v2, 24608, v2
    v_add_u32 v3, 24608, v3
    v_mfma_f32_16x16x32_bf16 v[28:31], a[36:39], a[16:19], v[28:31]
    ds_read_b64_tr_b16 a[32:33], v1 offset:0
    v_mfma_f32_16x16x32_bf16 v[52:55], a[36:39], a[20:23], v[52:55]
    ds_read_b64_tr_b16 a[34:35], v1 offset:768
    v_mfma_f32_16x16x32_bf16 v[76:79], a[36:39], a[24:27], v[76:79]
    ds_read_b128 a[0:3], v12 offset:32768
    v_mfma_f32_16x16x32_bf16 v[100:103], a[36:39], a[28:31], v[100:103]
    ds_read_b128 a[4:7], v12 offset:34816
    s_waitcnt lgkmcnt(6)
    v_mfma_f32_16x16x32_bf16 v[32:35], a[40:43], a[16:19], v[32:35]
    ds_read_b64_tr_b16 a[36:37], v1 offset:12320
    v_mfma_f32_16x16x32_bf16 v[56:59], a[40:43], a[20:23], v[56:59]
    ds_read_b64_tr_b16 a[38:39], v1 offset:13088
    v_mfma_f32_16x16x32_bf16 v[80:83], a[40:43], a[24:27], v[80:83]
    ds_read_b128 a[8:11], v12 offset:36864
    v_mfma_f32_16x16x32_bf16 v[104:107], a[40:43], a[28:31], v[104:107]
    ds_read_b128 a[12:15], v12 offset:38912
    s_waitcnt lgkmcnt(8)
    v_mfma_f32_16x16x32_bf16 v[36:39], a[44:47], a[16:19], v[36:39]
    ds_read_b64_tr_b16 a[40:41], v2 offset:0
    v_mfma_f32_16x16x32_bf16 v[60:63], a[44:47], a[20:23], v[60:63]
    ds_read_b64_tr_b16 a[42:43], v2 offset:768
    v_mfma_f32_16x16x32_bf16 v[84:87], a[44:47], a[24:27], v[84:87]
    v_mfma_f32_16x16x32_bf16 v[108:111], a[44:47], a[28:31], v[108:111]
    s_waitcnt lgkmcnt(2)
    v_add_u32 v5, 24608, v5
    v_add_u32 v6, 24608, v6
    v_add_u32 v7, 24608, v7
    v_mfma_f32_16x16x32_bf16 a[52:55], a[48:51], a[32:35], a[52:55]
    ds_read_b64_tr_b16 a[44:45], v2 offset:12320
    v_mfma_f32_16x16x32_bf16 v[16:19], a[32:35], a[0:3], v[16:19]
    ds_read_b64_tr_b16 a[46:47], v2 offset:13088
    v_mfma_f32_16x16x32_bf16 v[40:43], a[32:35], a[4:7], v[40:43]
    v_mfma_f32_16x16x32_bf16 v[64:67], a[32:35], a[8:11], v[64:67]
    v_mfma_f32_16x16x32_bf16 v[88:91], a[32:35], a[12:15], v[88:91]
    s_waitcnt lgkmcnt(6)
    v_mfma_f32_16x16x32_bf16 a[60:63], a[48:51], a[36:39], a[60:63]
    ds_read_b64_tr_b16 a[32:33], v3 offset:0
    v_mfma_f32_16x16x32_bf16 v[20:23], a[36:39], a[0:3], v[20:23]
    ds_read_b64_tr_b16 a[34:35], v3 offset:768
    v_mfma_f32_16x16x32_bf16 v[44:47], a[36:39], a[4:7], v[44:47]
    ds_read_b128 a[16:19], v13 offset:33792
    v_mfma_f32_16x16x32_bf16 v[68:71], a[36:39], a[8:11], v[68:71]
    v_mfma_f32_16x16x32_bf16 v[92:95], a[36:39], a[12:15], v[92:95]
    s_waitcnt lgkmcnt(5)
    v_mfma_f32_16x16x32_bf16 a[64:67], a[48:51], a[40:43], a[64:67]
    ds_read_b64_tr_b16 a[36:37], v3 offset:12320
    v_mfma_f32_16x16x32_bf16 v[24:27], a[40:43], a[0:3], v[24:27]
    ds_read_b64_tr_b16 a[38:39], v3 offset:13088
    v_mfma_f32_16x16x32_bf16 v[48:51], a[40:43], a[4:7], v[48:51]
    ds_read_b128 a[20:23], v13 offset:35840
    v_mfma_f32_16x16x32_bf16 v[72:75], a[40:43], a[8:11], v[72:75]
    v_mfma_f32_16x16x32_bf16 v[96:99], a[40:43], a[12:15], v[96:99]
    s_waitcnt lgkmcnt(6)
    v_mfma_f32_16x16x32_bf16 a[68:71], a[48:51], a[44:47], a[68:71]
    ds_read_b64_tr_b16 a[40:41], v5 offset:6144
    v_mfma_f32_16x16x32_bf16 v[28:31], a[44:47], a[0:3], v[28:31]
    ds_read_b64_tr_b16 a[42:43], v5 offset:6912
    v_mfma_f32_16x16x32_bf16 v[52:55], a[44:47], a[4:7], v[52:55]
    ds_read_b128 a[24:27], v13 offset:37888
    v_mfma_f32_16x16x32_bf16 v[76:79], a[44:47], a[8:11], v[76:79]
    v_mfma_f32_16x16x32_bf16 v[100:103], a[44:47], a[12:15], v[100:103]
    s_waitcnt lgkmcnt(7)
    v_mfma_f32_16x16x32_bf16 a[72:75], a[48:51], a[32:35], a[72:75]
    ds_read_b64_tr_b16 a[44:45], v5 offset:18464
    v_mfma_f32_16x16x32_bf16 v[32:35], a[32:35], a[0:3], v[32:35]
    ds_read_b64_tr_b16 a[46:47], v5 offset:19232
    v_mfma_f32_16x16x32_bf16 v[56:59], a[32:35], a[4:7], v[56:59]
    ds_read_b128 a[28:31], v13 offset:39936
    v_mfma_f32_16x16x32_bf16 v[80:83], a[32:35], a[8:11], v[80:83]
    v_mfma_f32_16x16x32_bf16 v[104:107], a[32:35], a[12:15], v[104:107]
    s_waitcnt lgkmcnt(7)
    v_mfma_f32_16x16x32_bf16 a[76:79], a[48:51], a[36:39], a[76:79]
    ds_read_b64_tr_b16 a[32:33], v6 offset:6144
    v_mfma_f32_16x16x32_bf16 v[36:39], a[36:39], a[0:3], v[36:39]
    ds_read_b64_tr_b16 a[34:35], v6 offset:6912
    v_mfma_f32_16x16x32_bf16 v[60:63], a[36:39], a[4:7], v[60:63]
    v_mfma_f32_16x16x32_bf16 v[84:87], a[36:39], a[8:11], v[84:87]
    v_mfma_f32_16x16x32_bf16 v[108:111], a[36:39], a[12:15], v[108:111]
    s_waitcnt lgkmcnt(2)
    v_mfma_f32_16x16x32_bf16 v[16:19], a[40:43], a[16:19], v[16:19]
    ds_read_b64_tr_b16 a[36:37], v6 offset:18464
    v_mfma_f32_16x16x32_bf16 v[40:43], a[40:43], a[20:23], v[40:43]
    ds_read_b64_tr_b16 a[38:39], v6 offset:19232
    v_mfma_f32_16x16x32_bf16 v[64:67], a[40:43], a[24:27], v[64:67]
    v_mfma_f32_16x16x32_bf16 v[88:91], a[40:43], a[28:31], v[88:91]
    s_waitcnt lgkmcnt(5)
    v_mfma_f32_16x16x32_bf16 v[20:23], a[44:47], a[16:19], v[20:23]
    ds_read_b64_tr_b16 a[40:41], v7 offset:6144
    v_mfma_f32_16x16x32_bf16 v[44:47], a[44:47], a[20:23], v[44:47]
    ds_read_b64_tr_b16 a[42:43], v7 offset:6912
    v_mfma_f32_16x16x32_bf16 v[68:71], a[44:47], a[24:27], v[68:71]
    v_mfma_f32_16x16x32_bf16 v[92:95], a[44:47], a[28:31], v[92:95]
    s_waitcnt lgkmcnt(4)
    v_mfma_f32_16x16x32_bf16 v[24:27], a[32:35], a[16:19], v[24:27]
    ds_read_b64_tr_b16 a[44:45], v7 offset:18464
    v_mfma_f32_16x16x32_bf16 v[48:51], a[32:35], a[20:23], v[48:51]
    ds_read_b64_tr_b16 a[46:47], v7 offset:19232
    v_mfma_f32_16x16x32_bf16 v[72:75], a[32:35], a[24:27], v[72:75]
    v_mfma_f32_16x16x32_bf16 v[96:99], a[32:35], a[28:31], v[96:99]
    s_waitcnt lgkmcnt(4)
    s_barrier
    v_add_u32 v1, 24608, v1
    v_add_u32 v2, 24608, v2
    v_add_u32 v3, 24608, v3
    v_mfma_f32_16x16x32_bf16 v[28:31], a[36:39], a[16:19], v[28:31]
    ds_read_b64_tr_b16 a[32:33], v1 offset:0
    v_mfma_f32_16x16x32_bf16 v[52:55], a[36:39], a[20:23], v[52:55]
    ds_read_b64_tr_b16 a[34:35], v1 offset:768
    v_mfma_f32_16x16x32_bf16 v[76:79], a[36:39], a[24:27], v[76:79]
    ds_read_b128 a[0:3], v12 offset:0
    v_mfma_f32_16x16x32_bf16 v[100:103], a[36:39], a[28:31], v[100:103]
    ds_read_b128 a[4:7], v12 offset:2048
    s_waitcnt lgkmcnt(6)
    v_mfma_f32_16x16x32_bf16 v[32:35], a[40:43], a[16:19], v[32:35]
    ds_read_b64_tr_b16 a[36:37], v1 offset:12320
    v_mfma_f32_16x16x32_bf16 v[56:59], a[40:43], a[20:23], v[56:59]
    ds_read_b64_tr_b16 a[38:39], v1 offset:13088
    v_mfma_f32_16x16x32_bf16 v[80:83], a[40:43], a[24:27], v[80:83]
    ds_read_b128 a[8:11], v12 offset:4096
    v_mfma_f32_16x16x32_bf16 v[104:107], a[40:43], a[28:31], v[104:107]
    ds_read_b128 a[12:15], v12 offset:6144
    s_waitcnt lgkmcnt(8)
    v_mfma_f32_16x16x32_bf16 v[36:39], a[44:47], a[16:19], v[36:39]
    ds_read_b64_tr_b16 a[40:41], v2 offset:0
    v_mfma_f32_16x16x32_bf16 v[60:63], a[44:47], a[20:23], v[60:63]
    ds_read_b64_tr_b16 a[42:43], v2 offset:768
    v_mfma_f32_16x16x32_bf16 v[84:87], a[44:47], a[24:27], v[84:87]
    v_mfma_f32_16x16x32_bf16 v[108:111], a[44:47], a[28:31], v[108:111]
    s_waitcnt lgkmcnt(2)
    v_add_u32 v5, 24608, v5
    v_add_u32 v6, 24608, v6
    v_add_u32 v7, 24608, v7
    v_mfma_f32_16x16x32_bf16 a[52:55], a[48:51], a[32:35], a[52:55]
    ds_read_b64_tr_b16 a[44:45], v2 offset:12320
    v_mfma_f32_16x16x32_bf16 v[16:19], a[32:35], a[0:3], v[16:19]
    ds_read_b64_tr_b16 a[46:47], v2 offset:13088
    v_mfma_f32_16x16x32_bf16 v[40:43], a[32:35], a[4:7], v[40:43]
    v_mfma_f32_16x16x32_bf16 v[64:67], a[32:35], a[8:11], v[64:67]
    v_mfma_f32_16x16x32_bf16 v[88:91], a[32:35], a[12:15], v[88:91]
    s_waitcnt lgkmcnt(6)
    v_mfma_f32_16x16x32_bf16 a[60:63], a[48:51], a[36:39], a[60:63]
    ds_read_b64_tr_b16 a[32:33], v3 offset:0
    v_mfma_f32_16x16x32_bf16 v[20:23], a[36:39], a[0:3], v[20:23]
    ds_read_b64_tr_b16 a[34:35], v3 offset:768
    v_mfma_f32_16x16x32_bf16 v[44:47], a[36:39], a[4:7], v[44:47]
    ds_read_b128 a[16:19], v13 offset:1024
    v_mfma_f32_16x16x32_bf16 v[68:71], a[36:39], a[8:11], v[68:71]
    v_mfma_f32_16x16x32_bf16 v[92:95], a[36:39], a[12:15], v[92:95]
    s_waitcnt lgkmcnt(5)
    v_mfma_f32_16x16x32_bf16 a[64:67], a[48:51], a[40:43], a[64:67]
    ds_read_b64_tr_b16 a[36:37], v3 offset:12320
    v_mfma_f32_16x16x32_bf16 v[24:27], a[40:43], a[0:3], v[24:27]
    ds_read_b64_tr_b16 a[38:39], v3 offset:13088
    v_mfma_f32_16x16x32_bf16 v[48:51], a[40:43], a[4:7], v[48:51]
    ds_read_b128 a[20:23], v13 offset:3072
    v_mfma_f32_16x16x32_bf16 v[72:75], a[40:43], a[8:11], v[72:75]
    v_mfma_f32_16x16x32_bf16 v[96:99], a[40:43], a[12:15], v[96:99]
    s_waitcnt lgkmcnt(6)
    v_mfma_f32_16x16x32_bf16 a[68:71], a[48:51], a[44:47], a[68:71]
    ds_read_b64_tr_b16 a[40:41], v5 offset:6144
    v_mfma_f32_16x16x32_bf16 v[28:31], a[44:47], a[0:3], v[28:31]
    ds_read_b64_tr_b16 a[42:43], v5 offset:6912
    v_mfma_f32_16x16x32_bf16 v[52:55], a[44:47], a[4:7], v[52:55]
    ds_read_b128 a[24:27], v13 offset:5120
    v_mfma_f32_16x16x32_bf16 v[76:79], a[44:47], a[8:11], v[76:79]
    v_mfma_f32_16x16x32_bf16 v[100:103], a[44:47], a[12:15], v[100:103]
    s_waitcnt lgkmcnt(7)
    v_mfma_f32_16x16x32_bf16 a[72:75], a[48:51], a[32:35], a[72:75]
    ds_read_b64_tr_b16 a[44:45], v5 offset:18464
    v_mfma_f32_16x16x32_bf16 v[32:35], a[32:35], a[0:3], v[32:35]
    ds_read_b64_tr_b16 a[46:47], v5 offset:19232
    v_mfma_f32_16x16x32_bf16 v[56:59], a[32:35], a[4:7], v[56:59]
    ds_read_b128 a[28:31], v13 offset:7168
    v_mfma_f32_16x16x32_bf16 v[80:83], a[32:35], a[8:11], v[80:83]
    v_mfma_f32_16x16x32_bf16 v[104:107], a[32:35], a[12:15], v[104:107]
    s_waitcnt lgkmcnt(7)
    v_mfma_f32_16x16x32_bf16 a[76:79], a[48:51], a[36:39], a[76:79]
    ds_read_b64_tr_b16 a[32:33], v6 offset:6144
    v_mfma_f32_16x16x32_bf16 v[36:39], a[36:39], a[0:3], v[36:39]
    ds_read_b64_tr_b16 a[34:35], v6 offset:6912
    v_mfma_f32_16x16x32_bf16 v[60:63], a[36:39], a[4:7], v[60:63]
    v_mfma_f32_16x16x32_bf16 v[84:87], a[36:39], a[8:11], v[84:87]
    v_mfma_f32_16x16x32_bf16 v[108:111], a[36:39], a[12:15], v[108:111]
    s_waitcnt lgkmcnt(2)
    v_mfma_f32_16x16x32_bf16 v[16:19], a[40:43], a[16:19], v[16:19]
    ds_read_b64_tr_b16 a[36:37], v6 offset:18464
    v_mfma_f32_16x16x32_bf16 v[40:43], a[40:43], a[20:23], v[40:43]
    ds_read_b64_tr_b16 a[38:39], v6 offset:19232
    v_mfma_f32_16x16x32_bf16 v[64:67], a[40:43], a[24:27], v[64:67]
    v_mfma_f32_16x16x32_bf16 v[88:91], a[40:43], a[28:31], v[88:91]
    s_waitcnt lgkmcnt(5)
    v_mfma_f32_16x16x32_bf16 v[20:23], a[44:47], a[16:19], v[20:23]
    ds_read_b64_tr_b16 a[40:41], v7 offset:6144
    v_mfma_f32_16x16x32_bf16 v[44:47], a[44:47], a[20:23], v[44:47]
    ds_read_b64_tr_b16 a[42:43], v7 offset:6912
    v_mfma_f32_16x16x32_bf16 v[68:71], a[44:47], a[24:27], v[68:71]
    v_mfma_f32_16x16x32_bf16 v[92:95], a[44:47], a[28:31], v[92:95]
    s_waitcnt lgkmcnt(4)
    v_mfma_f32_16x16x32_bf16 v[24:27], a[32:35], a[16:19], v[24:27]
    ds_read_b64_tr_b16 a[44:45], v7 offset:18464
    v_mfma_f32_16x16x32_bf16 v[48:51], a[32:35], a[20:23], v[48:51]
    ds_read_b64_tr_b16 a[46:47], v7 offset:19232
    v_mfma_f32_16x16x32_bf16 v[72:75], a[32:35], a[24:27], v[72:75]
    v_mfma_f32_16x16x32_bf16 v[96:99], a[32:35], a[28:31], v[96:99]
    s_waitcnt lgkmcnt(4)
    s_barrier
    v_add_u32 v1, 4294893472, v1
    v_add_u32 v2, 4294893472, v2
    v_add_u32 v3, 4294893472, v3
    v_mfma_f32_16x16x32_bf16 v[28:31], a[36:39], a[16:19], v[28:31]
    ds_read_b64_tr_b16 a[32:33], v1 offset:0
    v_mfma_f32_16x16x32_bf16 v[52:55], a[36:39], a[20:23], v[52:55]
    ds_read_b64_tr_b16 a[34:35], v1 offset:768
    v_mfma_f32_16x16x32_bf16 v[76:79], a[36:39], a[24:27], v[76:79]
    ds_read_b128 a[0:3], v12 offset:16384
    v_mfma_f32_16x16x32_bf16 v[100:103], a[36:39], a[28:31], v[100:103]
    ds_read_b128 a[4:7], v12 offset:18432
    s_waitcnt lgkmcnt(6)
    v_mfma_f32_16x16x32_bf16 v[32:35], a[40:43], a[16:19], v[32:35]
    ds_read_b64_tr_b16 a[36:37], v1 offset:12320
    v_mfma_f32_16x16x32_bf16 v[56:59], a[40:43], a[20:23], v[56:59]
    ds_read_b64_tr_b16 a[38:39], v1 offset:13088
    v_mfma_f32_16x16x32_bf16 v[80:83], a[40:43], a[24:27], v[80:83]
    ds_read_b128 a[8:11], v12 offset:20480
    v_mfma_f32_16x16x32_bf16 v[104:107], a[40:43], a[28:31], v[104:107]
    ds_read_b128 a[12:15], v12 offset:22528
    s_waitcnt lgkmcnt(8)
    v_mfma_f32_16x16x32_bf16 v[36:39], a[44:47], a[16:19], v[36:39]
    ds_read_b64_tr_b16 a[40:41], v2 offset:0
    v_mfma_f32_16x16x32_bf16 v[60:63], a[44:47], a[20:23], v[60:63]
    ds_read_b64_tr_b16 a[42:43], v2 offset:768
    v_mfma_f32_16x16x32_bf16 v[84:87], a[44:47], a[24:27], v[84:87]
    v_mfma_f32_16x16x32_bf16 v[108:111], a[44:47], a[28:31], v[108:111]
    s_waitcnt lgkmcnt(2)
    v_add_u32 v5, 4294893472, v5
    v_add_u32 v6, 4294893472, v6
    v_add_u32 v7, 4294893472, v7
    v_mfma_f32_16x16x32_bf16 a[52:55], a[48:51], a[32:35], a[52:55]
    ds_read_b64_tr_b16 a[44:45], v2 offset:12320
    v_mfma_f32_16x16x32_bf16 v[16:19], a[32:35], a[0:3], v[16:19]
    ds_read_b64_tr_b16 a[46:47], v2 offset:13088
    v_mfma_f32_16x16x32_bf16 v[40:43], a[32:35], a[4:7], v[40:43]
    v_mfma_f32_16x16x32_bf16 v[64:67], a[32:35], a[8:11], v[64:67]
    v_mfma_f32_16x16x32_bf16 v[88:91], a[32:35], a[12:15], v[88:91]
    s_waitcnt lgkmcnt(6)
    v_mfma_f32_16x16x32_bf16 a[60:63], a[48:51], a[36:39], a[60:63]
    ds_read_b64_tr_b16 a[32:33], v3 offset:0
    v_mfma_f32_16x16x32_bf16 v[20:23], a[36:39], a[0:3], v[20:23]
    ds_read_b64_tr_b16 a[34:35], v3 offset:768
    v_mfma_f32_16x16x32_bf16 v[44:47], a[36:39], a[4:7], v[44:47]
    ds_read_b128 a[16:19], v13 offset:17408
    v_mfma_f32_16x16x32_bf16 v[68:71], a[36:39], a[8:11], v[68:71]
    v_mfma_f32_16x16x32_bf16 v[92:95], a[36:39], a[12:15], v[92:95]
    s_waitcnt lgkmcnt(5)
    v_mfma_f32_16x16x32_bf16 a[64:67], a[48:51], a[40:43], a[64:67]
    ds_read_b64_tr_b16 a[36:37], v3 offset:12320
    v_mfma_f32_16x16x32_bf16 v[24:27], a[40:43], a[0:3], v[24:27]
    ds_read_b64_tr_b16 a[38:39], v3 offset:13088
    v_mfma_f32_16x16x32_bf16 v[48:51], a[40:43], a[4:7], v[48:51]
    ds_read_b128 a[20:23], v13 offset:19456
    v_mfma_f32_16x16x32_bf16 v[72:75], a[40:43], a[8:11], v[72:75]
    v_mfma_f32_16x16x32_bf16 v[96:99], a[40:43], a[12:15], v[96:99]
    s_waitcnt lgkmcnt(6)
    v_mfma_f32_16x16x32_bf16 a[68:71], a[48:51], a[44:47], a[68:71]
    ds_read_b64_tr_b16 a[40:41], v5 offset:6144
    v_mfma_f32_16x16x32_bf16 v[28:31], a[44:47], a[0:3], v[28:31]
    ds_read_b64_tr_b16 a[42:43], v5 offset:6912
    v_mfma_f32_16x16x32_bf16 v[52:55], a[44:47], a[4:7], v[52:55]
    ds_read_b128 a[24:27], v13 offset:21504
    v_mfma_f32_16x16x32_bf16 v[76:79], a[44:47], a[8:11], v[76:79]
    v_mfma_f32_16x16x32_bf16 v[100:103], a[44:47], a[12:15], v[100:103]
    s_waitcnt lgkmcnt(7)
    v_mfma_f32_16x16x32_bf16 a[72:75], a[48:51], a[32:35], a[72:75]
    ds_read_b64_tr_b16 a[44:45], v5 offset:18464
    v_mfma_f32_16x16x32_bf16 v[32:35], a[32:35], a[0:3], v[32:35]
    ds_read_b64_tr_b16 a[46:47], v5 offset:19232
    v_mfma_f32_16x16x32_bf16 v[56:59], a[32:35], a[4:7], v[56:59]
    ds_read_b128 a[28:31], v13 offset:23552
    v_mfma_f32_16x16x32_bf16 v[80:83], a[32:35], a[8:11], v[80:83]
    v_mfma_f32_16x16x32_bf16 v[104:107], a[32:35], a[12:15], v[104:107]
    s_waitcnt lgkmcnt(7)
    v_mfma_f32_16x16x32_bf16 a[76:79], a[48:51], a[36:39], a[76:79]
    ds_read_b64_tr_b16 a[32:33], v6 offset:6144
    v_mfma_f32_16x16x32_bf16 v[36:39], a[36:39], a[0:3], v[36:39]
    ds_read_b64_tr_b16 a[34:35], v6 offset:6912
    v_mfma_f32_16x16x32_bf16 v[60:63], a[36:39], a[4:7], v[60:63]
    v_mfma_f32_16x16x32_bf16 v[84:87], a[36:39], a[8:11], v[84:87]
    v_mfma_f32_16x16x32_bf16 v[108:111], a[36:39], a[12:15], v[108:111]
    s_waitcnt lgkmcnt(2)
    v_mfma_f32_16x16x32_bf16 v[16:19], a[40:43], a[16:19], v[16:19]
    ds_read_b64_tr_b16 a[36:37], v6 offset:18464
    v_mfma_f32_16x16x32_bf16 v[40:43], a[40:43], a[20:23], v[40:43]
    ds_read_b64_tr_b16 a[38:39], v6 offset:19232
    v_mfma_f32_16x16x32_bf16 v[64:67], a[40:43], a[24:27], v[64:67]
    v_mfma_f32_16x16x32_bf16 v[88:91], a[40:43], a[28:31], v[88:91]
    s_waitcnt lgkmcnt(5)
    v_mfma_f32_16x16x32_bf16 v[20:23], a[44:47], a[16:19], v[20:23]
    ds_read_b64_tr_b16 a[40:41], v7 offset:6144
    v_mfma_f32_16x16x32_bf16 v[44:47], a[44:47], a[20:23], v[44:47]
    ds_read_b64_tr_b16 a[42:43], v7 offset:6912
    v_mfma_f32_16x16x32_bf16 v[68:71], a[44:47], a[24:27], v[68:71]
    v_mfma_f32_16x16x32_bf16 v[92:95], a[44:47], a[28:31], v[92:95]
    s_waitcnt lgkmcnt(4)
    v_mfma_f32_16x16x32_bf16 v[24:27], a[32:35], a[16:19], v[24:27]
    ds_read_b64_tr_b16 a[44:45], v7 offset:18464
    v_mfma_f32_16x16x32_bf16 v[48:51], a[32:35], a[20:23], v[48:51]
    ds_read_b64_tr_b16 a[46:47], v7 offset:19232
    v_mfma_f32_16x16x32_bf16 v[72:75], a[32:35], a[24:27], v[72:75]
    v_mfma_f32_16x16x32_bf16 v[96:99], a[32:35], a[28:31], v[96:99]
    s_waitcnt lgkmcnt(4)
    s_barrier
    v_add_u32 v1, 24608, v1
    v_add_u32 v2, 24608, v2
    v_add_u32 v3, 24608, v3
    v_mfma_f32_16x16x32_bf16 v[28:31], a[36:39], a[16:19], v[28:31]
    ds_read_b64_tr_b16 a[32:33], v1 offset:0
    v_mfma_f32_16x16x32_bf16 v[52:55], a[36:39], a[20:23], v[52:55]
    ds_read_b64_tr_b16 a[34:35], v1 offset:768
    v_mfma_f32_16x16x32_bf16 v[76:79], a[36:39], a[24:27], v[76:79]
    ds_read_b128 a[0:3], v12 offset:32768
    v_mfma_f32_16x16x32_bf16 v[100:103], a[36:39], a[28:31], v[100:103]
    ds_read_b128 a[4:7], v12 offset:34816
    s_waitcnt lgkmcnt(6)
    v_mfma_f32_16x16x32_bf16 v[32:35], a[40:43], a[16:19], v[32:35]
    ds_read_b64_tr_b16 a[36:37], v1 offset:12320
    v_mfma_f32_16x16x32_bf16 v[56:59], a[40:43], a[20:23], v[56:59]
    ds_read_b64_tr_b16 a[38:39], v1 offset:13088
    v_mfma_f32_16x16x32_bf16 v[80:83], a[40:43], a[24:27], v[80:83]
    ds_read_b128 a[8:11], v12 offset:36864
    v_mfma_f32_16x16x32_bf16 v[104:107], a[40:43], a[28:31], v[104:107]
    ds_read_b128 a[12:15], v12 offset:38912
    s_waitcnt lgkmcnt(8)
    v_mfma_f32_16x16x32_bf16 v[36:39], a[44:47], a[16:19], v[36:39]
    ds_read_b64_tr_b16 a[40:41], v2 offset:0
    v_mfma_f32_16x16x32_bf16 v[60:63], a[44:47], a[20:23], v[60:63]
    ds_read_b64_tr_b16 a[42:43], v2 offset:768
    v_mfma_f32_16x16x32_bf16 v[84:87], a[44:47], a[24:27], v[84:87]
    v_mfma_f32_16x16x32_bf16 v[108:111], a[44:47], a[28:31], v[108:111]
    s_waitcnt lgkmcnt(2)
    v_add_u32 v5, 24608, v5
    v_add_u32 v6, 24608, v6
    v_add_u32 v7, 24608, v7
    v_mfma_f32_16x16x32_bf16 a[52:55], a[48:51], a[32:35], a[52:55]
    ds_read_b64_tr_b16 a[44:45], v2 offset:12320
    v_mfma_f32_16x16x32_bf16 v[16:19], a[32:35], a[0:3], v[16:19]
    ds_read_b64_tr_b16 a[46:47], v2 offset:13088
    v_mfma_f32_16x16x32_bf16 v[40:43], a[32:35], a[4:7], v[40:43]
    v_mfma_f32_16x16x32_bf16 v[64:67], a[32:35], a[8:11], v[64:67]
    v_mfma_f32_16x16x32_bf16 v[88:91], a[32:35], a[12:15], v[88:91]
    s_waitcnt lgkmcnt(6)
    v_mfma_f32_16x16x32_bf16 a[60:63], a[48:51], a[36:39], a[60:63]
    ds_read_b64_tr_b16 a[32:33], v3 offset:0
    v_mfma_f32_16x16x32_bf16 v[20:23], a[36:39], a[0:3], v[20:23]
    ds_read_b64_tr_b16 a[34:35], v3 offset:768
    v_mfma_f32_16x16x32_bf16 v[44:47], a[36:39], a[4:7], v[44:47]
    ds_read_b128 a[16:19], v13 offset:33792
    v_mfma_f32_16x16x32_bf16 v[68:71], a[36:39], a[8:11], v[68:71]
    v_mfma_f32_16x16x32_bf16 v[92:95], a[36:39], a[12:15], v[92:95]
    s_waitcnt lgkmcnt(5)
    v_mfma_f32_16x16x32_bf16 a[64:67], a[48:51], a[40:43], a[64:67]
    ds_read_b64_tr_b16 a[36:37], v3 offset:12320
    v_mfma_f32_16x16x32_bf16 v[24:27], a[40:43], a[0:3], v[24:27]
    ds_read_b64_tr_b16 a[38:39], v3 offset:13088
    v_mfma_f32_16x16x32_bf16 v[48:51], a[40:43], a[4:7], v[48:51]
    ds_read_b128 a[20:23], v13 offset:35840
    v_mfma_f32_16x16x32_bf16 v[72:75], a[40:43], a[8:11], v[72:75]
    v_mfma_f32_16x16x32_bf16 v[96:99], a[40:43], a[12:15], v[96:99]
    s_waitcnt lgkmcnt(6)
    v_mfma_f32_16x16x32_bf16 a[68:71], a[48:51], a[44:47], a[68:71]
    ds_read_b64_tr_b16 a[40:41], v5 offset:6144
    v_mfma_f32_16x16x32_bf16 v[28:31], a[44:47], a[0:3], v[28:31]
    ds_read_b64_tr_b16 a[42:43], v5 offset:6912
    v_mfma_f32_16x16x32_bf16 v[52:55], a[44:47], a[4:7], v[52:55]
    ds_read_b128 a[24:27], v13 offset:37888
    v_mfma_f32_16x16x32_bf16 v[76:79], a[44:47], a[8:11], v[76:79]
    v_mfma_f32_16x16x32_bf16 v[100:103], a[44:47], a[12:15], v[100:103]
    s_waitcnt lgkmcnt(7)
    v_mfma_f32_16x16x32_bf16 a[72:75], a[48:51], a[32:35], a[72:75]
    ds_read_b64_tr_b16 a[44:45], v5 offset:18464
    v_mfma_f32_16x16x32_bf16 v[32:35], a[32:35], a[0:3], v[32:35]
    ds_read_b64_tr_b16 a[46:47], v5 offset:19232
    v_mfma_f32_16x16x32_bf16 v[56:59], a[32:35], a[4:7], v[56:59]
    ds_read_b128 a[28:31], v13 offset:39936
    v_mfma_f32_16x16x32_bf16 v[80:83], a[32:35], a[8:11], v[80:83]
    v_mfma_f32_16x16x32_bf16 v[104:107], a[32:35], a[12:15], v[104:107]
    s_waitcnt lgkmcnt(7)
    v_mfma_f32_16x16x32_bf16 a[76:79], a[48:51], a[36:39], a[76:79]
    ds_read_b64_tr_b16 a[32:33], v6 offset:6144
    v_mfma_f32_16x16x32_bf16 v[36:39], a[36:39], a[0:3], v[36:39]
    ds_read_b64_tr_b16 a[34:35], v6 offset:6912
    v_mfma_f32_16x16x32_bf16 v[60:63], a[36:39], a[4:7], v[60:63]
    v_mfma_f32_16x16x32_bf16 v[84:87], a[36:39], a[8:11], v[84:87]
    v_mfma_f32_16x16x32_bf16 v[108:111], a[36:39], a[12:15], v[108:111]
    s_waitcnt lgkmcnt(2)
    v_mfma_f32_16x16x32_bf16 v[16:19], a[40:43], a[16:19], v[16:19]
    ds_read_b64_tr_b16 a[36:37], v6 offset:18464
    v_mfma_f32_16x16x32_bf16 v[40:43], a[40:43], a[20:23], v[40:43]
    ds_read_b64_tr_b16 a[38:39], v6 offset:19232
    v_mfma_f32_16x16x32_bf16 v[64:67], a[40:43], a[24:27], v[64:67]
    v_mfma_f32_16x16x32_bf16 v[88:91], a[40:43], a[28:31], v[88:91]
    s_waitcnt lgkmcnt(5)
    v_mfma_f32_16x16x32_bf16 v[20:23], a[44:47], a[16:19], v[20:23]
    ds_read_b64_tr_b16 a[40:41], v7 offset:6144
    v_mfma_f32_16x16x32_bf16 v[44:47], a[44:47], a[20:23], v[44:47]
    ds_read_b64_tr_b16 a[42:43], v7 offset:6912
    v_mfma_f32_16x16x32_bf16 v[68:71], a[44:47], a[24:27], v[68:71]
    v_mfma_f32_16x16x32_bf16 v[92:95], a[44:47], a[28:31], v[92:95]
    s_waitcnt lgkmcnt(4)
    v_mfma_f32_16x16x32_bf16 v[24:27], a[32:35], a[16:19], v[24:27]
    ds_read_b64_tr_b16 a[44:45], v7 offset:18464
    v_mfma_f32_16x16x32_bf16 v[48:51], a[32:35], a[20:23], v[48:51]
    ds_read_b64_tr_b16 a[46:47], v7 offset:19232
    v_mfma_f32_16x16x32_bf16 v[72:75], a[32:35], a[24:27], v[72:75]
    v_mfma_f32_16x16x32_bf16 v[96:99], a[32:35], a[28:31], v[96:99]
    s_waitcnt lgkmcnt(4)
    s_barrier
    v_add_u32 v1, 24608, v1
    v_add_u32 v2, 24608, v2
    v_add_u32 v3, 24608, v3
    v_mfma_f32_16x16x32_bf16 v[28:31], a[36:39], a[16:19], v[28:31]
    ds_read_b64_tr_b16 a[32:33], v1 offset:0
    v_mfma_f32_16x16x32_bf16 v[52:55], a[36:39], a[20:23], v[52:55]
    ds_read_b64_tr_b16 a[34:35], v1 offset:768
    v_mfma_f32_16x16x32_bf16 v[76:79], a[36:39], a[24:27], v[76:79]
    ds_read_b128 a[0:3], v12 offset:0
    v_mfma_f32_16x16x32_bf16 v[100:103], a[36:39], a[28:31], v[100:103]
    ds_read_b128 a[4:7], v12 offset:2048
    s_waitcnt lgkmcnt(6)
    v_mfma_f32_16x16x32_bf16 v[32:35], a[40:43], a[16:19], v[32:35]
    ds_read_b64_tr_b16 a[36:37], v1 offset:12320
    v_mfma_f32_16x16x32_bf16 v[56:59], a[40:43], a[20:23], v[56:59]
    ds_read_b64_tr_b16 a[38:39], v1 offset:13088
    v_mfma_f32_16x16x32_bf16 v[80:83], a[40:43], a[24:27], v[80:83]
    ds_read_b128 a[8:11], v12 offset:4096
    v_mfma_f32_16x16x32_bf16 v[104:107], a[40:43], a[28:31], v[104:107]
    ds_read_b128 a[12:15], v12 offset:6144
    s_waitcnt lgkmcnt(8)
    v_mfma_f32_16x16x32_bf16 v[36:39], a[44:47], a[16:19], v[36:39]
    ds_read_b64_tr_b16 a[40:41], v2 offset:0
    v_mfma_f32_16x16x32_bf16 v[60:63], a[44:47], a[20:23], v[60:63]
    ds_read_b64_tr_b16 a[42:43], v2 offset:768
    v_mfma_f32_16x16x32_bf16 v[84:87], a[44:47], a[24:27], v[84:87]
    v_mfma_f32_16x16x32_bf16 v[108:111], a[44:47], a[28:31], v[108:111]
    s_waitcnt lgkmcnt(2)
    v_add_u32 v5, 24608, v5
    v_add_u32 v6, 24608, v6
    v_add_u32 v7, 24608, v7
    v_mfma_f32_16x16x32_bf16 a[52:55], a[48:51], a[32:35], a[52:55]
    ds_read_b64_tr_b16 a[44:45], v2 offset:12320
    v_mfma_f32_16x16x32_bf16 v[16:19], a[32:35], a[0:3], v[16:19]
    ds_read_b64_tr_b16 a[46:47], v2 offset:13088
    v_mfma_f32_16x16x32_bf16 v[40:43], a[32:35], a[4:7], v[40:43]
    v_mfma_f32_16x16x32_bf16 v[64:67], a[32:35], a[8:11], v[64:67]
    v_mfma_f32_16x16x32_bf16 v[88:91], a[32:35], a[12:15], v[88:91]
    s_waitcnt lgkmcnt(6)
    v_mfma_f32_16x16x32_bf16 a[60:63], a[48:51], a[36:39], a[60:63]
    ds_read_b64_tr_b16 a[32:33], v3 offset:0
    v_mfma_f32_16x16x32_bf16 v[20:23], a[36:39], a[0:3], v[20:23]
    ds_read_b64_tr_b16 a[34:35], v3 offset:768
    v_mfma_f32_16x16x32_bf16 v[44:47], a[36:39], a[4:7], v[44:47]
    ds_read_b128 a[16:19], v13 offset:1024
    v_mfma_f32_16x16x32_bf16 v[68:71], a[36:39], a[8:11], v[68:71]
    v_mfma_f32_16x16x32_bf16 v[92:95], a[36:39], a[12:15], v[92:95]
    s_waitcnt lgkmcnt(5)
    v_mfma_f32_16x16x32_bf16 a[64:67], a[48:51], a[40:43], a[64:67]
    ds_read_b64_tr_b16 a[36:37], v3 offset:12320
    v_mfma_f32_16x16x32_bf16 v[24:27], a[40:43], a[0:3], v[24:27]
    ds_read_b64_tr_b16 a[38:39], v3 offset:13088
    v_mfma_f32_16x16x32_bf16 v[48:51], a[40:43], a[4:7], v[48:51]
    ds_read_b128 a[20:23], v13 offset:3072
    v_mfma_f32_16x16x32_bf16 v[72:75], a[40:43], a[8:11], v[72:75]
    v_mfma_f32_16x16x32_bf16 v[96:99], a[40:43], a[12:15], v[96:99]
    s_waitcnt lgkmcnt(6)
    v_mfma_f32_16x16x32_bf16 a[68:71], a[48:51], a[44:47], a[68:71]
    ds_read_b64_tr_b16 a[40:41], v5 offset:6144
    v_mfma_f32_16x16x32_bf16 v[28:31], a[44:47], a[0:3], v[28:31]
    ds_read_b64_tr_b16 a[42:43], v5 offset:6912
    v_mfma_f32_16x16x32_bf16 v[52:55], a[44:47], a[4:7], v[52:55]
    ds_read_b128 a[24:27], v13 offset:5120
    v_mfma_f32_16x16x32_bf16 v[76:79], a[44:47], a[8:11], v[76:79]
    v_mfma_f32_16x16x32_bf16 v[100:103], a[44:47], a[12:15], v[100:103]
    s_waitcnt lgkmcnt(7)
    v_mfma_f32_16x16x32_bf16 a[72:75], a[48:51], a[32:35], a[72:75]
    ds_read_b64_tr_b16 a[44:45], v5 offset:18464
    v_mfma_f32_16x16x32_bf16 v[32:35], a[32:35], a[0:3], v[32:35]
    ds_read_b64_tr_b16 a[46:47], v5 offset:19232
    v_mfma_f32_16x16x32_bf16 v[56:59], a[32:35], a[4:7], v[56:59]
    ds_read_b128 a[28:31], v13 offset:7168
    v_mfma_f32_16x16x32_bf16 v[80:83], a[32:35], a[8:11], v[80:83]
    v_mfma_f32_16x16x32_bf16 v[104:107], a[32:35], a[12:15], v[104:107]
    s_waitcnt lgkmcnt(7)
    v_mfma_f32_16x16x32_bf16 a[76:79], a[48:51], a[36:39], a[76:79]
    ds_read_b64_tr_b16 a[32:33], v6 offset:6144
    v_mfma_f32_16x16x32_bf16 v[36:39], a[36:39], a[0:3], v[36:39]
    ds_read_b64_tr_b16 a[34:35], v6 offset:6912
    v_mfma_f32_16x16x32_bf16 v[60:63], a[36:39], a[4:7], v[60:63]
    v_mfma_f32_16x16x32_bf16 v[84:87], a[36:39], a[8:11], v[84:87]
    v_mfma_f32_16x16x32_bf16 v[108:111], a[36:39], a[12:15], v[108:111]
    s_waitcnt lgkmcnt(2)
    v_mfma_f32_16x16x32_bf16 v[16:19], a[40:43], a[16:19], v[16:19]
    ds_read_b64_tr_b16 a[36:37], v6 offset:18464
    v_mfma_f32_16x16x32_bf16 v[40:43], a[40:43], a[20:23], v[40:43]
    ds_read_b64_tr_b16 a[38:39], v6 offset:19232
    v_mfma_f32_16x16x32_bf16 v[64:67], a[40:43], a[24:27], v[64:67]
    v_mfma_f32_16x16x32_bf16 v[88:91], a[40:43], a[28:31], v[88:91]
    s_waitcnt lgkmcnt(5)
    v_mfma_f32_16x16x32_bf16 v[20:23], a[44:47], a[16:19], v[20:23]
    ds_read_b64_tr_b16 a[40:41], v7 offset:6144
    v_mfma_f32_16x16x32_bf16 v[44:47], a[44:47], a[20:23], v[44:47]
    ds_read_b64_tr_b16 a[42:43], v7 offset:6912
    v_mfma_f32_16x16x32_bf16 v[68:71], a[44:47], a[24:27], v[68:71]
    v_mfma_f32_16x16x32_bf16 v[92:95], a[44:47], a[28:31], v[92:95]
    s_waitcnt lgkmcnt(4)
    v_mfma_f32_16x16x32_bf16 v[24:27], a[32:35], a[16:19], v[24:27]
    ds_read_b64_tr_b16 a[44:45], v7 offset:18464
    v_mfma_f32_16x16x32_bf16 v[48:51], a[32:35], a[20:23], v[48:51]
    ds_read_b64_tr_b16 a[46:47], v7 offset:19232
    v_mfma_f32_16x16x32_bf16 v[72:75], a[32:35], a[24:27], v[72:75]
    v_mfma_f32_16x16x32_bf16 v[96:99], a[32:35], a[28:31], v[96:99]
    s_waitcnt lgkmcnt(4)
    s_barrier
    v_add_u32 v1, 24608, v1
    v_add_u32 v2, 24608, v2
    v_add_u32 v3, 24608, v3
    v_mfma_f32_16x16x32_bf16 v[28:31], a[36:39], a[16:19], v[28:31]
    ds_read_b64_tr_b16 a[32:33], v1 offset:0
    v_mfma_f32_16x16x32_bf16 v[52:55], a[36:39], a[20:23], v[52:55]
    ds_read_b64_tr_b16 a[34:35], v1 offset:768
    v_mfma_f32_16x16x32_bf16 v[76:79], a[36:39], a[24:27], v[76:79]
    ds_read_b128 a[0:3], v12 offset:16384
    v_mfma_f32_16x16x32_bf16 v[100:103], a[36:39], a[28:31], v[100:103]
    ds_read_b128 a[4:7], v12 offset:18432
    s_waitcnt lgkmcnt(6)
    v_mfma_f32_16x16x32_bf16 v[32:35], a[40:43], a[16:19], v[32:35]
    ds_read_b64_tr_b16 a[36:37], v1 offset:12320
    v_mfma_f32_16x16x32_bf16 v[56:59], a[40:43], a[20:23], v[56:59]
    ds_read_b64_tr_b16 a[38:39], v1 offset:13088
    v_mfma_f32_16x16x32_bf16 v[80:83], a[40:43], a[24:27], v[80:83]
    ds_read_b128 a[8:11], v12 offset:20480
    v_mfma_f32_16x16x32_bf16 v[104:107], a[40:43], a[28:31], v[104:107]
    ds_read_b128 a[12:15], v12 offset:22528
    s_waitcnt lgkmcnt(8)
    v_mfma_f32_16x16x32_bf16 v[36:39], a[44:47], a[16:19], v[36:39]
    ds_read_b64_tr_b16 a[40:41], v2 offset:0
    v_mfma_f32_16x16x32_bf16 v[60:63], a[44:47], a[20:23], v[60:63]
    ds_read_b64_tr_b16 a[42:43], v2 offset:768
    v_mfma_f32_16x16x32_bf16 v[84:87], a[44:47], a[24:27], v[84:87]
    v_mfma_f32_16x16x32_bf16 v[108:111], a[44:47], a[28:31], v[108:111]
    s_waitcnt lgkmcnt(2)
    v_add_u32 v5, 24608, v5
    v_add_u32 v6, 24608, v6
    v_add_u32 v7, 24608, v7
    v_mfma_f32_16x16x32_bf16 a[52:55], a[48:51], a[32:35], a[52:55]
    ds_read_b64_tr_b16 a[44:45], v2 offset:12320
    v_mfma_f32_16x16x32_bf16 v[16:19], a[32:35], a[0:3], v[16:19]
    ds_read_b64_tr_b16 a[46:47], v2 offset:13088
    v_mfma_f32_16x16x32_bf16 v[40:43], a[32:35], a[4:7], v[40:43]
    v_mfma_f32_16x16x32_bf16 v[64:67], a[32:35], a[8:11], v[64:67]
    v_mfma_f32_16x16x32_bf16 v[88:91], a[32:35], a[12:15], v[88:91]
    s_waitcnt lgkmcnt(6)
    v_mfma_f32_16x16x32_bf16 a[60:63], a[48:51], a[36:39], a[60:63]
    ds_read_b64_tr_b16 a[32:33], v3 offset:0
    v_mfma_f32_16x16x32_bf16 v[20:23], a[36:39], a[0:3], v[20:23]
    ds_read_b64_tr_b16 a[34:35], v3 offset:768
    v_mfma_f32_16x16x32_bf16 v[44:47], a[36:39], a[4:7], v[44:47]
    ds_read_b128 a[16:19], v13 offset:17408
    v_mfma_f32_16x16x32_bf16 v[68:71], a[36:39], a[8:11], v[68:71]
    v_mfma_f32_16x16x32_bf16 v[92:95], a[36:39], a[12:15], v[92:95]
    s_waitcnt lgkmcnt(5)
    v_mfma_f32_16x16x32_bf16 a[64:67], a[48:51], a[40:43], a[64:67]
    ds_read_b64_tr_b16 a[36:37], v3 offset:12320
    v_mfma_f32_16x16x32_bf16 v[24:27], a[40:43], a[0:3], v[24:27]
    ds_read_b64_tr_b16 a[38:39], v3 offset:13088
    v_mfma_f32_16x16x32_bf16 v[48:51], a[40:43], a[4:7], v[48:51]
    ds_read_b128 a[20:23], v13 offset:19456
    v_mfma_f32_16x16x32_bf16 v[72:75], a[40:43], a[8:11], v[72:75]
    v_mfma_f32_16x16x32_bf16 v[96:99], a[40:43], a[12:15], v[96:99]
    s_waitcnt lgkmcnt(6)
    v_mfma_f32_16x16x32_bf16 a[68:71], a[48:51], a[44:47], a[68:71]
    ds_read_b64_tr_b16 a[40:41], v5 offset:6144
    v_mfma_f32_16x16x32_bf16 v[28:31], a[44:47], a[0:3], v[28:31]
    ds_read_b64_tr_b16 a[42:43], v5 offset:6912
    v_mfma_f32_16x16x32_bf16 v[52:55], a[44:47], a[4:7], v[52:55]
    ds_read_b128 a[24:27], v13 offset:21504
    v_mfma_f32_16x16x32_bf16 v[76:79], a[44:47], a[8:11], v[76:79]
    v_mfma_f32_16x16x32_bf16 v[100:103], a[44:47], a[12:15], v[100:103]
    s_waitcnt lgkmcnt(7)
    v_mfma_f32_16x16x32_bf16 a[72:75], a[48:51], a[32:35], a[72:75]
    ds_read_b64_tr_b16 a[44:45], v5 offset:18464
    v_mfma_f32_16x16x32_bf16 v[32:35], a[32:35], a[0:3], v[32:35]
    ds_read_b64_tr_b16 a[46:47], v5 offset:19232
    v_mfma_f32_16x16x32_bf16 v[56:59], a[32:35], a[4:7], v[56:59]
    ds_read_b128 a[28:31], v13 offset:23552
    v_mfma_f32_16x16x32_bf16 v[80:83], a[32:35], a[8:11], v[80:83]
    v_mfma_f32_16x16x32_bf16 v[104:107], a[32:35], a[12:15], v[104:107]
    s_waitcnt lgkmcnt(7)
    v_mfma_f32_16x16x32_bf16 a[76:79], a[48:51], a[36:39], a[76:79]
    ds_read_b64_tr_b16 a[32:33], v6 offset:6144
    v_mfma_f32_16x16x32_bf16 v[36:39], a[36:39], a[0:3], v[36:39]
    ds_read_b64_tr_b16 a[34:35], v6 offset:6912
    v_mfma_f32_16x16x32_bf16 v[60:63], a[36:39], a[4:7], v[60:63]
    v_mfma_f32_16x16x32_bf16 v[84:87], a[36:39], a[8:11], v[84:87]
    v_mfma_f32_16x16x32_bf16 v[108:111], a[36:39], a[12:15], v[108:111]
    s_waitcnt lgkmcnt(2)
    v_mfma_f32_16x16x32_bf16 v[16:19], a[40:43], a[16:19], v[16:19]
    ds_read_b64_tr_b16 a[36:37], v6 offset:18464
    v_mfma_f32_16x16x32_bf16 v[40:43], a[40:43], a[20:23], v[40:43]
    ds_read_b64_tr_b16 a[38:39], v6 offset:19232
    v_mfma_f32_16x16x32_bf16 v[64:67], a[40:43], a[24:27], v[64:67]
    v_mfma_f32_16x16x32_bf16 v[88:91], a[40:43], a[28:31], v[88:91]
    s_waitcnt lgkmcnt(5)
    v_mfma_f32_16x16x32_bf16 v[20:23], a[44:47], a[16:19], v[20:23]
    ds_read_b64_tr_b16 a[40:41], v7 offset:6144
    v_mfma_f32_16x16x32_bf16 v[44:47], a[44:47], a[20:23], v[44:47]
    ds_read_b64_tr_b16 a[42:43], v7 offset:6912
    v_mfma_f32_16x16x32_bf16 v[68:71], a[44:47], a[24:27], v[68:71]
    v_mfma_f32_16x16x32_bf16 v[92:95], a[44:47], a[28:31], v[92:95]
    s_waitcnt lgkmcnt(4)
    v_mfma_f32_16x16x32_bf16 v[24:27], a[32:35], a[16:19], v[24:27]
    ds_read_b64_tr_b16 a[44:45], v7 offset:18464
    v_mfma_f32_16x16x32_bf16 v[48:51], a[32:35], a[20:23], v[48:51]
    ds_read_b64_tr_b16 a[46:47], v7 offset:19232
    v_mfma_f32_16x16x32_bf16 v[72:75], a[32:35], a[24:27], v[72:75]
    v_mfma_f32_16x16x32_bf16 v[96:99], a[32:35], a[28:31], v[96:99]
    s_waitcnt lgkmcnt(4)
    s_barrier
    v_add_u32 v1, 4294893472, v1
    v_add_u32 v2, 4294893472, v2
    v_add_u32 v3, 4294893472, v3
    v_mfma_f32_16x16x32_bf16 v[28:31], a[36:39], a[16:19], v[28:31]
    ds_read_b64_tr_b16 a[32:33], v1 offset:0
    v_mfma_f32_16x16x32_bf16 v[52:55], a[36:39], a[20:23], v[52:55]
    ds_read_b64_tr_b16 a[34:35], v1 offset:768
    v_mfma_f32_16x16x32_bf16 v[76:79], a[36:39], a[24:27], v[76:79]
    ds_read_b128 a[0:3], v12 offset:32768
    v_mfma_f32_16x16x32_bf16 v[100:103], a[36:39], a[28:31], v[100:103]
    ds_read_b128 a[4:7], v12 offset:34816
    s_waitcnt lgkmcnt(6)
    v_mfma_f32_16x16x32_bf16 v[32:35], a[40:43], a[16:19], v[32:35]
    ds_read_b64_tr_b16 a[36:37], v1 offset:12320
    v_mfma_f32_16x16x32_bf16 v[56:59], a[40:43], a[20:23], v[56:59]
    ds_read_b64_tr_b16 a[38:39], v1 offset:13088
    v_mfma_f32_16x16x32_bf16 v[80:83], a[40:43], a[24:27], v[80:83]
    ds_read_b128 a[8:11], v12 offset:36864
    v_mfma_f32_16x16x32_bf16 v[104:107], a[40:43], a[28:31], v[104:107]
    ds_read_b128 a[12:15], v12 offset:38912
    s_waitcnt lgkmcnt(8)
    v_mfma_f32_16x16x32_bf16 v[36:39], a[44:47], a[16:19], v[36:39]
    ds_read_b64_tr_b16 a[40:41], v2 offset:0
    v_mfma_f32_16x16x32_bf16 v[60:63], a[44:47], a[20:23], v[60:63]
    ds_read_b64_tr_b16 a[42:43], v2 offset:768
    v_mfma_f32_16x16x32_bf16 v[84:87], a[44:47], a[24:27], v[84:87]
    v_mfma_f32_16x16x32_bf16 v[108:111], a[44:47], a[28:31], v[108:111]
    s_waitcnt lgkmcnt(2)
    v_add_u32 v5, 4294893472, v5
    v_add_u32 v6, 4294893472, v6
    v_add_u32 v7, 4294893472, v7
    v_mfma_f32_16x16x32_bf16 a[52:55], a[48:51], a[32:35], a[52:55]
    ds_read_b64_tr_b16 a[44:45], v2 offset:12320
    v_mfma_f32_16x16x32_bf16 v[16:19], a[32:35], a[0:3], v[16:19]
    ds_read_b64_tr_b16 a[46:47], v2 offset:13088
    v_mfma_f32_16x16x32_bf16 v[40:43], a[32:35], a[4:7], v[40:43]
    v_mfma_f32_16x16x32_bf16 v[64:67], a[32:35], a[8:11], v[64:67]
    v_mfma_f32_16x16x32_bf16 v[88:91], a[32:35], a[12:15], v[88:91]
    s_waitcnt lgkmcnt(6)
    v_mfma_f32_16x16x32_bf16 a[60:63], a[48:51], a[36:39], a[60:63]
    ds_read_b64_tr_b16 a[32:33], v3 offset:0
    v_mfma_f32_16x16x32_bf16 v[20:23], a[36:39], a[0:3], v[20:23]
    ds_read_b64_tr_b16 a[34:35], v3 offset:768
    v_mfma_f32_16x16x32_bf16 v[44:47], a[36:39], a[4:7], v[44:47]
    ds_read_b128 a[16:19], v13 offset:33792
    v_mfma_f32_16x16x32_bf16 v[68:71], a[36:39], a[8:11], v[68:71]
    v_mfma_f32_16x16x32_bf16 v[92:95], a[36:39], a[12:15], v[92:95]
    s_waitcnt lgkmcnt(5)
    v_mfma_f32_16x16x32_bf16 a[64:67], a[48:51], a[40:43], a[64:67]
    ds_read_b64_tr_b16 a[36:37], v3 offset:12320
    v_mfma_f32_16x16x32_bf16 v[24:27], a[40:43], a[0:3], v[24:27]
    ds_read_b64_tr_b16 a[38:39], v3 offset:13088
    v_mfma_f32_16x16x32_bf16 v[48:51], a[40:43], a[4:7], v[48:51]
    ds_read_b128 a[20:23], v13 offset:35840
    v_mfma_f32_16x16x32_bf16 v[72:75], a[40:43], a[8:11], v[72:75]
    v_mfma_f32_16x16x32_bf16 v[96:99], a[40:43], a[12:15], v[96:99]
    s_waitcnt lgkmcnt(6)
    v_mfma_f32_16x16x32_bf16 a[68:71], a[48:51], a[44:47], a[68:71]
    ds_read_b64_tr_b16 a[40:41], v5 offset:6144
    v_mfma_f32_16x16x32_bf16 v[28:31], a[44:47], a[0:3], v[28:31]
    ds_read_b64_tr_b16 a[42:43], v5 offset:6912
    v_mfma_f32_16x16x32_bf16 v[52:55], a[44:47], a[4:7], v[52:55]
    ds_read_b128 a[24:27], v13 offset:37888
    v_mfma_f32_16x16x32_bf16 v[76:79], a[44:47], a[8:11], v[76:79]
    v_mfma_f32_16x16x32_bf16 v[100:103], a[44:47], a[12:15], v[100:103]
    s_waitcnt lgkmcnt(7)
    v_mfma_f32_16x16x32_bf16 a[72:75], a[48:51], a[32:35], a[72:75]
    ds_read_b64_tr_b16 a[44:45], v5 offset:18464
    v_mfma_f32_16x16x32_bf16 v[32:35], a[32:35], a[0:3], v[32:35]
    ds_read_b64_tr_b16 a[46:47], v5 offset:19232
    v_mfma_f32_16x16x32_bf16 v[56:59], a[32:35], a[4:7], v[56:59]
    ds_read_b128 a[28:31], v13 offset:39936
    v_mfma_f32_16x16x32_bf16 v[80:83], a[32:35], a[8:11], v[80:83]
    v_mfma_f32_16x16x32_bf16 v[104:107], a[32:35], a[12:15], v[104:107]
    s_waitcnt lgkmcnt(7)
    v_mfma_f32_16x16x32_bf16 a[76:79], a[48:51], a[36:39], a[76:79]
    ds_read_b64_tr_b16 a[32:33], v6 offset:6144
    v_mfma_f32_16x16x32_bf16 v[36:39], a[36:39], a[0:3], v[36:39]
    ds_read_b64_tr_b16 a[34:35], v6 offset:6912
    v_mfma_f32_16x16x32_bf16 v[60:63], a[36:39], a[4:7], v[60:63]
    v_mfma_f32_16x16x32_bf16 v[84:87], a[36:39], a[8:11], v[84:87]
    v_mfma_f32_16x16x32_bf16 v[108:111], a[36:39], a[12:15], v[108:111]
    s_waitcnt lgkmcnt(2)
    v_mfma_f32_16x16x32_bf16 v[16:19], a[40:43], a[16:19], v[16:19]
    ds_read_b64_tr_b16 a[36:37], v6 offset:18464
    v_mfma_f32_16x16x32_bf16 v[40:43], a[40:43], a[20:23], v[40:43]
    ds_read_b64_tr_b16 a[38:39], v6 offset:19232
    v_mfma_f32_16x16x32_bf16 v[64:67], a[40:43], a[24:27], v[64:67]
    v_mfma_f32_16x16x32_bf16 v[88:91], a[40:43], a[28:31], v[88:91]
    s_waitcnt lgkmcnt(5)
    v_mfma_f32_16x16x32_bf16 v[20:23], a[44:47], a[16:19], v[20:23]
    ds_read_b64_tr_b16 a[40:41], v7 offset:6144
    v_mfma_f32_16x16x32_bf16 v[44:47], a[44:47], a[20:23], v[44:47]
    ds_read_b64_tr_b16 a[42:43], v7 offset:6912
    v_mfma_f32_16x16x32_bf16 v[68:71], a[44:47], a[24:27], v[68:71]
    v_mfma_f32_16x16x32_bf16 v[92:95], a[44:47], a[28:31], v[92:95]
    s_waitcnt lgkmcnt(4)
    v_mfma_f32_16x16x32_bf16 v[24:27], a[32:35], a[16:19], v[24:27]
    ds_read_b64_tr_b16 a[44:45], v7 offset:18464
    v_mfma_f32_16x16x32_bf16 v[48:51], a[32:35], a[20:23], v[48:51]
    ds_read_b64_tr_b16 a[46:47], v7 offset:19232
    v_mfma_f32_16x16x32_bf16 v[72:75], a[32:35], a[24:27], v[72:75]
    v_mfma_f32_16x16x32_bf16 v[96:99], a[32:35], a[28:31], v[96:99]
    s_waitcnt lgkmcnt(4)
    s_barrier
    v_add_u32 v1, 24608, v1
    v_add_u32 v2, 24608, v2
    v_add_u32 v3, 24608, v3
    v_mfma_f32_16x16x32_bf16 v[28:31], a[36:39], a[16:19], v[28:31]
    ds_read_b64_tr_b16 a[32:33], v1 offset:0
    v_mfma_f32_16x16x32_bf16 v[52:55], a[36:39], a[20:23], v[52:55]
    ds_read_b64_tr_b16 a[34:35], v1 offset:768
    v_mfma_f32_16x16x32_bf16 v[76:79], a[36:39], a[24:27], v[76:79]
    ds_read_b128 a[0:3], v12 offset:0
    v_mfma_f32_16x16x32_bf16 v[100:103], a[36:39], a[28:31], v[100:103]
    ds_read_b128 a[4:7], v12 offset:2048
    s_waitcnt lgkmcnt(6)
    v_mfma_f32_16x16x32_bf16 v[32:35], a[40:43], a[16:19], v[32:35]
    ds_read_b64_tr_b16 a[36:37], v1 offset:12320
    v_mfma_f32_16x16x32_bf16 v[56:59], a[40:43], a[20:23], v[56:59]
    ds_read_b64_tr_b16 a[38:39], v1 offset:13088
    v_mfma_f32_16x16x32_bf16 v[80:83], a[40:43], a[24:27], v[80:83]
    ds_read_b128 a[8:11], v12 offset:4096
    v_mfma_f32_16x16x32_bf16 v[104:107], a[40:43], a[28:31], v[104:107]
    ds_read_b128 a[12:15], v12 offset:6144
    s_waitcnt lgkmcnt(8)
    v_mfma_f32_16x16x32_bf16 v[36:39], a[44:47], a[16:19], v[36:39]
    ds_read_b64_tr_b16 a[40:41], v2 offset:0
    v_mfma_f32_16x16x32_bf16 v[60:63], a[44:47], a[20:23], v[60:63]
    ds_read_b64_tr_b16 a[42:43], v2 offset:768
    v_mfma_f32_16x16x32_bf16 v[84:87], a[44:47], a[24:27], v[84:87]
    v_mfma_f32_16x16x32_bf16 v[108:111], a[44:47], a[28:31], v[108:111]
    s_waitcnt lgkmcnt(2)
    v_add_u32 v5, 24608, v5
    v_add_u32 v6, 24608, v6
    v_add_u32 v7, 24608, v7
    v_mfma_f32_16x16x32_bf16 a[52:55], a[48:51], a[32:35], a[52:55]
    ds_read_b64_tr_b16 a[44:45], v2 offset:12320
    v_mfma_f32_16x16x32_bf16 v[16:19], a[32:35], a[0:3], v[16:19]
    ds_read_b64_tr_b16 a[46:47], v2 offset:13088
    v_mfma_f32_16x16x32_bf16 v[40:43], a[32:35], a[4:7], v[40:43]
    v_mfma_f32_16x16x32_bf16 v[64:67], a[32:35], a[8:11], v[64:67]
    v_mfma_f32_16x16x32_bf16 v[88:91], a[32:35], a[12:15], v[88:91]
    s_waitcnt lgkmcnt(6)
    v_mfma_f32_16x16x32_bf16 a[60:63], a[48:51], a[36:39], a[60:63]
    ds_read_b64_tr_b16 a[32:33], v3 offset:0
    v_mfma_f32_16x16x32_bf16 v[20:23], a[36:39], a[0:3], v[20:23]
    ds_read_b64_tr_b16 a[34:35], v3 offset:768
    v_mfma_f32_16x16x32_bf16 v[44:47], a[36:39], a[4:7], v[44:47]
    ds_read_b128 a[16:19], v13 offset:1024
    v_mfma_f32_16x16x32_bf16 v[68:71], a[36:39], a[8:11], v[68:71]
    v_mfma_f32_16x16x32_bf16 v[92:95], a[36:39], a[12:15], v[92:95]
    s_waitcnt lgkmcnt(5)
    v_mfma_f32_16x16x32_bf16 a[64:67], a[48:51], a[40:43], a[64:67]
    ds_read_b64_tr_b16 a[36:37], v3 offset:12320
    v_mfma_f32_16x16x32_bf16 v[24:27], a[40:43], a[0:3], v[24:27]
    ds_read_b64_tr_b16 a[38:39], v3 offset:13088
    v_mfma_f32_16x16x32_bf16 v[48:51], a[40:43], a[4:7], v[48:51]
    ds_read_b128 a[20:23], v13 offset:3072
    v_mfma_f32_16x16x32_bf16 v[72:75], a[40:43], a[8:11], v[72:75]
    v_mfma_f32_16x16x32_bf16 v[96:99], a[40:43], a[12:15], v[96:99]
    s_waitcnt lgkmcnt(6)
    v_mfma_f32_16x16x32_bf16 a[68:71], a[48:51], a[44:47], a[68:71]
    ds_read_b64_tr_b16 a[40:41], v5 offset:6144
    v_mfma_f32_16x16x32_bf16 v[28:31], a[44:47], a[0:3], v[28:31]
    ds_read_b64_tr_b16 a[42:43], v5 offset:6912
    v_mfma_f32_16x16x32_bf16 v[52:55], a[44:47], a[4:7], v[52:55]
    ds_read_b128 a[24:27], v13 offset:5120
    v_mfma_f32_16x16x32_bf16 v[76:79], a[44:47], a[8:11], v[76:79]
    v_mfma_f32_16x16x32_bf16 v[100:103], a[44:47], a[12:15], v[100:103]
    s_waitcnt lgkmcnt(7)
    v_mfma_f32_16x16x32_bf16 a[72:75], a[48:51], a[32:35], a[72:75]
    ds_read_b64_tr_b16 a[44:45], v5 offset:18464
    v_mfma_f32_16x16x32_bf16 v[32:35], a[32:35], a[0:3], v[32:35]
    ds_read_b64_tr_b16 a[46:47], v5 offset:19232
    v_mfma_f32_16x16x32_bf16 v[56:59], a[32:35], a[4:7], v[56:59]
    ds_read_b128 a[28:31], v13 offset:7168
    v_mfma_f32_16x16x32_bf16 v[80:83], a[32:35], a[8:11], v[80:83]
    v_mfma_f32_16x16x32_bf16 v[104:107], a[32:35], a[12:15], v[104:107]
    s_waitcnt lgkmcnt(7)
    v_mfma_f32_16x16x32_bf16 a[76:79], a[48:51], a[36:39], a[76:79]
    ds_read_b64_tr_b16 a[32:33], v6 offset:6144
    v_mfma_f32_16x16x32_bf16 v[36:39], a[36:39], a[0:3], v[36:39]
    ds_read_b64_tr_b16 a[34:35], v6 offset:6912
    v_mfma_f32_16x16x32_bf16 v[60:63], a[36:39], a[4:7], v[60:63]
    v_mfma_f32_16x16x32_bf16 v[84:87], a[36:39], a[8:11], v[84:87]
    v_mfma_f32_16x16x32_bf16 v[108:111], a[36:39], a[12:15], v[108:111]
    s_mul_i32 s27, s37, 1536
    s_add_u32 s27, s27, 147648
    v_and_b32 v2, 31, v0
    v_lshlrev_b32 v2, 3, v2
    v_add_u32 v2, s27, v2
    s_lshl_b32 s28, s36, 7
    s_add_u32 s27, s27, s28
    v_and_b32 v3, 15, v0
    v_lshlrev_b32 v3, 3, v3
    v_add_u32 v1, s27, v3
    s_lshl_b32 s27, s36, 9
    s_add_u32 s27, s27, 150720
    v_add_u32 v3, s27, v3
    s_mov_b32 exec_lo, 0
    v_mov_b32 v3, 152256
    s_mov_b32 exec_lo, -1
    s_waitcnt lgkmcnt(2)
    v_mfma_f32_16x16x32_bf16 v[16:19], a[40:43], a[16:19], v[16:19]
    ds_read_b64_tr_b16 a[36:37], v6 offset:18464
    v_accvgpr_read_b32 v12, a52
    v_mfma_f32_16x16x32_bf16 v[40:43], a[40:43], a[20:23], v[40:43]
    ds_read_b64_tr_b16 a[38:39], v6 offset:19232
    v_cvt_pk_bf16_f32 v9, v12, v12
    v_mfma_f32_16x16x32_bf16 v[64:67], a[40:43], a[24:27], v[64:67]
    v_and_b32 v9, 0xffff0000, v9
    v_sub_f32 v12, v12, v9
    v_cvt_pk_bf16_f32 v8, v9, v12
    v_mfma_f32_16x16x32_bf16 v[88:91], a[40:43], a[28:31], v[88:91]
    v_lshrrev_b32 v9, 16, v9
    ds_write_b64 v1, v[8:9] offset:0
    v_accvgpr_read_b32 v12, a60
    s_waitcnt lgkmcnt(6)
    v_mfma_f32_16x16x32_bf16 v[20:23], a[44:47], a[16:19], v[20:23]
    ds_read_b64_tr_b16 a[40:41], v7 offset:6144
    v_cvt_pk_bf16_f32 v11, v12, v12
    v_mfma_f32_16x16x32_bf16 v[44:47], a[44:47], a[20:23], v[44:47]
    ds_read_b64_tr_b16 a[42:43], v7 offset:6912
    v_and_b32 v11, 0xffff0000, v11
    v_mfma_f32_16x16x32_bf16 v[68:71], a[44:47], a[24:27], v[68:71]
    v_sub_f32 v12, v12, v11
    v_cvt_pk_bf16_f32 v10, v11, v12
    v_lshrrev_b32 v11, 16, v11
    v_mfma_f32_16x16x32_bf16 v[92:95], a[44:47], a[28:31], v[92:95]
    ds_write_b64 v1, v[10:11] offset:256
    v_accvgpr_read_b32 v12, a64
    v_cvt_pk_bf16_f32 v9, v12, v12
    s_waitcnt lgkmcnt(6)
    v_mfma_f32_16x16x32_bf16 v[24:27], a[32:35], a[16:19], v[24:27]
    ds_read_b64_tr_b16 a[44:45], v7 offset:18464
    v_and_b32 v9, 0xffff0000, v9
    v_mfma_f32_16x16x32_bf16 v[48:51], a[32:35], a[20:23], v[48:51]
    ds_read_b64_tr_b16 a[46:47], v7 offset:19232
    v_sub_f32 v12, v12, v9
    v_mfma_f32_16x16x32_bf16 v[72:75], a[32:35], a[24:27], v[72:75]
    v_cvt_pk_bf16_f32 v8, v9, v12
    v_lshrrev_b32 v9, 16, v9
    ds_write_b64 v1, v[8:9] offset:512
    v_mfma_f32_16x16x32_bf16 v[96:99], a[32:35], a[28:31], v[96:99]
    v_accvgpr_read_b32 v12, a68
    v_cvt_pk_bf16_f32 v11, v12, v12
    v_and_b32 v11, 0xffff0000, v11
    s_waitcnt lgkmcnt(7)
    v_mfma_f32_16x16x32_bf16 v[28:31], a[36:39], a[16:19], v[28:31]
    v_sub_f32 v12, v12, v11
    v_cvt_pk_bf16_f32 v10, v11, v12
    v_lshrrev_b32 v11, 16, v11
    v_mfma_f32_16x16x32_bf16 v[52:55], a[36:39], a[20:23], v[52:55]
    ds_write_b64 v1, v[10:11] offset:768
    v_accvgpr_read_b32 v12, a72
    v_cvt_pk_bf16_f32 v9, v12, v12
    v_mfma_f32_16x16x32_bf16 v[76:79], a[36:39], a[24:27], v[76:79]
    v_and_b32 v9, 0xffff0000, v9
    v_sub_f32 v12, v12, v9
    v_cvt_pk_bf16_f32 v8, v9, v12
    v_mfma_f32_16x16x32_bf16 v[100:103], a[36:39], a[28:31], v[100:103]
    v_lshrrev_b32 v9, 16, v9
    ds_write_b64 v1, v[8:9] offset:1024
    v_accvgpr_read_b32 v12, a76
    s_waitcnt lgkmcnt(6)
    v_mfma_f32_16x16x32_bf16 v[32:35], a[40:43], a[16:19], v[32:35]
    v_cvt_pk_bf16_f32 v11, v12, v12
    v_and_b32 v11, 0xffff0000, v11
    v_sub_f32 v12, v12, v11
    v_mfma_f32_16x16x32_bf16 v[56:59], a[40:43], a[20:23], v[56:59]
    v_cvt_pk_bf16_f32 v10, v11, v12
    v_lshrrev_b32 v11, 16, v11
    ds_write_b64 v1, v[10:11] offset:1280
    v_mfma_f32_16x16x32_bf16 v[80:83], a[40:43], a[24:27], v[80:83]
    v_mfma_f32_16x16x32_bf16 v[104:107], a[40:43], a[28:31], v[104:107]
    s_waitcnt lgkmcnt(4)
    s_waitcnt lgkmcnt(0)
    s_barrier
    v_mfma_f32_16x16x32_bf16 v[36:39], a[44:47], a[16:19], v[36:39]
    ds_read_b64 v[6:7], v3
    ds_read_b64 a[0:1], v2 offset:0
    ds_read_b64 a[2:3], v2 offset:256
    v_mfma_f32_16x16x32_bf16 v[60:63], a[44:47], a[20:23], v[60:63]
    ds_read_b64 a[4:5], v2 offset:512
    ds_read_b64 a[6:7], v2 offset:768
    ds_read_b64 a[8:9], v2 offset:1024
    v_mfma_f32_16x16x32_bf16 v[84:87], a[44:47], a[24:27], v[84:87]
    ds_read_b64 a[10:11], v2 offset:1280
    ds_read_b64 v[8:9], v3 offset:128
    ds_read_b64 v[10:11], v3 offset:256
    v_mfma_f32_16x16x32_bf16 v[108:111], a[44:47], a[28:31], v[108:111]
    ds_read_b64 v[12:13], v3 offset:384
    s_and_b32 s49, s41, -8
    s_lshl_b32 s27, s36, 2
    s_add_u32 s49, s49, s27
    s_mul_i32 s49, s49, 49152
    s_mul_i32 s27, s42, 3072
    s_add_u32 s49, s49, s27
    s_mul_i32 s27, s37, 1536
    s_add_u32 s49, s49, s27
    s_add_u32 s49, s49, 0xc80000
    s_waitcnt lgkmcnt(3)
    v_mfma_f32_16x16x16_bf16 v[16:19], a[0:1], v[6:7], v[16:19]
    v_mfma_f32_16x16x16_bf16 v[20:23], a[2:3], v[6:7], v[20:23]
    v_mfma_f32_16x16x16_bf16 v[24:27], a[4:5], v[6:7], v[24:27]
    v_mfma_f32_16x16x16_bf16 v[28:31], a[6:7], v[6:7], v[28:31]
    v_mfma_f32_16x16x16_bf16 v[32:35], a[8:9], v[6:7], v[32:35]
    v_mfma_f32_16x16x16_bf16 v[36:39], a[10:11], v[6:7], v[36:39]
    s_waitcnt lgkmcnt(0)
    v_mfma_f32_16x16x16_bf16 v[40:43], a[0:1], v[8:9], v[40:43]
    s_nop 0
    v_max_f32 v16, 0, v16
    v_max_f32 v17, 0, v17
    v_max_f32 v18, 0, v18
    v_mfma_f32_16x16x16_bf16 v[44:47], a[2:3], v[8:9], v[44:47]
    v_max_f32 v19, 0, v19
    v_mul_f32 v16, v16, v20
    v_mul_f32 v17, v17, v21
    v_mfma_f32_16x16x16_bf16 v[48:51], a[4:5], v[8:9], v[48:51]
    v_mul_f32 v18, v18, v22
    v_mul_f32 v19, v19, v23
    v_max_f32 v24, 0, v24
    v_mfma_f32_16x16x16_bf16 v[52:55], a[6:7], v[8:9], v[52:55]
    v_max_f32 v25, 0, v25
    v_max_f32 v26, 0, v26
    v_max_f32 v27, 0, v27
    v_mfma_f32_16x16x16_bf16 v[56:59], a[8:9], v[8:9], v[56:59]
    v_mul_f32 v24, v24, v28
    v_mul_f32 v25, v25, v29
    v_mul_f32 v26, v26, v30
    v_mfma_f32_16x16x16_bf16 v[60:63], a[10:11], v[8:9], v[60:63]
    v_mul_f32 v27, v27, v31
    v_max_f32 v32, 0, v32
    v_max_f32 v33, 0, v33
    v_max_f32 v34, 0, v34
    v_max_f32 v35, 0, v35
    v_mul_f32 v32, v32, v36
    v_mul_f32 v33, v33, v37
    v_mul_f32 v34, v34, v38
    v_mul_f32 v35, v35, v39
    v_cvt_pk_bf16_f32 v16, v16, v17
    v_cvt_pk_bf16_f32 v17, v18, v19
    v_cvt_pk_bf16_f32 v18, v24, v25
    v_cvt_pk_bf16_f32 v19, v26, v27
    v_cvt_pk_bf16_f32 v36, v32, v33
    v_cvt_pk_bf16_f32 v37, v34, v35
    v_permlane16_swap_b32 v16, v18
    v_permlane16_swap_b32 v17, v19
    s_add_u32 s29, s49, 0
    buffer_store_dwordx4 v[16:19], v14, s[8:11], s29 offen sc1
    v_mfma_f32_16x16x16_bf16 v[64:67], a[0:1], v[10:11], v[64:67]
    v_max_f32 v40, 0, v40
    v_max_f32 v41, 0, v41
    v_max_f32 v42, 0, v42
    v_mfma_f32_16x16x16_bf16 v[68:71], a[2:3], v[10:11], v[68:71]
    v_max_f32 v43, 0, v43
    v_mul_f32 v40, v40, v44
    v_mul_f32 v41, v41, v45
    v_mfma_f32_16x16x16_bf16 v[72:75], a[4:5], v[10:11], v[72:75]
    v_mul_f32 v42, v42, v46
    v_mul_f32 v43, v43, v47
    v_max_f32 v48, 0, v48
    v_mfma_f32_16x16x16_bf16 v[76:79], a[6:7], v[10:11], v[76:79]
    v_max_f32 v49, 0, v49
    v_max_f32 v50, 0, v50
    v_max_f32 v51, 0, v51
    v_mfma_f32_16x16x16_bf16 v[80:83], a[8:9], v[10:11], v[80:83]
    v_mul_f32 v48, v48, v52
    v_mul_f32 v49, v49, v53
    v_mul_f32 v50, v50, v54
    v_mfma_f32_16x16x16_bf16 v[84:87], a[10:11], v[10:11], v[84:87]
    v_mul_f32 v51, v51, v55
    v_max_f32 v56, 0, v56
    v_max_f32 v57, 0, v57
    v_max_f32 v58, 0, v58
    v_max_f32 v59, 0, v59
    v_mul_f32 v56, v56, v60
    v_mul_f32 v57, v57, v61
    v_mul_f32 v58, v58, v62
    v_mul_f32 v59, v59, v63
    v_cvt_pk_bf16_f32 v40, v40, v41
    v_cvt_pk_bf16_f32 v41, v42, v43
    v_cvt_pk_bf16_f32 v42, v48, v49
    v_cvt_pk_bf16_f32 v43, v50, v51
    v_cvt_pk_bf16_f32 v38, v56, v57
    v_cvt_pk_bf16_f32 v39, v58, v59
    v_permlane16_swap_b32 v40, v42
    v_permlane16_swap_b32 v41, v43
    s_add_u32 s29, s49, 49152
    buffer_store_dwordx4 v[40:43], v14, s[8:11], s29 offen sc1
    v_permlane16_swap_b32 v36, v38
    v_permlane16_swap_b32 v37, v39
    s_add_u32 s29, s49, 0
    buffer_store_dwordx4 v[36:39], v15, s[8:11], s29 offen offset:1024 sc1
    v_mfma_f32_16x16x16_bf16 v[88:91], a[0:1], v[12:13], v[88:91]
    v_max_f32 v64, 0, v64
    v_max_f32 v65, 0, v65
    v_max_f32 v66, 0, v66
    v_mfma_f32_16x16x16_bf16 v[92:95], a[2:3], v[12:13], v[92:95]
    v_max_f32 v67, 0, v67
    v_mul_f32 v64, v64, v68
    v_mul_f32 v65, v65, v69
    v_mfma_f32_16x16x16_bf16 v[96:99], a[4:5], v[12:13], v[96:99]
    v_mul_f32 v66, v66, v70
    v_mul_f32 v67, v67, v71
    v_max_f32 v72, 0, v72
    v_mfma_f32_16x16x16_bf16 v[100:103], a[6:7], v[12:13], v[100:103]
    v_max_f32 v73, 0, v73
    v_max_f32 v74, 0, v74
    v_max_f32 v75, 0, v75
    v_mfma_f32_16x16x16_bf16 v[104:107], a[8:9], v[12:13], v[104:107]
    v_mul_f32 v72, v72, v76
    v_mul_f32 v73, v73, v77
    v_mul_f32 v74, v74, v78
    v_mfma_f32_16x16x16_bf16 v[108:111], a[10:11], v[12:13], v[108:111]
    v_mul_f32 v75, v75, v79
    v_max_f32 v80, 0, v80
    v_max_f32 v81, 0, v81
    v_max_f32 v82, 0, v82
    v_max_f32 v83, 0, v83
    v_mul_f32 v80, v80, v84
    v_mul_f32 v81, v81, v85
    v_mul_f32 v82, v82, v86
    v_mul_f32 v83, v83, v87
    v_cvt_pk_bf16_f32 v64, v64, v65
    v_cvt_pk_bf16_f32 v65, v66, v67
    v_cvt_pk_bf16_f32 v66, v72, v73
    v_cvt_pk_bf16_f32 v67, v74, v75
    v_cvt_pk_bf16_f32 v84, v80, v81
    v_cvt_pk_bf16_f32 v85, v82, v83
    v_permlane16_swap_b32 v64, v66
    v_permlane16_swap_b32 v65, v67
    s_add_u32 s29, s49, 98304
    buffer_store_dwordx4 v[64:67], v14, s[8:11], s29 offen sc1
    v_max_f32 v88, 0, v88
    v_max_f32 v89, 0, v89
    v_max_f32 v90, 0, v90
    v_max_f32 v91, 0, v91
    v_pk_mul_f32 v[88:89], v[88:89], v[92:93]
    v_pk_mul_f32 v[90:91], v[90:91], v[94:95]
    v_max_f32 v96, 0, v96
    v_max_f32 v97, 0, v97
    v_max_f32 v98, 0, v98
    v_max_f32 v99, 0, v99
    v_pk_mul_f32 v[96:97], v[96:97], v[100:101]
    v_pk_mul_f32 v[98:99], v[98:99], v[102:103]
    v_max_f32 v104, 0, v104
    v_max_f32 v105, 0, v105
    v_max_f32 v106, 0, v106
    v_max_f32 v107, 0, v107
    v_pk_mul_f32 v[104:105], v[104:105], v[108:109]
    v_pk_mul_f32 v[106:107], v[106:107], v[110:111]
    v_cvt_pk_bf16_f32 v88, v88, v89
    v_cvt_pk_bf16_f32 v89, v90, v91
    v_cvt_pk_bf16_f32 v90, v96, v97
    v_cvt_pk_bf16_f32 v91, v98, v99
    v_cvt_pk_bf16_f32 v86, v104, v105
    v_cvt_pk_bf16_f32 v87, v106, v107
    v_permlane16_swap_b32 v88, v90
    v_permlane16_swap_b32 v89, v91
    s_add_u32 s29, s49, 147456
    buffer_store_dwordx4 v[88:91], v14, s[8:11], s29 offen sc1
    v_permlane16_swap_b32 v84, v86
    v_permlane16_swap_b32 v85, v87
    s_add_u32 s29, s49, 98304
    buffer_store_dwordx4 v[84:87], v15, s[8:11], s29 offen offset:1024 sc1
L_gu_epi_done:
    s_add_u32 s27, s45, 15360
    buffer_load_dwordx4 a[60:63], v4, s[8:11], s27 offen sc1
    s_add_u32 s27, s45, 16384
    buffer_load_dwordx4 a[64:67], v4, s[8:11], s27 offen sc1
    s_add_u32 s27, s45, 17408
    buffer_load_dwordx4 a[68:71], v4, s[8:11], s27 offen sc1
    s_add_u32 s27, s45, 18432
    buffer_load_dwordx4 a[72:75], v4, s[8:11], s27 offen sc1
    s_add_u32 s27, s45, 19456
    buffer_load_dwordx4 a[76:79], v4, s[8:11], s27 offen sc1
    s_branch L_gu_done
L_gu_loader:
    s_waitcnt vmcnt(3)
    buffer_load_dwordx4 v[28:31], v13, s[8:11], s49 offen sc1
    v_mfma_f32_16x16x32_bf16 v[56:59], a[80:83], v[32:35], 0
    v_mfma_f32_16x16x32_bf16 v[60:63], a[84:87], v[32:35], 0
    v_mfma_f32_16x16x32_bf16 v[72:75], a[96:99], v[32:35], 0
    v_mfma_f32_16x16x32_bf16 v[64:67], a[88:91], v[32:35], 0
    v_mfma_f32_16x16x32_bf16 v[68:71], a[92:95], v[32:35], 0
    s_waitcnt vmcnt(3)
    buffer_load_dwordx2 v[52:53], v7, s[8:11], s96 offen offset:0 sc1
    buffer_load_dwordx2 v[54:55], v7, s[8:11], s96 offen offset:128 sc1
    v_mfma_f32_16x16x32_bf16 v[56:59], a[0:3], v[16:19], v[56:59]
    v_mfma_f32_16x16x32_bf16 v[60:63], a[4:7], v[16:19], v[60:63]
    v_mfma_f32_16x16x32_bf16 v[72:75], a[16:19], v[16:19], v[72:75]
    v_mfma_f32_16x16x32_bf16 v[64:67], a[8:11], v[16:19], v[64:67]
    v_mfma_f32_16x16x32_bf16 v[68:71], a[12:15], v[16:19], v[68:71]
    s_waitcnt vmcnt(4)
    buffer_load_dwordx4 v[36:39], v10, s[8:11], s96 offen sc1
    v_mfma_f32_16x16x32_bf16 v[56:59], a[20:23], v[20:23], v[56:59]
    v_mfma_f32_16x16x32_bf16 v[60:63], a[24:27], v[20:23], v[60:63]
    v_mfma_f32_16x16x32_bf16 v[72:75], a[36:39], v[20:23], v[72:75]
    v_mfma_f32_16x16x32_bf16 v[64:67], a[28:31], v[20:23], v[64:67]
    v_mfma_f32_16x16x32_bf16 v[68:71], a[32:35], v[20:23], v[68:71]
    s_waitcnt vmcnt(4)
    buffer_load_dwordx4 v[40:43], v11, s[8:11], s96 offen sc1
    v_mfma_f32_16x16x32_bf16 v[56:59], a[40:43], v[24:27], v[56:59]
    v_mfma_f32_16x16x32_bf16 v[60:63], a[44:47], v[24:27], v[60:63]
    v_mfma_f32_16x16x32_bf16 v[72:75], a[56:59], v[24:27], v[72:75]
    v_mfma_f32_16x16x32_bf16 v[64:67], a[48:51], v[24:27], v[64:67]
    v_mfma_f32_16x16x32_bf16 v[68:71], a[52:55], v[24:27], v[68:71]
    s_waitcnt vmcnt(4)
    buffer_load_dwordx4 v[44:47], v12, s[8:11], s96 offen sc1
    v_mfma_f32_16x16x32_bf16 v[56:59], a[60:63], v[28:31], v[56:59]
    v_mfma_f32_16x16x32_bf16 v[60:63], a[64:67], v[28:31], v[60:63]
    v_mfma_f32_16x16x32_bf16 v[72:75], a[76:79], v[28:31], v[72:75]
    v_mfma_f32_16x16x32_bf16 v[64:67], a[68:71], v[28:31], v[64:67]
    v_mfma_f32_16x16x32_bf16 v[68:71], a[72:75], v[28:31], v[68:71]
    s_waitcnt vmcnt(3)
    buffer_load_dwordx4 v[48:51], v13, s[8:11], s96 offen sc1
    v_mfma_f32_16x16x32_bf16 v[76:79], a[80:83], v[52:55], 0
    v_mfma_f32_16x16x32_bf16 v[80:83], a[84:87], v[52:55], 0
    v_mfma_f32_16x16x32_bf16 v[92:95], a[96:99], v[52:55], 0
    v_mfma_f32_16x16x32_bf16 v[84:87], a[88:91], v[52:55], 0
    v_mfma_f32_16x16x32_bf16 v[88:91], a[92:95], v[52:55], 0
    ds_write_b128 v3, v[56:59] offset:40960
    s_waitcnt vmcnt(3)
    v_mfma_f32_16x16x32_bf16 v[76:79], a[0:3], v[36:39], v[76:79]
    v_mfma_f32_16x16x32_bf16 v[80:83], a[4:7], v[36:39], v[80:83]
    v_mfma_f32_16x16x32_bf16 v[92:95], a[16:19], v[36:39], v[92:95]
    v_mfma_f32_16x16x32_bf16 v[84:87], a[8:11], v[36:39], v[84:87]
    v_mfma_f32_16x16x32_bf16 v[88:91], a[12:15], v[36:39], v[88:91]
    ds_write_b128 v3, v[60:63] offset:41984
    s_waitcnt vmcnt(2)
    v_mfma_f32_16x16x32_bf16 v[76:79], a[20:23], v[40:43], v[76:79]
    v_mfma_f32_16x16x32_bf16 v[80:83], a[24:27], v[40:43], v[80:83]
    v_mfma_f32_16x16x32_bf16 v[92:95], a[36:39], v[40:43], v[92:95]
    v_mfma_f32_16x16x32_bf16 v[84:87], a[28:31], v[40:43], v[84:87]
    v_mfma_f32_16x16x32_bf16 v[88:91], a[32:35], v[40:43], v[88:91]
    ds_write_b128 v3, v[72:75] offset:45056
    s_waitcnt vmcnt(1)
    v_mfma_f32_16x16x32_bf16 v[76:79], a[40:43], v[44:47], v[76:79]
    v_mfma_f32_16x16x32_bf16 v[80:83], a[44:47], v[44:47], v[80:83]
    v_mfma_f32_16x16x32_bf16 v[92:95], a[56:59], v[44:47], v[92:95]
    v_mfma_f32_16x16x32_bf16 v[84:87], a[48:51], v[44:47], v[84:87]
    v_mfma_f32_16x16x32_bf16 v[88:91], a[52:55], v[44:47], v[88:91]
    ds_write_b128 v3, v[64:67] offset:22528
    s_waitcnt vmcnt(0)
    v_mfma_f32_16x16x32_bf16 v[76:79], a[60:63], v[48:51], v[76:79]
    v_mfma_f32_16x16x32_bf16 v[80:83], a[64:67], v[48:51], v[80:83]
    v_mfma_f32_16x16x32_bf16 v[92:95], a[76:79], v[48:51], v[92:95]
    v_mfma_f32_16x16x32_bf16 v[84:87], a[68:71], v[48:51], v[84:87]
    v_mfma_f32_16x16x32_bf16 v[88:91], a[72:75], v[48:51], v[88:91]
    ds_write_b128 v3, v[68:71] offset:23552
    s_nop 2
    ds_write_b128 v6, v[76:79] offset:0
    ds_write_b128 v6, v[80:83] offset:1024
    ds_write_b128 v6, v[92:95] offset:4096
    s_add_u32 s27, s45, 10240
    buffer_load_dwordx4 a[80:83], v4, s[8:11], s27 offen sc1
    s_add_u32 s27, s45, 11264
    buffer_load_dwordx4 a[84:87], v4, s[8:11], s27 offen sc1
    s_add_u32 s27, s45, 12288
    buffer_load_dwordx4 a[88:91], v4, s[8:11], s27 offen sc1
    s_add_u32 s27, s45, 13312
    buffer_load_dwordx4 a[92:95], v4, s[8:11], s27 offen sc1
    s_waitcnt lgkmcnt(0)
    s_barrier
    ds_read_b128 v[16:19], v5 offset:0
    ds_read_b128 v[20:23], v5 offset:1024
    ds_read_b128 v[24:27], v5 offset:20480
    ds_read_b128 v[28:31], v5 offset:21504
    ds_read_b128 v[32:35], v5 offset:40960
    ds_read_b128 v[36:39], v5 offset:41984
    s_add_u32 s27, s45, 14336
    buffer_load_dwordx4 a[96:99], v4, s[8:11], s27 offen sc1
    v_lshlrev_b32 v56, 16, v100
    v_and_b32 v57, 0xffff0000, v100
    v_lshlrev_b32 v58, 16, v101
    v_and_b32 v59, 0xffff0000, v101
    v_lshlrev_b32 v60, 16, v102
    v_and_b32 v61, 0xffff0000, v102
    v_lshlrev_b32 v62, 16, v103
    v_and_b32 v63, 0xffff0000, v103
    v_pk_add_f32 v[84:85], v[84:85], v[56:57]
    v_pk_add_f32 v[86:87], v[86:87], v[58:59]
    v_pk_add_f32 v[88:89], v[88:89], v[60:61]
    v_pk_add_f32 v[90:91], v[90:91], v[62:63]
    v_mov_b32 v10, 0x3f803f80
    v_lshlrev_b32 v11, 3, v0
    s_waitcnt lgkmcnt(4)
    v_pk_add_f32 v[84:85], v[84:85], v[16:17]
    v_pk_add_f32 v[86:87], v[86:87], v[18:19]
    v_pk_add_f32 v[88:89], v[88:89], v[20:21]
    v_pk_add_f32 v[90:91], v[90:91], v[22:23]
    s_waitcnt lgkmcnt(2)
    v_pk_add_f32 v[84:85], v[84:85], v[24:25]
    v_pk_add_f32 v[86:87], v[86:87], v[26:27]
    v_pk_add_f32 v[88:89], v[88:89], v[28:29]
    v_pk_add_f32 v[90:91], v[90:91], v[30:31]
    s_waitcnt lgkmcnt(0)
    v_pk_add_f32 v[84:85], v[84:85], v[32:33]
    v_pk_add_f32 v[86:87], v[86:87], v[34:35]
    v_pk_add_f32 v[88:89], v[88:89], v[36:37]
    v_pk_add_f32 v[90:91], v[90:91], v[38:39]
    v_cvt_pk_bf16_f32 v16, v84, v85
    v_cvt_pk_bf16_f32 v17, v86, v87
    v_cvt_pk_bf16_f32 v18, v88, v89
    v_cvt_pk_bf16_f32 v19, v90, v91
    s_cmp_lg_u32 s43, 0
    s_cbranch_scc1 L_stf_19
    buffer_store_dwordx4 v[16:19], v108, s[8:11], 0 offen sc1
    s_branch L_ste_20
L_stf_19:
    buffer_store_dwordx4 v[16:19], v108, s[8:11], 0 offen
L_ste_20:
    v_dot2_f32_bf16 v24, v16, v10, 0
    v_dot2_f32_bf16 v25, v16, v16, 0
    v_dot2_f32_bf16 v24, v17, v10, v24
    v_dot2_f32_bf16 v25, v17, v17, v25
    v_dot2_f32_bf16 v24, v18, v10, v24
    v_dot2_f32_bf16 v25, v18, v18, v25
    v_dot2_f32_bf16 v24, v19, v10, v24
    v_dot2_f32_bf16 v25, v19, v19, v25
    v_accvgpr_write_b32 a140, v16
    v_accvgpr_write_b32 a141, v17
    v_accvgpr_write_b32 a142, v18
    v_mov_b32 v8, v24
    v_mov_b32 v9, v25
    s_nop 0
    v_permlane16_swap_b32 v24, v8
    v_permlane16_swap_b32 v25, v9
    v_pk_add_f32 v[24:25], v[24:25], v[8:9]
    v_mov_b32 v8, v24
    v_mov_b32 v9, v25
    s_nop 0
    v_permlane32_swap_b32 v24, v8
    v_permlane32_swap_b32 v25, v9
    v_pk_add_f32 v[24:25], v[24:25], v[8:9]
    s_mov_b64 exec, 0xffff
    s_cmp_lg_u32 s43, 0
    s_cbranch_scc1 L_stf_21
    buffer_store_dwordx2 v[24:25], v11, s[8:11], s30 offen sc1
    s_branch L_ste_22
L_stf_21:
    buffer_store_dwordx2 v[24:25], v11, s[8:11], s30 offen
L_ste_22:
    s_mov_b64 exec, -1
    v_accvgpr_write_b32 a143, v19
    v_bfe_u32 v10, v0, 4, 1
    v_lshrrev_b32 v11, 5, v0
    v_and_b32 v3, 15, v0
    v_lshlrev_b32 v3, 3, v3
    v_lshl_add_u32 v3, v10, 11, v3
    v_lshl_add_u32 v3, v11, 10, v3
    s_lshl_b32 s49, s33, 11
    s_add_u32 s49, s49, 0x1580000
    s_waitcnt vmcnt(0)
    s_barrier
    s_barrier
    s_add_u32 m0, s39, 100480
    s_add_u32 s27, s38, 20480
    buffer_load_dwordx4 v4, s[8:11], s27 offen sc1 lds
    s_add_u32 m0, s39, 101504
    s_add_u32 s27, s38, 21504
    buffer_load_dwordx4 v4, s[8:11], s27 offen sc1 lds
    s_add_u32 s38, s38, 2048
    s_cmp_eq_u32 s38, s90
    s_cselect_b32 s27, 20480, 0
    s_sub_u32 s38, s38, s27
    s_add_u32 m0, s39, 114816
    s_add_u32 s27, s38, 0
    buffer_load_dwordx4 v4, s[8:11], s27 offen sc1 lds
    s_add_u32 m0, s39, 115840
    s_add_u32 s27, s38, 1024
    buffer_load_dwordx4 v4, s[8:11], s27 offen sc1 lds
    s_add_u32 m0, s39, 116864
    s_add_u32 s27, s38, 20480
    buffer_load_dwordx4 v4, s[8:11], s27 offen sc1 lds
    s_add_u32 m0, s39, 117888
    s_add_u32 s27, s38, 21504
    buffer_load_dwordx4 v4, s[8:11], s27 offen sc1 lds
    s_add_u32 s38, s38, 2048
    s_cmp_eq_u32 s38, s90
    s_cselect_b32 s27, 20480, 0
    s_sub_u32 s38, s38, s27
    s_setprio 0
    s_waitcnt vmcnt(4)
    s_barrier
    s_add_u32 m0, s39, 131200
    s_add_u32 s27, s38, 0
    buffer_load_dwordx4 v4, s[8:11], s27 offen sc1 lds
    s_add_u32 m0, s39, 132224
    s_add_u32 s27, s38, 1024
    buffer_load_dwordx4 v4, s[8:11], s27 offen sc1 lds
    s_add_u32 m0, s39, 133248
    s_add_u32 s27, s38, 20480
    buffer_load_dwordx4 v4, s[8:11], s27 offen sc1 lds
    s_add_u32 m0, s39, 134272
    s_add_u32 s27, s38, 21504
    buffer_load_dwordx4 v4, s[8:11], s27 offen sc1 lds
    s_add_u32 s38, s38, 2048
    s_cmp_eq_u32 s38, s90
    s_cselect_b32 s27, 20480, 0
    s_sub_u32 s38, s38, s27
    buffer_load_dwordx2 v[72:73], v3, s[8:11], s49 offen offset:0 sc1
    buffer_load_dwordx2 v[74:75], v3, s[8:11], s49 offen offset:128 sc1
    buffer_load_dwordx2 v[76:77], v3, s[8:11], s49 offen offset:256 sc1
    buffer_load_dwordx2 v[78:79], v3, s[8:11], s49 offen offset:384 sc1
    buffer_load_dwordx2 v[80:81], v3, s[8:11], s49 offen offset:512 sc1
    buffer_load_dwordx2 v[82:83], v3, s[8:11], s49 offen offset:640 sc1
    buffer_load_dwordx2 v[84:85], v3, s[8:11], s49 offen offset:768 sc1
    buffer_load_dwordx2 v[86:87], v3, s[8:11], s49 offen offset:896 sc1
    s_waitcnt vmcnt(12)
    s_barrier
    s_add_u32 m0, s39, 98432
    s_add_u32 s27, s38, 0
    buffer_load_dwordx4 v4, s[8:11], s27 offen sc1 lds
    s_add_u32 m0, s39, 99456
    s_add_u32 s27, s38, 1024
    buffer_load_dwordx4 v4, s[8:11], s27 offen sc1 lds
    s_add_u32 m0, s39, 100480
    s_add_u32 s27, s38, 20480
    buffer_load_dwordx4 v4, s[8:11], s27 offen sc1 lds
    s_add_u32 m0, s39, 101504
    s_add_u32 s27, s38, 21504
    buffer_load_dwordx4 v4, s[8:11], s27 offen sc1 lds
    s_add_u32 s38, s38, 2048
    s_cmp_eq_u32 s38, s90
    s_cselect_b32 s27, 20480, 0
    s_sub_u32 s38, s38, s27
    s_add_u32 s27, s45, 15360
    buffer_load_dwordx4 a[60:63], v4, s[8:11], s27 offen sc1
    s_add_u32 s27, s45, 16384
    buffer_load_dwordx4 a[64:67], v4, s[8:11], s27 offen sc1
    s_add_u32 s27, s45, 17408
    buffer_load_dwordx4 a[68:71], v4, s[8:11], s27 offen sc1
    s_add_u32 s27, s45, 18432
    buffer_load_dwordx4 a[72:75], v4, s[8:11], s27 offen sc1
    s_add_u32 s27, s45, 19456
    buffer_load_dwordx4 a[76:79], v4, s[8:11], s27 offen sc1
    s_waitcnt vmcnt(17)
    s_barrier
    s_add_u32 m0, s39, 114816
    s_add_u32 s27, s38, 0
    buffer_load_dwordx4 v4, s[8:11], s27 offen sc1 lds
    s_add_u32 m0, s39, 115840
    s_add_u32 s27, s38, 1024
    buffer_load_dwordx4 v4, s[8:11], s27 offen sc1 lds
    s_add_u32 m0, s39, 116864
    s_add_u32 s27, s38, 20480
    buffer_load_dwordx4 v4, s[8:11], s27 offen sc1 lds
    s_add_u32 m0, s39, 117888
    s_add_u32 s27, s38, 21504
    buffer_load_dwordx4 v4, s[8:11], s27 offen sc1 lds
    s_add_u32 s38, s38, 2048
    s_cmp_eq_u32 s38, s90
    s_cselect_b32 s27, 20480, 0
    s_sub_u32 s38, s38, s27
    s_add_u32 m0, s47, 0
    s_nop 0
    buffer_load_dwordx4 v96, s[12:15], s46 offen lds
    s_add_u32 m0, s47, 1024
    s_nop 0
    buffer_load_dwordx4 v97, s[12:15], s46 offen lds
    s_add_u32 m0, s47, 2048
    s_nop 0
    buffer_load_dwordx4 v98, s[12:15], s46 offen lds
    s_add_u32 m0, s47, 12320
    s_nop 0
    buffer_load_dwordx4 v96, s[16:19], s46 offen lds
    s_add_u32 m0, s47, 13344
    s_nop 0
    buffer_load_dwordx4 v97, s[16:19], s46 offen lds
    s_add_u32 m0, s47, 14368
    s_nop 0
    buffer_load_dwordx4 v98, s[16:19], s46 offen lds
    s_add_u32 s46, s46, 196608
    s_cmp_eq_u32 s46, s99
    s_cselect_b32 s27, 1966080, 0
    s_sub_u32 s46, s46, s27
    s_waitcnt vmcnt(15)
    s_barrier
    s_add_u32 m0, s39, 131200
    s_add_u32 s27, s38, 0
    buffer_load_dwordx4 v4, s[8:11], s27 offen sc1 lds
    s_add_u32 m0, s39, 132224
    s_add_u32 s27, s38, 1024
    buffer_load_dwordx4 v4, s[8:11], s27 offen sc1 lds
    s_add_u32 m0, s39, 133248
    s_add_u32 s27, s38, 20480
    buffer_load_dwordx4 v4, s[8:11], s27 offen sc1 lds
    s_add_u32 m0, s39, 134272
    s_add_u32 s27, s38, 21504
    buffer_load_dwordx4 v4, s[8:11], s27 offen sc1 lds
    s_add_u32 s38, s38, 2048
    s_cmp_eq_u32 s38, s90
    s_cselect_b32 s27, 20480, 0
    s_sub_u32 s38, s38, s27
    s_add_u32 m0, s47, 24608
    s_nop 0
    buffer_load_dwordx4 v96, s[12:15], s46 offen lds
    s_add_u32 m0, s47, 25632
    s_nop 0
    buffer_load_dwordx4 v97, s[12:15], s46 offen lds
    s_add_u32 m0, s47, 26656
    s_nop 0
    buffer_load_dwordx4 v98, s[12:15], s46 offen lds
    s_add_u32 m0, s47, 36928
    s_nop 0
    buffer_load_dwordx4 v96, s[16:19], s46 offen lds
    s_add_u32 m0, s47, 37952
    s_nop 0
    buffer_load_dwordx4 v97, s[16:19], s46 offen lds
    s_add_u32 m0, s47, 38976
    s_nop 0
    buffer_load_dwordx4 v98, s[16:19], s46 offen lds
    s_add_u32 s46, s46, 196608
    s_cmp_eq_u32 s46, s99
    s_cselect_b32 s27, 1966080, 0
    s_sub_u32 s46, s46, s27
    s_waitcnt vmcnt(10)
    s_barrier
    s_add_u32 m0, s39, 98432
    s_add_u32 s27, s38, 0
    buffer_load_dwordx4 v4, s[8:11], s27 offen sc1 lds
    s_add_u32 m0, s39, 99456
    s_add_u32 s27, s38, 1024
    buffer_load_dwordx4 v4, s[8:11], s27 offen sc1 lds
    s_add_u32 m0, s39, 100480
    s_add_u32 s27, s38, 20480
    buffer_load_dwordx4 v4, s[8:11], s27 offen sc1 lds
    s_add_u32 m0, s39, 101504
    s_add_u32 s27, s38, 21504
    buffer_load_dwordx4 v4, s[8:11], s27 offen sc1 lds
    s_add_u32 s38, s38, 2048
    s_cmp_eq_u32 s38, s90
    s_cselect_b32 s27, 20480, 0
    s_sub_u32 s38, s38, s27
    s_add_u32 m0, s47, 49216
    s_nop 0
    buffer_load_dwordx4 v96, s[12:15], s46 offen lds
    s_add_u32 m0, s47, 50240
    s_nop 0
    buffer_load_dwordx4 v97, s[12:15], s46 offen lds
    s_add_u32 m0, s47, 51264
    s_nop 0
    buffer_load_dwordx4 v98, s[12:15], s46 offen lds
    s_add_u32 m0, s47, 61536
    s_nop 0
    buffer_load_dwordx4 v96, s[16:19], s46 offen lds
    s_add_u32 m0, s47, 62560
    s_nop 0
    buffer_load_dwordx4 v97, s[16:19], s46 offen lds
    s_add_u32 m0, s47, 63584
    s_nop 0
    buffer_load_dwordx4 v98, s[16:19], s46 offen lds
    s_add_u32 s46, s46, 196608
    s_cmp_eq_u32 s46, s99
    s_cselect_b32 s27, 1966080, 0
    s_sub_u32 s46, s46, s27
    s_waitcnt vmcnt(10)
    s_barrier
    s_add_u32 m0, s39, 114816
    s_add_u32 s27, s38, 0
    buffer_load_dwordx4 v4, s[8:11], s27 offen sc1 lds
    s_add_u32 m0, s39, 115840
    s_add_u32 s27, s38, 1024
    buffer_load_dwordx4 v4, s[8:11], s27 offen sc1 lds
    s_add_u32 m0, s39, 116864
    s_add_u32 s27, s38, 20480
    buffer_load_dwordx4 v4, s[8:11], s27 offen sc1 lds
    s_add_u32 m0, s39, 117888
    s_add_u32 s27, s38, 21504
    buffer_load_dwordx4 v4, s[8:11], s27 offen sc1 lds
    s_add_u32 s38, s38, 2048
    s_cmp_eq_u32 s38, s90
    s_cselect_b32 s27, 20480, 0
    s_sub_u32 s38, s38, s27
    s_add_u32 m0, s47, 73824
    s_nop 0
    buffer_load_dwordx4 v96, s[12:15], s46 offen lds
    s_add_u32 m0, s47, 74848
    s_nop 0
    buffer_load_dwordx4 v97, s[12:15], s46 offen lds
    s_add_u32 m0, s47, 75872
    s_nop 0
    buffer_load_dwordx4 v98, s[12:15], s46 offen lds
    s_add_u32 m0, s47, 86144
    s_nop 0
    buffer_load_dwordx4 v96, s[16:19], s46 offen lds
    s_add_u32 m0, s47, 87168
    s_nop 0
    buffer_load_dwordx4 v97, s[16:19], s46 offen lds
    s_add_u32 m0, s47, 88192
    s_nop 0
    buffer_load_dwordx4 v98, s[16:19], s46 offen lds
    s_add_u32 s46, s46, 196608
    s_cmp_eq_u32 s46, s99
    s_cselect_b32 s27, 1966080, 0
    s_sub_u32 s46, s46, s27
    s_waitcnt vmcnt(10)
    s_barrier
    s_add_u32 m0, s39, 131200
    s_add_u32 s27, s38, 0
    buffer_load_dwordx4 v4, s[8:11], s27 offen sc1 lds
    s_add_u32 m0, s39, 132224
    s_add_u32 s27, s38, 1024
    buffer_load_dwordx4 v4, s[8:11], s27 offen sc1 lds
    s_add_u32 m0, s39, 133248
    s_add_u32 s27, s38, 20480
    buffer_load_dwordx4 v4, s[8:11], s27 offen sc1 lds
    s_add_u32 m0, s39, 134272
    s_add_u32 s27, s38, 21504
    buffer_load_dwordx4 v4, s[8:11], s27 offen sc1 lds
    s_add_u32 s38, s38, 2048
    s_cmp_eq_u32 s38, s90
    s_cselect_b32 s27, 20480, 0
    s_sub_u32 s38, s38, s27
    s_add_u32 m0, s47, 0
    s_nop 0
    buffer_load_dwordx4 v96, s[12:15], s46 offen lds
    s_add_u32 m0, s47, 1024
    s_nop 0
    buffer_load_dwordx4 v97, s[12:15], s46 offen lds
    s_add_u32 m0, s47, 2048
    s_nop 0
    buffer_load_dwordx4 v98, s[12:15], s46 offen lds
    s_add_u32 m0, s47, 12320
    s_nop 0
    buffer_load_dwordx4 v96, s[16:19], s46 offen lds
    s_add_u32 m0, s47, 13344
    s_nop 0
    buffer_load_dwordx4 v97, s[16:19], s46 offen lds
    s_add_u32 m0, s47, 14368
    s_nop 0
    buffer_load_dwordx4 v98, s[16:19], s46 offen lds
    s_add_u32 s46, s46, 196608
    s_cmp_eq_u32 s46, s99
    s_cselect_b32 s27, 1966080, 0
    s_sub_u32 s46, s46, s27
    s_waitcnt vmcnt(10)
    s_barrier
    s_add_u32 m0, s39, 98432
    s_add_u32 s27, s38, 0
    buffer_load_dwordx4 v4, s[8:11], s27 offen sc1 lds
    s_add_u32 m0, s39, 99456
    s_add_u32 s27, s38, 1024
    buffer_load_dwordx4 v4, s[8:11], s27 offen sc1 lds
    s_add_u32 m0, s39, 100480
    s_add_u32 s27, s38, 20480
    buffer_load_dwordx4 v4, s[8:11], s27 offen sc1 lds
    s_add_u32 m0, s39, 101504
    s_add_u32 s27, s38, 21504
    buffer_load_dwordx4 v4, s[8:11], s27 offen sc1 lds
    s_add_u32 s38, s38, 2048
    s_cmp_eq_u32 s38, s90
    s_cselect_b32 s27, 20480, 0
    s_sub_u32 s38, s38, s27
    s_add_u32 m0, s47, 24608
    s_nop 0
    buffer_load_dwordx4 v96, s[12:15], s46 offen lds
    s_add_u32 m0, s47, 25632
    s_nop 0
    buffer_load_dwordx4 v97, s[12:15], s46 offen lds
    s_add_u32 m0, s47, 26656
    s_nop 0
    buffer_load_dwordx4 v98, s[12:15], s46 offen lds
    s_add_u32 m0, s47, 36928
    s_nop 0
    buffer_load_dwordx4 v96, s[16:19], s46 offen lds
    s_add_u32 m0, s47, 37952
    s_nop 0
    buffer_load_dwordx4 v97, s[16:19], s46 offen lds
    s_add_u32 m0, s47, 38976
    s_nop 0
    buffer_load_dwordx4 v98, s[16:19], s46 offen lds
    s_add_u32 s46, s46, 196608
    s_cmp_eq_u32 s46, s99
    s_cselect_b32 s27, 1966080, 0
    s_sub_u32 s46, s46, s27
    s_add_u32 s27, s45, 20480
    buffer_load_dwordx4 a[40:43], v4, s[8:11], s27 offen sc1
    s_add_u32 s27, s45, 21504
    buffer_load_dwordx4 a[44:47], v4, s[8:11], s27 offen sc1
    s_waitcnt vmcnt(12)
    s_barrier
    s_add_u32 s27, s45, 22528
    buffer_load_dwordx4 a[48:51], v4, s[8:11], s27 offen sc1
    s_add_u32 s27, s45, 23552
    buffer_load_dwordx4 a[52:55], v4, s[8:11], s27 offen sc1
    s_add_u32 s27, s45, 24576
    buffer_load_dwordx4 a[56:59], v4, s[8:11], s27 offen sc1
    s_add_u32 s27, s45, 25600
    buffer_load_dwordx4 a[20:23], v4, s[8:11], s27 offen sc1
    s_add_u32 s27, s45, 26624
    buffer_load_dwordx4 a[24:27], v4, s[8:11], s27 offen sc1
    s_add_u32 s27, s45, 27648
    buffer_load_dwordx4 a[28:31], v4, s[8:11], s27 offen sc1
    s_add_u32 s27, s45, 28672
    buffer_load_dwordx4 a[32:35], v4, s[8:11], s27 offen sc1
    s_add_u32 s27, s45, 29696
    buffer_load_dwordx4 a[36:39], v4, s[8:11], s27 offen sc1
    s_waitcnt vmcnt(63)
    s_setprio 3
    v_add_f32 v72, v72, v74
    v_add_f32 v73, v73, v75
    v_add_f32 v72, v72, v76
    v_add_f32 v73, v73, v77
    v_add_f32 v72, v72, v78
    v_add_f32 v73, v73, v79
    v_add_f32 v72, v72, v80
    v_add_f32 v73, v73, v81
    v_add_f32 v72, v72, v82
    v_add_f32 v73, v73, v83
    v_add_f32 v72, v72, v84
    v_add_f32 v73, v73, v85
    v_add_f32 v72, v72, v86
    v_add_f32 v73, v73, v87
    v_mov_b32 v74, v72
    s_nop 1
    v_permlane32_swap_b32 v72, v74
    v_add_f32 v72, v72, v74
    v_mov_b32 v74, v73
    s_nop 1
    v_permlane32_swap_b32 v73, v74
    v_add_f32 v73, v73, v74
    v_mul_f32 v72, 0x3acccccd, v72
    v_mul_f32 v73, 0x3acccccd, v73
    v_fma_f32 v73, -v72, v72, v73
    v_max_f32 v73, 0, v73
    v_add_f32 v73, 0x3727c5ac, v73
    v_rcp_f32 v73, v73
    v_cvt_pk_bf16_f32 v74, -v72, -v72
    v_and_b32 v75, 0xffff0000, v74
    v_sub_f32 v75, -v72, v75
    v_cvt_pk_bf16_f32 v75, v75, 0
    v_and_b32 v76, 31, v0
    s_lshl_b32 s27, s51, 5
    v_add_u32 v76, s27, v76
    v_lshlrev_b32 v77, 3, v76
    v_lshlrev_b32 v76, 2, v76
    v_add_u32 v77, 150720, v77
    v_add_u32 v76, 151744, v76
    ds_write_b64 v77, v[74:75]
    ds_write_b32 v76, v73
    v_mov_b32 v78, 0
    ds_write_b32 v76, v78 offset:512
    s_setprio 0
    s_waitcnt lgkmcnt(0)
    s_waitcnt vmcnt(10)
    s_barrier
    s_add_u32 s27, s45, 30720
    buffer_load_dwordx4 a[0:3], v4, s[8:11], s27 offen sc1
    s_add_u32 s27, s45, 31744
    buffer_load_dwordx4 a[4:7], v4, s[8:11], s27 offen sc1
    s_add_u32 s27, s45, 32768
    buffer_load_dwordx4 a[8:11], v4, s[8:11], s27 offen sc1
    s_add_u32 s27, s45, 33792
    buffer_load_dwordx4 a[12:15], v4, s[8:11], s27 offen sc1
    s_add_u32 s27, s45, 34816
    buffer_load_dwordx4 a[16:19], v4, s[8:11], s27 offen sc1
    s_add_u32 s27, s45, 35840
    buffer_load_dwordx4 v[40:43], v4, s[8:11], s27 offen sc1
    s_add_u32 s27, s45, 36864
    buffer_load_dwordx4 v[44:47], v4, s[8:11], s27 offen sc1
    s_add_u32 s27, s45, 37888
    buffer_load_dwordx4 v[48:51], v4, s[8:11], s27 offen sc1
    s_add_u32 s27, s45, 38912
    buffer_load_dwordx4 v[52:55], v4, s[8:11], s27 offen sc1
    s_add_u32 s27, s45, 39936
    buffer_load_dwordx4 v[56:59], v4, s[8:11], s27 offen sc1
    s_barrier
    s_setprio 0
L_gu_done:
    s_lshl_b32 s28, s87, 10
    s_add_u32 s28, s28, 0xc80000
    s_xor_b32 s27, s51, 3
    s_add_u32 s36, s27, s41
    s_mul_i32 s36, s36, 49152
    s_add_u32 s36, s36, s28
    s_mul_i32 s27, s27, 5120
    s_add_u32 s27, s27, 122880
    v_add_u32 v13, s27, v4
    v_subrev_u32 v10, 81920, v13
    s_xor_b32 s27, s51, 2
    s_add_u32 s37, s27, s41
    s_mul_i32 s37, s37, 49152
    s_add_u32 s37, s37, s28
    s_mul_i32 s27, s27, 5120
    s_add_u32 s27, s27, 102400
    v_add_u32 v14, s27, v4
    v_subrev_u32 v11, 81920, v14
    s_xor_b32 s27, s51, 1
    s_add_u32 s38, s27, s41
    s_mul_i32 s38, s38, 49152
    s_add_u32 s38, s38, s28
    s_mul_i32 s27, s27, 5120
    s_add_u32 s27, s27, 81920
    s_mov_b32 s97, s27
    s_xor_b32 s27, s51, 0
    s_add_u32 s39, s27, s41
    s_mul_i32 s39, s39, 49152
    s_add_u32 s39, s39, s28
    s_mul_i32 s27, s27, 5120
    s_add_u32 s27, s27, 61440
    s_mov_b32 s98, s27
    s_and_b32 s27, s41, 7
    s_add_u32 s27, s27, s51
    s_lshl_b32 s27, s27, 6
    s_add_u32 s27, s27, 151744
    v_and_b32 v15, 15, v0
    v_lshlrev_b32 v15, 2, v15
    v_add_u32 v15, s27, v15
    ds_read_b32 v15, v15
    s_load_dwordx2 s[20:21], s[0:1], 56
    v_and_b32 v8, 15, v0
    v_lshrrev_b32 v9, 4, v0
    v_mul_u32_u24 v8, 1280, v8
    s_add_u32 s27, s51, s41
    s_mul_i32 s27, s27, 20480
    s_mul_i32 s28, s40, 160
    s_add_u32 s27, s27, s28
    v_add_u32 v8, s27, v8
    v_lshl_add_u32 v1, v9, 4, v8
    v_lshl_add_u32 v2, v9, 3, v8
    v_add_u32 v2, 128, v2
    s_and_b32 s27, s24, 4
    s_lshl_b32 s27, s27, 4
    v_add_u32 v1, s27, v1
    s_mul_i32 s27, s51, 5120
    s_and_b32 s28, s24, 4
    s_lshl_b32 s28, s28, 9
    s_add_u32 s27, s27, s28
    s_add_u32 s27, s27, 0
    v_add_u32 v5, s27, v4
    v_add_u32 v6, 61440, v5
    v_add_u32 v7, 122880, v5
    s_waitcnt lgkmcnt(0)
    s_and_b32 s21, s21, 0xffff
    s_mov_b32 s22, 0x280000
    s_mov_b32 s23, 0x20000
    s_cmp_ge_u32 s24, 4
    s_cbranch_scc1 L_dn_nw
    s_waitcnt vmcnt(5)
L_dn_nw:
    s_waitcnt vmcnt(63)
    s_barrier
    s_cmp_lg_u32 s24, 0
    s_cbranch_scc1 L_sy_23
    s_lshl_b32 s27, s26, 2
    s_add_u32 s27, s27, s48
    v_mov_b32 v8, 1
    v_mov_b32 v9, 0
    s_mov_b64 exec, 1
    s_cmp_lg_u32 s43, 0
    s_cbranch_scc1 L_stf_25
    buffer_store_dword v8, v9, s[8:11], s27 offen offset:256 sc1
    s_branch L_ste_26
L_stf_25:
    buffer_store_dword v8, v9, s[8:11], s27 offen offset:256
L_ste_26:
    s_and_b32 s27, s26, 2
    s_lshl_b32 s27, 0x33333333, s27
    s_mov_b32 exec_lo, s27
    v_lshlrev_b32 v9, 2, v0
    s_mov_b32 s28, 0
L_poll_24:
    buffer_load_dword v8, v9, s[8:11], s48 offen offset:256 sc1
    s_add_u32 s28, s28, 1
    s_waitcnt vmcnt(0)
    v_cmp_eq_u32 vcc, 0, v8
    s_cmp_lt_u32 s28, 0x40000
    s_cselect_b64 vcc, vcc, 0
    s_cbranch_vccnz L_poll_24
    s_mov_b64 exec, -1
L_sy_23:
    s_barrier
    s_cmp_ge_u32 s24, 4
    s_cbranch_scc1 L_dn_b
    buffer_load_dwordx4 v[16:19], v4, s[8:11], s36 offen offset:0 sc1
    buffer_load_dwordx4 v[20:23], v4, s[8:11], s36 offen offset:1024 sc1
    buffer_load_dwordx4 v[24:27], v4, s[8:11], s36 offen offset:2048 sc1
    buffer_load_dwordx4 v[28:31], v4, s[8:11], s36 offen offset:3072 sc1
    v_add_u32 v8, s97, v4
    v_subrev_u32 v12, 81920, v8
    v_add_u32 v9, s98, v4
    buffer_load_dwordx4 v[32:35], v4, s[8:11], s37 offen offset:0 sc1
    s_waitcnt vmcnt(4)
    v_mfma_f32_16x16x32_bf16 v[80:83], a[108:111], v[16:19], 0
    v_mfma_f32_16x16x32_bf16 v[84:87], a[112:115], v[16:19], 0
    v_mfma_f32_16x16x32_bf16 v[72:75], a[100:103], v[16:19], 0
    v_mfma_f32_16x16x32_bf16 v[76:79], a[104:107], v[16:19], 0
    v_mfma_f32_16x16x32_bf16 v[88:91], a[116:119], v[16:19], 0
    buffer_load_dwordx4 v[16:19], v4, s[8:11], s37 offen offset:1024 sc1
    s_waitcnt vmcnt(4)
    v_mfma_f32_16x16x32_bf16 v[80:83], a[128:131], v[20:23], v[80:83]
    v_mfma_f32_16x16x32_bf16 v[84:87], a[132:135], v[20:23], v[84:87]
    v_mfma_f32_16x16x32_bf16 v[72:75], a[120:123], v[20:23], v[72:75]
    v_mfma_f32_16x16x32_bf16 v[76:79], a[124:127], v[20:23], v[76:79]
    v_mfma_f32_16x16x32_bf16 v[88:91], a[136:139], v[20:23], v[88:91]
    buffer_load_dwordx4 v[20:23], v4, s[8:11], s37 offen offset:2048 sc1
    s_waitcnt vmcnt(4)
    v_mfma_f32_16x16x32_bf16 v[80:83], a[88:91], v[24:27], v[80:83]
    v_mfma_f32_16x16x32_bf16 v[84:87], a[92:95], v[24:27], v[84:87]
    v_mfma_f32_16x16x32_bf16 v[72:75], a[80:83], v[24:27], v[72:75]
    v_mfma_f32_16x16x32_bf16 v[76:79], a[84:87], v[24:27], v[76:79]
    v_mfma_f32_16x16x32_bf16 v[88:91], a[96:99], v[24:27], v[88:91]
    buffer_load_dwordx4 v[24:27], v4, s[8:11], s37 offen offset:3072 sc1
    s_waitcnt vmcnt(4)
    v_mfma_f32_16x16x32_bf16 v[80:83], a[68:71], v[28:31], v[80:83]
    v_mfma_f32_16x16x32_bf16 v[84:87], a[72:75], v[28:31], v[84:87]
    v_mfma_f32_16x16x32_bf16 v[72:75], a[60:63], v[28:31], v[72:75]
    v_mfma_f32_16x16x32_bf16 v[76:79], a[64:67], v[28:31], v[76:79]
    v_mfma_f32_16x16x32_bf16 v[88:91], a[76:79], v[28:31], v[88:91]
    buffer_load_dwordx4 v[28:31], v4, s[8:11], s38 offen offset:0 sc1
    s_waitcnt vmcnt(4)
    v_mfma_f32_16x16x32_bf16 v[100:103], a[108:111], v[32:35], 0
    v_mfma_f32_16x16x32_bf16 v[104:107], a[112:115], v[32:35], 0
    v_mfma_f32_16x16x32_bf16 v[92:95], a[100:103], v[32:35], 0
    v_mfma_f32_16x16x32_bf16 v[96:99], a[104:107], v[32:35], 0
    v_mfma_f32_16x16x32_bf16 v[108:111], a[116:119], v[32:35], 0
    buffer_load_dwordx4 v[32:35], v4, s[8:11], s38 offen offset:1024 sc1
    ds_write_b128 v13, v[80:83] offset:2048
    ds_write_b128 v13, v[84:87] offset:3072
    s_waitcnt vmcnt(4)
    v_mfma_f32_16x16x32_bf16 v[100:103], a[128:131], v[16:19], v[100:103]
    v_mfma_f32_16x16x32_bf16 v[104:107], a[132:135], v[16:19], v[104:107]
    v_mfma_f32_16x16x32_bf16 v[92:95], a[120:123], v[16:19], v[92:95]
    v_mfma_f32_16x16x32_bf16 v[96:99], a[124:127], v[16:19], v[96:99]
    v_mfma_f32_16x16x32_bf16 v[108:111], a[136:139], v[16:19], v[108:111]
    buffer_load_dwordx4 v[16:19], v4, s[8:11], s38 offen offset:2048 sc1
    ds_write_b128 v10, v[72:75] offset:0
    ds_write_b128 v10, v[76:79] offset:1024
    s_waitcnt vmcnt(4)
    v_mfma_f32_16x16x32_bf16 v[100:103], a[88:91], v[20:23], v[100:103]
    v_mfma_f32_16x16x32_bf16 v[104:107], a[92:95], v[20:23], v[104:107]
    v_mfma_f32_16x16x32_bf16 v[92:95], a[80:83], v[20:23], v[92:95]
    v_mfma_f32_16x16x32_bf16 v[96:99], a[84:87], v[20:23], v[96:99]
    v_mfma_f32_16x16x32_bf16 v[108:111], a[96:99], v[20:23], v[108:111]
    buffer_load_dwordx4 v[20:23], v4, s[8:11], s38 offen offset:3072 sc1
    ds_write_b128 v10, v[88:91] offset:4096
    s_waitcnt vmcnt(4)
    v_mfma_f32_16x16x32_bf16 v[100:103], a[68:71], v[24:27], v[100:103]
    v_mfma_f32_16x16x32_bf16 v[104:107], a[72:75], v[24:27], v[104:107]
    v_mfma_f32_16x16x32_bf16 v[92:95], a[60:63], v[24:27], v[92:95]
    v_mfma_f32_16x16x32_bf16 v[96:99], a[64:67], v[24:27], v[96:99]
    v_mfma_f32_16x16x32_bf16 v[108:111], a[76:79], v[24:27], v[108:111]
    buffer_load_dwordx4 v[24:27], v4, s[8:11], s39 offen offset:0 sc1
    s_waitcnt vmcnt(4)
    v_mfma_f32_16x16x32_bf16 v[80:83], a[108:111], v[28:31], 0
    v_mfma_f32_16x16x32_bf16 v[84:87], a[112:115], v[28:31], 0
    v_mfma_f32_16x16x32_bf16 v[72:75], a[100:103], v[28:31], 0
    v_mfma_f32_16x16x32_bf16 v[76:79], a[104:107], v[28:31], 0
    v_mfma_f32_16x16x32_bf16 v[88:91], a[116:119], v[28:31], 0
    buffer_load_dwordx4 v[28:31], v4, s[8:11], s39 offen offset:1024 sc1
    ds_write_b128 v14, v[100:103] offset:2048
    ds_write_b128 v14, v[104:107] offset:3072
    s_waitcnt vmcnt(4)
    v_mfma_f32_16x16x32_bf16 v[80:83], a[128:131], v[32:35], v[80:83]
    v_mfma_f32_16x16x32_bf16 v[84:87], a[132:135], v[32:35], v[84:87]
    v_mfma_f32_16x16x32_bf16 v[72:75], a[120:123], v[32:35], v[72:75]
    v_mfma_f32_16x16x32_bf16 v[76:79], a[124:127], v[32:35], v[76:79]
    v_mfma_f32_16x16x32_bf16 v[88:91], a[136:139], v[32:35], v[88:91]
    buffer_load_dwordx4 v[32:35], v4, s[8:11], s39 offen offset:2048 sc1
    ds_write_b128 v11, v[92:95] offset:0
    ds_write_b128 v11, v[96:99] offset:1024
    s_waitcnt vmcnt(4)
    v_mfma_f32_16x16x32_bf16 v[80:83], a[88:91], v[16:19], v[80:83]
    v_mfma_f32_16x16x32_bf16 v[84:87], a[92:95], v[16:19], v[84:87]
    v_mfma_f32_16x16x32_bf16 v[72:75], a[80:83], v[16:19], v[72:75]
    v_mfma_f32_16x16x32_bf16 v[76:79], a[84:87], v[16:19], v[76:79]
    v_mfma_f32_16x16x32_bf16 v[88:91], a[96:99], v[16:19], v[88:91]
    buffer_load_dwordx4 v[16:19], v4, s[8:11], s39 offen offset:3072 sc1
    ds_write_b128 v11, v[108:111] offset:4096
    s_waitcnt vmcnt(4)
    v_mfma_f32_16x16x32_bf16 v[80:83], a[68:71], v[20:23], v[80:83]
    v_mfma_f32_16x16x32_bf16 v[84:87], a[72:75], v[20:23], v[84:87]
    v_mfma_f32_16x16x32_bf16 v[72:75], a[60:63], v[20:23], v[72:75]
    v_mfma_f32_16x16x32_bf16 v[76:79], a[64:67], v[20:23], v[76:79]
    v_mfma_f32_16x16x32_bf16 v[88:91], a[76:79], v[20:23], v[88:91]
    s_waitcnt vmcnt(3)
    v_mfma_f32_16x16x32_bf16 v[100:103], a[108:111], v[24:27], 0
    v_mfma_f32_16x16x32_bf16 v[104:107], a[112:115], v[24:27], 0
    v_mfma_f32_16x16x32_bf16 v[92:95], a[100:103], v[24:27], 0
    v_mfma_f32_16x16x32_bf16 v[96:99], a[104:107], v[24:27], 0
    v_mfma_f32_16x16x32_bf16 v[108:111], a[116:119], v[24:27], 0
    ds_write_b128 v8, v[80:83] offset:2048
    ds_write_b128 v8, v[84:87] offset:3072
    s_waitcnt vmcnt(2)
    v_mfma_f32_16x16x32_bf16 v[100:103], a[128:131], v[28:31], v[100:103]
    v_mfma_f32_16x16x32_bf16 v[104:107], a[132:135], v[28:31], v[104:107]
    v_mfma_f32_16x16x32_bf16 v[92:95], a[120:123], v[28:31], v[92:95]
    v_mfma_f32_16x16x32_bf16 v[96:99], a[124:127], v[28:31], v[96:99]
    v_mfma_f32_16x16x32_bf16 v[108:111], a[136:139], v[28:31], v[108:111]
    ds_write_b128 v12, v[72:75] offset:0
    ds_write_b128 v12, v[76:79] offset:1024
    s_waitcnt vmcnt(1)
    v_mfma_f32_16x16x32_bf16 v[100:103], a[88:91], v[32:35], v[100:103]
    v_mfma_f32_16x16x32_bf16 v[104:107], a[92:95], v[32:35], v[104:107]
    v_mfma_f32_16x16x32_bf16 v[92:95], a[80:83], v[32:35], v[92:95]
    v_mfma_f32_16x16x32_bf16 v[96:99], a[84:87], v[32:35], v[96:99]
    v_mfma_f32_16x16x32_bf16 v[108:111], a[96:99], v[32:35], v[108:111]
    ds_write_b128 v12, v[88:91] offset:4096
    s_waitcnt vmcnt(0)
    v_mfma_f32_16x16x32_bf16 v[100:103], a[68:71], v[16:19], v[100:103]
    v_mfma_f32_16x16x32_bf16 v[104:107], a[72:75], v[16:19], v[104:107]
    v_mfma_f32_16x16x32_bf16 v[92:95], a[60:63], v[16:19], v[92:95]
    v_mfma_f32_16x16x32_bf16 v[96:99], a[64:67], v[16:19], v[96:99]
    v_mfma_f32_16x16x32_bf16 v[108:111], a[76:79], v[16:19], v[108:111]
    s_nop 3
    ds_write_b128 v9, v[100:103] offset:2048
    ds_write_b128 v9, v[104:107] offset:3072
    v_mov_b32 v3, v15
    s_waitcnt lgkmcnt(0)
    s_barrier
    ds_read_b128 v[8:11], v5 offset:0
    ds_read_b128 v[12:15], v5 offset:1024
    ds_read_b128 v[16:19], v5 offset:4096
    ds_read_b128 v[20:23], v5 offset:20480
    ds_read_b128 v[24:27], v5 offset:21504
    ds_read_b128 v[28:31], v5 offset:24576
    ds_read_b128 v[32:35], v5 offset:40960
    ds_read_b128 v[36:39], v5 offset:41984
    ds_read_b128 v[40:43], v5 offset:45056
    ds_read_b128 v[44:47], v6 offset:0
    ds_read_b128 v[48:51], v6 offset:1024
    ds_read_b128 v[52:55], v6 offset:4096
    ds_read_b128 v[56:59], v6 offset:20480
    ds_read_b128 v[60:63], v6 offset:21504
    ds_read_b128 v[64:67], v6 offset:24576
    ds_read_b128 v[68:71], v6 offset:40960
    ds_read_b128 v[72:75], v6 offset:41984
    ds_read_b128 v[76:79], v6 offset:45056
    ds_read_b128 v[80:83], v7 offset:0
    ds_read_b128 v[84:87], v7 offset:1024
    ds_read_b128 v[88:91], v7 offset:4096
    s_waitcnt lgkmcnt(15)
    v_pk_add_f32 v[92:93], v[92:93], v[8:9]
    v_pk_add_f32 v[94:95], v[94:95], v[10:11]
    v_pk_add_f32 v[96:97], v[96:97], v[12:13]
    v_pk_add_f32 v[98:99], v[98:99], v[14:15]
    v_pk_add_f32 v[108:109], v[108:109], v[16:17]
    v_pk_add_f32 v[110:111], v[110:111], v[18:19]
    s_waitcnt lgkmcnt(15)
    v_pk_add_f32 v[92:93], v[92:93], v[20:21]
    v_pk_add_f32 v[94:95], v[94:95], v[22:23]
    v_pk_add_f32 v[96:97], v[96:97], v[24:25]
    v_pk_add_f32 v[98:99], v[98:99], v[26:27]
    v_pk_add_f32 v[108:109], v[108:109], v[28:29]
    v_pk_add_f32 v[110:111], v[110:111], v[30:31]
    s_waitcnt lgkmcnt(12)
    v_pk_add_f32 v[92:93], v[92:93], v[32:33]
    v_pk_add_f32 v[94:95], v[94:95], v[34:35]
    v_pk_add_f32 v[96:97], v[96:97], v[36:37]
    v_pk_add_f32 v[98:99], v[98:99], v[38:39]
    v_pk_add_f32 v[108:109], v[108:109], v[40:41]
    v_pk_add_f32 v[110:111], v[110:111], v[42:43]
    s_waitcnt lgkmcnt(9)
    v_pk_add_f32 v[92:93], v[92:93], v[44:45]
    v_pk_add_f32 v[94:95], v[94:95], v[46:47]
    v_pk_add_f32 v[96:97], v[96:97], v[48:49]
    v_pk_add_f32 v[98:99], v[98:99], v[50:51]
    v_pk_add_f32 v[108:109], v[108:109], v[52:53]
    v_pk_add_f32 v[110:111], v[110:111], v[54:55]
    s_waitcnt lgkmcnt(6)
    v_pk_add_f32 v[92:93], v[92:93], v[56:57]
    v_pk_add_f32 v[94:95], v[94:95], v[58:59]
    v_pk_add_f32 v[96:97], v[96:97], v[60:61]
    v_pk_add_f32 v[98:99], v[98:99], v[62:63]
    v_pk_add_f32 v[108:109], v[108:109], v[64:65]
    v_pk_add_f32 v[110:111], v[110:111], v[66:67]
    s_waitcnt lgkmcnt(3)
    v_pk_add_f32 v[92:93], v[92:93], v[68:69]
    v_pk_add_f32 v[94:95], v[94:95], v[70:71]
    v_pk_add_f32 v[96:97], v[96:97], v[72:73]
    v_pk_add_f32 v[98:99], v[98:99], v[74:75]
    v_pk_add_f32 v[108:109], v[108:109], v[76:77]
    v_pk_add_f32 v[110:111], v[110:111], v[78:79]
    s_waitcnt lgkmcnt(0)
    v_pk_add_f32 v[92:93], v[92:93], v[80:81]
    v_pk_add_f32 v[94:95], v[94:95], v[82:83]
    v_pk_add_f32 v[96:97], v[96:97], v[84:85]
    v_pk_add_f32 v[98:99], v[98:99], v[86:87]
    v_pk_add_f32 v[108:109], v[108:109], v[88:89]
    v_pk_add_f32 v[110:111], v[110:111], v[90:91]
    v_accvgpr_read_b32 v10, a140
    v_lshlrev_b32 v8, 16, v10
    v_and_b32 v9, 0xffff0000, v10
    v_fma_f32 v92, v92, v3, v8
    v_fma_f32 v93, v93, v3, v9
    v_cvt_pk_bf16_f32 v16, v92, v93
    v_accvgpr_read_b32 v10, a141
    v_lshlrev_b32 v8, 16, v10
    v_and_b32 v9, 0xffff0000, v10
    v_fma_f32 v94, v94, v3, v8
    v_fma_f32 v95, v95, v3, v9
    v_cvt_pk_bf16_f32 v17, v94, v95
    v_accvgpr_read_b32 v10, a142
    v_lshlrev_b32 v8, 16, v10
    v_and_b32 v9, 0xffff0000, v10
    v_fma_f32 v96, v96, v3, v8
    v_fma_f32 v97, v97, v3, v9
    v_cvt_pk_bf16_f32 v18, v96, v97
    v_accvgpr_read_b32 v10, a143
    v_lshlrev_b32 v8, 16, v10
    v_and_b32 v9, 0xffff0000, v10
    v_fma_f32 v98, v98, v3, v8
    v_fma_f32 v99, v99, v3, v9
    v_cvt_pk_bf16_f32 v19, v98, v99
    buffer_store_dwordx4 v[16:19], v1, s[20:23], 0 offen
    v_accvgpr_read_b32 v10, a58
    v_lshlrev_b32 v8, 16, v10
    v_and_b32 v9, 0xffff0000, v10
    v_fma_f32 v108, v108, v3, v8
    v_fma_f32 v109, v109, v3, v9
    v_cvt_pk_bf16_f32 v20, v108, v109
    v_accvgpr_read_b32 v10, a59
    v_lshlrev_b32 v8, 16, v10
    v_and_b32 v9, 0xffff0000, v10
    v_fma_f32 v110, v110, v3, v8
    v_fma_f32 v111, v111, v3, v9
    v_cvt_pk_bf16_f32 v21, v110, v111
    buffer_store_dwordx2 v[20:21], v2, s[20:23], 0 offen
    s_branch L_dn_e
L_dn_b:
    s_setprio 1
    buffer_load_dwordx4 v[16:19], v4, s[8:11], s36 offen offset:0 sc1
    buffer_load_dwordx4 v[20:23], v4, s[8:11], s36 offen offset:1024 sc1
    buffer_load_dwordx4 v[24:27], v4, s[8:11], s36 offen offset:2048 sc1
    buffer_load_dwordx4 v[28:31], v4, s[8:11], s36 offen offset:3072 sc1
    v_add_u32 v8, s97, v4
    v_subrev_u32 v12, 81920, v8
    v_add_u32 v9, s98, v4
    s_add_u32 s36, s36, 4096
    buffer_load_dwordx4 v[32:35], v4, s[8:11], s36 offen offset:0 sc1
    buffer_load_dwordx4 v[36:39], v4, s[8:11], s36 offen offset:1024 sc1
    buffer_load_dwordx4 v[60:63], v4, s[8:11], s36 offen offset:2048 sc1
    buffer_load_dwordx4 v[64:67], v4, s[8:11], s36 offen offset:3072 sc1
    s_waitcnt vmcnt(7)
    v_mfma_f32_16x16x32_bf16 v[72:75], a[100:103], v[16:19], 0
    v_mfma_f32_16x16x32_bf16 v[76:79], a[104:107], v[16:19], 0
    v_mfma_f32_16x16x32_bf16 v[88:91], a[116:119], v[16:19], 0
    v_mfma_f32_16x16x32_bf16 v[80:83], a[108:111], v[16:19], 0
    v_mfma_f32_16x16x32_bf16 v[84:87], a[112:115], v[16:19], 0
    buffer_load_dwordx4 v[16:19], v4, s[8:11], s37 offen offset:0 sc1
    s_waitcnt vmcnt(7)
    v_mfma_f32_16x16x32_bf16 v[72:75], a[120:123], v[20:23], v[72:75]
    v_mfma_f32_16x16x32_bf16 v[76:79], a[124:127], v[20:23], v[76:79]
    v_mfma_f32_16x16x32_bf16 v[88:91], a[136:139], v[20:23], v[88:91]
    v_mfma_f32_16x16x32_bf16 v[80:83], a[128:131], v[20:23], v[80:83]
    v_mfma_f32_16x16x32_bf16 v[84:87], a[132:135], v[20:23], v[84:87]
    buffer_load_dwordx4 v[20:23], v4, s[8:11], s37 offen offset:1024 sc1
    s_waitcnt vmcnt(7)
    v_mfma_f32_16x16x32_bf16 v[72:75], a[80:83], v[24:27], v[72:75]
    v_mfma_f32_16x16x32_bf16 v[76:79], a[84:87], v[24:27], v[76:79]
    v_mfma_f32_16x16x32_bf16 v[88:91], a[96:99], v[24:27], v[88:91]
    v_mfma_f32_16x16x32_bf16 v[80:83], a[88:91], v[24:27], v[80:83]
    v_mfma_f32_16x16x32_bf16 v[84:87], a[92:95], v[24:27], v[84:87]
    buffer_load_dwordx4 v[24:27], v4, s[8:11], s37 offen offset:2048 sc1
    s_waitcnt vmcnt(7)
    v_mfma_f32_16x16x32_bf16 v[72:75], a[60:63], v[28:31], v[72:75]
    v_mfma_f32_16x16x32_bf16 v[76:79], a[64:67], v[28:31], v[76:79]
    v_mfma_f32_16x16x32_bf16 v[88:91], a[76:79], v[28:31], v[88:91]
    v_mfma_f32_16x16x32_bf16 v[80:83], a[68:71], v[28:31], v[80:83]
    v_mfma_f32_16x16x32_bf16 v[84:87], a[72:75], v[28:31], v[84:87]
    buffer_load_dwordx4 v[28:31], v4, s[8:11], s37 offen offset:3072 sc1
    s_waitcnt vmcnt(7)
    v_mfma_f32_16x16x32_bf16 v[72:75], a[40:43], v[32:35], v[72:75]
    v_mfma_f32_16x16x32_bf16 v[76:79], a[44:47], v[32:35], v[76:79]
    v_mfma_f32_16x16x32_bf16 v[88:91], a[56:59], v[32:35], v[88:91]
    v_mfma_f32_16x16x32_bf16 v[80:83], a[48:51], v[32:35], v[80:83]
    v_mfma_f32_16x16x32_bf16 v[84:87], a[52:55], v[32:35], v[84:87]
    s_add_u32 s37, s37, 4096
    buffer_load_dwordx4 v[32:35], v4, s[8:11], s37 offen offset:0 sc1
    s_waitcnt vmcnt(7)
    v_mfma_f32_16x16x32_bf16 v[72:75], a[20:23], v[36:39], v[72:75]
    v_mfma_f32_16x16x32_bf16 v[76:79], a[24:27], v[36:39], v[76:79]
    v_mfma_f32_16x16x32_bf16 v[88:91], a[36:39], v[36:39], v[88:91]
    v_mfma_f32_16x16x32_bf16 v[80:83], a[28:31], v[36:39], v[80:83]
    v_mfma_f32_16x16x32_bf16 v[84:87], a[32:35], v[36:39], v[84:87]
    buffer_load_dwordx4 v[36:39], v4, s[8:11], s37 offen offset:1024 sc1
    s_waitcnt vmcnt(7)
    v_mfma_f32_16x16x32_bf16 v[72:75], a[0:3], v[60:63], v[72:75]
    v_mfma_f32_16x16x32_bf16 v[76:79], a[4:7], v[60:63], v[76:79]
    v_mfma_f32_16x16x32_bf16 v[88:91], a[16:19], v[60:63], v[88:91]
    v_mfma_f32_16x16x32_bf16 v[80:83], a[8:11], v[60:63], v[80:83]
    v_mfma_f32_16x16x32_bf16 v[84:87], a[12:15], v[60:63], v[84:87]
    buffer_load_dwordx4 v[60:63], v4, s[8:11], s37 offen offset:2048 sc1
    s_waitcnt vmcnt(7)
    v_mfma_f32_16x16x32_bf16 v[72:75], v[40:43], v[64:67], v[72:75]
    v_mfma_f32_16x16x32_bf16 v[76:79], v[44:47], v[64:67], v[76:79]
    v_mfma_f32_16x16x32_bf16 v[88:91], v[56:59], v[64:67], v[88:91]
    v_mfma_f32_16x16x32_bf16 v[80:83], v[48:51], v[64:67], v[80:83]
    v_mfma_f32_16x16x32_bf16 v[84:87], v[52:55], v[64:67], v[84:87]
    buffer_load_dwordx4 v[64:67], v4, s[8:11], s37 offen offset:3072 sc1
    s_waitcnt vmcnt(7)
    v_mfma_f32_16x16x32_bf16 v[92:95], a[100:103], v[16:19], 0
    v_mfma_f32_16x16x32_bf16 v[96:99], a[104:107], v[16:19], 0
    v_mfma_f32_16x16x32_bf16 v[108:111], a[116:119], v[16:19], 0
    v_mfma_f32_16x16x32_bf16 v[100:103], a[108:111], v[16:19], 0
    v_mfma_f32_16x16x32_bf16 v[104:107], a[112:115], v[16:19], 0
    buffer_load_dwordx4 v[16:19], v4, s[8:11], s38 offen offset:0 sc1
    ds_write_b128 v13, v[72:75] offset:0
    s_waitcnt vmcnt(7)
    v_mfma_f32_16x16x32_bf16 v[92:95], a[120:123], v[20:23], v[92:95]
    v_mfma_f32_16x16x32_bf16 v[96:99], a[124:127], v[20:23], v[96:99]
    v_mfma_f32_16x16x32_bf16 v[108:111], a[136:139], v[20:23], v[108:111]
    v_mfma_f32_16x16x32_bf16 v[100:103], a[128:131], v[20:23], v[100:103]
    v_mfma_f32_16x16x32_bf16 v[104:107], a[132:135], v[20:23], v[104:107]
    buffer_load_dwordx4 v[20:23], v4, s[8:11], s38 offen offset:1024 sc1
    ds_write_b128 v13, v[76:79] offset:1024
    s_waitcnt vmcnt(7)
    v_mfma_f32_16x16x32_bf16 v[92:95], a[80:83], v[24:27], v[92:95]
    v_mfma_f32_16x16x32_bf16 v[96:99], a[84:87], v[24:27], v[96:99]
    v_mfma_f32_16x16x32_bf16 v[108:111], a[96:99], v[24:27], v[108:111]
    v_mfma_f32_16x16x32_bf16 v[100:103], a[88:91], v[24:27], v[100:103]
    v_mfma_f32_16x16x32_bf16 v[104:107], a[92:95], v[24:27], v[104:107]
    buffer_load_dwordx4 v[24:27], v4, s[8:11], s38 offen offset:2048 sc1
    ds_write_b128 v13, v[88:91] offset:4096
    s_waitcnt vmcnt(7)
    v_mfma_f32_16x16x32_bf16 v[92:95], a[60:63], v[28:31], v[92:95]
    v_mfma_f32_16x16x32_bf16 v[96:99], a[64:67], v[28:31], v[96:99]
    v_mfma_f32_16x16x32_bf16 v[108:111], a[76:79], v[28:31], v[108:111]
    v_mfma_f32_16x16x32_bf16 v[100:103], a[68:71], v[28:31], v[100:103]
    v_mfma_f32_16x16x32_bf16 v[104:107], a[72:75], v[28:31], v[104:107]
    buffer_load_dwordx4 v[28:31], v4, s[8:11], s38 offen offset:3072 sc1
    ds_write_b128 v10, v[80:83] offset:2048
    s_waitcnt vmcnt(7)
    v_mfma_f32_16x16x32_bf16 v[92:95], a[40:43], v[32:35], v[92:95]
    v_mfma_f32_16x16x32_bf16 v[96:99], a[44:47], v[32:35], v[96:99]
    v_mfma_f32_16x16x32_bf16 v[108:111], a[56:59], v[32:35], v[108:111]
    v_mfma_f32_16x16x32_bf16 v[100:103], a[48:51], v[32:35], v[100:103]
    v_mfma_f32_16x16x32_bf16 v[104:107], a[52:55], v[32:35], v[104:107]
    s_add_u32 s38, s38, 4096
    buffer_load_dwordx4 v[32:35], v4, s[8:11], s38 offen offset:0 sc1
    ds_write_b128 v10, v[84:87] offset:3072
    s_waitcnt vmcnt(7)
    v_mfma_f32_16x16x32_bf16 v[92:95], a[20:23], v[36:39], v[92:95]
    v_mfma_f32_16x16x32_bf16 v[96:99], a[24:27], v[36:39], v[96:99]
    v_mfma_f32_16x16x32_bf16 v[108:111], a[36:39], v[36:39], v[108:111]
    v_mfma_f32_16x16x32_bf16 v[100:103], a[28:31], v[36:39], v[100:103]
    v_mfma_f32_16x16x32_bf16 v[104:107], a[32:35], v[36:39], v[104:107]
    buffer_load_dwordx4 v[36:39], v4, s[8:11], s38 offen offset:1024 sc1
    s_waitcnt vmcnt(7)
    v_mfma_f32_16x16x32_bf16 v[92:95], a[0:3], v[60:63], v[92:95]
    v_mfma_f32_16x16x32_bf16 v[96:99], a[4:7], v[60:63], v[96:99]
    v_mfma_f32_16x16x32_bf16 v[108:111], a[16:19], v[60:63], v[108:111]
    v_mfma_f32_16x16x32_bf16 v[100:103], a[8:11], v[60:63], v[100:103]
    v_mfma_f32_16x16x32_bf16 v[104:107], a[12:15], v[60:63], v[104:107]
    buffer_load_dwordx4 v[60:63], v4, s[8:11], s38 offen offset:2048 sc1
    s_waitcnt vmcnt(7)
    v_mfma_f32_16x16x32_bf16 v[92:95], v[40:43], v[64:67], v[92:95]
    v_mfma_f32_16x16x32_bf16 v[96:99], v[44:47], v[64:67], v[96:99]
    v_mfma_f32_16x16x32_bf16 v[108:111], v[56:59], v[64:67], v[108:111]
    v_mfma_f32_16x16x32_bf16 v[100:103], v[48:51], v[64:67], v[100:103]
    v_mfma_f32_16x16x32_bf16 v[104:107], v[52:55], v[64:67], v[104:107]
    buffer_load_dwordx4 v[64:67], v4, s[8:11], s38 offen offset:3072 sc1
    s_waitcnt vmcnt(7)
    v_mfma_f32_16x16x32_bf16 v[72:75], a[100:103], v[16:19], 0
    v_mfma_f32_16x16x32_bf16 v[76:79], a[104:107], v[16:19], 0
    v_mfma_f32_16x16x32_bf16 v[88:91], a[116:119], v[16:19], 0
    v_mfma_f32_16x16x32_bf16 v[80:83], a[108:111], v[16:19], 0
    v_mfma_f32_16x16x32_bf16 v[84:87], a[112:115], v[16:19], 0
    buffer_load_dwordx4 v[16:19], v4, s[8:11], s39 offen offset:0 sc1
    ds_write_b128 v14, v[92:95] offset:0
    s_waitcnt vmcnt(7)
    v_mfma_f32_16x16x32_bf16 v[72:75], a[120:123], v[20:23], v[72:75]
    v_mfma_f32_16x16x32_bf16 v[76:79], a[124:127], v[20:23], v[76:79]
    v_mfma_f32_16x16x32_bf16 v[88:91], a[136:139], v[20:23], v[88:91]
    v_mfma_f32_16x16x32_bf16 v[80:83], a[128:131], v[20:23], v[80:83]
    v_mfma_f32_16x16x32_bf16 v[84:87], a[132:135], v[20:23], v[84:87]
    buffer_load_dwordx4 v[20:23], v4, s[8:11], s39 offen offset:1024 sc1
    ds_write_b128 v14, v[96:99] offset:1024
    s_waitcnt vmcnt(7)
    v_mfma_f32_16x16x32_bf16 v[72:75], a[80:83], v[24:27], v[72:75]
    v_mfma_f32_16x16x32_bf16 v[76:79], a[84:87], v[24:27], v[76:79]
    v_mfma_f32_16x16x32_bf16 v[88:91], a[96:99], v[24:27], v[88:91]
    v_mfma_f32_16x16x32_bf16 v[80:83], a[88:91], v[24:27], v[80:83]
    v_mfma_f32_16x16x32_bf16 v[84:87], a[92:95], v[24:27], v[84:87]
    buffer_load_dwordx4 v[24:27], v4, s[8:11], s39 offen offset:2048 sc1
    ds_write_b128 v14, v[108:111] offset:4096
    s_waitcnt vmcnt(7)
    v_mfma_f32_16x16x32_bf16 v[72:75], a[60:63], v[28:31], v[72:75]
    v_mfma_f32_16x16x32_bf16 v[76:79], a[64:67], v[28:31], v[76:79]
    v_mfma_f32_16x16x32_bf16 v[88:91], a[76:79], v[28:31], v[88:91]
    v_mfma_f32_16x16x32_bf16 v[80:83], a[68:71], v[28:31], v[80:83]
    v_mfma_f32_16x16x32_bf16 v[84:87], a[72:75], v[28:31], v[84:87]
    buffer_load_dwordx4 v[28:31], v4, s[8:11], s39 offen offset:3072 sc1
    ds_write_b128 v11, v[100:103] offset:2048
    s_waitcnt vmcnt(7)
    v_mfma_f32_16x16x32_bf16 v[72:75], a[40:43], v[32:35], v[72:75]
    v_mfma_f32_16x16x32_bf16 v[76:79], a[44:47], v[32:35], v[76:79]
    v_mfma_f32_16x16x32_bf16 v[88:91], a[56:59], v[32:35], v[88:91]
    v_mfma_f32_16x16x32_bf16 v[80:83], a[48:51], v[32:35], v[80:83]
    v_mfma_f32_16x16x32_bf16 v[84:87], a[52:55], v[32:35], v[84:87]
    s_add_u32 s39, s39, 4096
    buffer_load_dwordx4 v[32:35], v4, s[8:11], s39 offen offset:0 sc1
    ds_write_b128 v11, v[104:107] offset:3072
    s_waitcnt vmcnt(7)
    v_mfma_f32_16x16x32_bf16 v[72:75], a[20:23], v[36:39], v[72:75]
    v_mfma_f32_16x16x32_bf16 v[76:79], a[24:27], v[36:39], v[76:79]
    v_mfma_f32_16x16x32_bf16 v[88:91], a[36:39], v[36:39], v[88:91]
    v_mfma_f32_16x16x32_bf16 v[80:83], a[28:31], v[36:39], v[80:83]
    v_mfma_f32_16x16x32_bf16 v[84:87], a[32:35], v[36:39], v[84:87]
    buffer_load_dwordx4 v[36:39], v4, s[8:11], s39 offen offset:1024 sc1
    s_waitcnt vmcnt(7)
    v_mfma_f32_16x16x32_bf16 v[72:75], a[0:3], v[60:63], v[72:75]
    v_mfma_f32_16x16x32_bf16 v[76:79], a[4:7], v[60:63], v[76:79]
    v_mfma_f32_16x16x32_bf16 v[88:91], a[16:19], v[60:63], v[88:91]
    v_mfma_f32_16x16x32_bf16 v[80:83], a[8:11], v[60:63], v[80:83]
    v_mfma_f32_16x16x32_bf16 v[84:87], a[12:15], v[60:63], v[84:87]
    buffer_load_dwordx4 v[60:63], v4, s[8:11], s39 offen offset:2048 sc1
    s_waitcnt vmcnt(7)
    v_mfma_f32_16x16x32_bf16 v[72:75], v[40:43], v[64:67], v[72:75]
    v_mfma_f32_16x16x32_bf16 v[76:79], v[44:47], v[64:67], v[76:79]
    v_mfma_f32_16x16x32_bf16 v[88:91], v[56:59], v[64:67], v[88:91]
    v_mfma_f32_16x16x32_bf16 v[80:83], v[48:51], v[64:67], v[80:83]
    v_mfma_f32_16x16x32_bf16 v[84:87], v[52:55], v[64:67], v[84:87]
    buffer_load_dwordx4 v[64:67], v4, s[8:11], s39 offen offset:3072 sc1
    s_waitcnt vmcnt(7)
    v_mfma_f32_16x16x32_bf16 v[92:95], a[100:103], v[16:19], 0
    v_mfma_f32_16x16x32_bf16 v[96:99], a[104:107], v[16:19], 0
    v_mfma_f32_16x16x32_bf16 v[108:111], a[116:119], v[16:19], 0
    v_mfma_f32_16x16x32_bf16 v[100:103], a[108:111], v[16:19], 0
    v_mfma_f32_16x16x32_bf16 v[104:107], a[112:115], v[16:19], 0
    ds_write_b128 v8, v[72:75] offset:0
    s_waitcnt vmcnt(6)
    v_mfma_f32_16x16x32_bf16 v[92:95], a[120:123], v[20:23], v[92:95]
    v_mfma_f32_16x16x32_bf16 v[96:99], a[124:127], v[20:23], v[96:99]
    v_mfma_f32_16x16x32_bf16 v[108:111], a[136:139], v[20:23], v[108:111]
    v_mfma_f32_16x16x32_bf16 v[100:103], a[128:131], v[20:23], v[100:103]
    v_mfma_f32_16x16x32_bf16 v[104:107], a[132:135], v[20:23], v[104:107]
    ds_write_b128 v8, v[76:79] offset:1024
    s_waitcnt vmcnt(5)
    v_mfma_f32_16x16x32_bf16 v[92:95], a[80:83], v[24:27], v[92:95]
    v_mfma_f32_16x16x32_bf16 v[96:99], a[84:87], v[24:27], v[96:99]
    v_mfma_f32_16x16x32_bf16 v[108:111], a[96:99], v[24:27], v[108:111]
    v_mfma_f32_16x16x32_bf16 v[100:103], a[88:91], v[24:27], v[100:103]
    v_mfma_f32_16x16x32_bf16 v[104:107], a[92:95], v[24:27], v[104:107]
    ds_write_b128 v8, v[88:91] offset:4096
    s_waitcnt vmcnt(4)
    v_mfma_f32_16x16x32_bf16 v[92:95], a[60:63], v[28:31], v[92:95]
    v_mfma_f32_16x16x32_bf16 v[96:99], a[64:67], v[28:31], v[96:99]
    v_mfma_f32_16x16x32_bf16 v[108:111], a[76:79], v[28:31], v[108:111]
    v_mfma_f32_16x16x32_bf16 v[100:103], a[68:71], v[28:31], v[100:103]
    v_mfma_f32_16x16x32_bf16 v[104:107], a[72:75], v[28:31], v[104:107]
    ds_write_b128 v12, v[80:83] offset:2048
    s_waitcnt vmcnt(3)
    v_mfma_f32_16x16x32_bf16 v[92:95], a[40:43], v[32:35], v[92:95]
    v_mfma_f32_16x16x32_bf16 v[96:99], a[44:47], v[32:35], v[96:99]
    v_mfma_f32_16x16x32_bf16 v[108:111], a[56:59], v[32:35], v[108:111]
    v_mfma_f32_16x16x32_bf16 v[100:103], a[48:51], v[32:35], v[100:103]
    v_mfma_f32_16x16x32_bf16 v[104:107], a[52:55], v[32:35], v[104:107]
    ds_write_b128 v12, v[84:87] offset:3072
    s_waitcnt vmcnt(2)
    v_mfma_f32_16x16x32_bf16 v[92:95], a[20:23], v[36:39], v[92:95]
    v_mfma_f32_16x16x32_bf16 v[96:99], a[24:27], v[36:39], v[96:99]
    v_mfma_f32_16x16x32_bf16 v[108:111], a[36:39], v[36:39], v[108:111]
    v_mfma_f32_16x16x32_bf16 v[100:103], a[28:31], v[36:39], v[100:103]
    v_mfma_f32_16x16x32_bf16 v[104:107], a[32:35], v[36:39], v[104:107]
    s_waitcnt vmcnt(1)
    v_mfma_f32_16x16x32_bf16 v[92:95], a[0:3], v[60:63], v[92:95]
    v_mfma_f32_16x16x32_bf16 v[96:99], a[4:7], v[60:63], v[96:99]
    v_mfma_f32_16x16x32_bf16 v[108:111], a[16:19], v[60:63], v[108:111]
    v_mfma_f32_16x16x32_bf16 v[100:103], a[8:11], v[60:63], v[100:103]
    v_mfma_f32_16x16x32_bf16 v[104:107], a[12:15], v[60:63], v[104:107]
    s_waitcnt vmcnt(0)
    v_mfma_f32_16x16x32_bf16 v[92:95], v[40:43], v[64:67], v[92:95]
    v_mfma_f32_16x16x32_bf16 v[96:99], v[44:47], v[64:67], v[96:99]
    v_mfma_f32_16x16x32_bf16 v[108:111], v[56:59], v[64:67], v[108:111]
    v_mfma_f32_16x16x32_bf16 v[100:103], v[48:51], v[64:67], v[100:103]
    v_mfma_f32_16x16x32_bf16 v[104:107], v[52:55], v[64:67], v[104:107]
    s_nop 3
    ds_write_b128 v9, v[92:95] offset:0
    ds_write_b128 v9, v[96:99] offset:1024
    ds_write_b128 v9, v[108:111] offset:4096
    v_mov_b32 v3, v15
    s_waitcnt lgkmcnt(0)
    s_barrier
    ds_read_b128 v[8:11], v5 offset:0
    ds_read_b128 v[12:15], v5 offset:1024
    ds_read_b128 v[16:19], v5 offset:20480
    ds_read_b128 v[20:23], v5 offset:21504
    ds_read_b128 v[24:27], v5 offset:40960
    ds_read_b128 v[28:31], v5 offset:41984
    ds_read_b128 v[32:35], v6 offset:0
    ds_read_b128 v[36:39], v6 offset:1024
    ds_read_b128 v[40:43], v6 offset:20480
    ds_read_b128 v[44:47], v6 offset:21504
    ds_read_b128 v[48:51], v6 offset:40960
    ds_read_b128 v[52:55], v6 offset:41984
    ds_read_b128 v[56:59], v7 offset:0
    ds_read_b128 v[60:63], v7 offset:1024
    s_waitcnt lgkmcnt(12)
    v_pk_add_f32 v[100:101], v[100:101], v[8:9]
    v_pk_add_f32 v[102:103], v[102:103], v[10:11]
    v_pk_add_f32 v[104:105], v[104:105], v[12:13]
    v_pk_add_f32 v[106:107], v[106:107], v[14:15]
    s_waitcnt lgkmcnt(10)
    v_pk_add_f32 v[100:101], v[100:101], v[16:17]
    v_pk_add_f32 v[102:103], v[102:103], v[18:19]
    v_pk_add_f32 v[104:105], v[104:105], v[20:21]
    v_pk_add_f32 v[106:107], v[106:107], v[22:23]
    s_waitcnt lgkmcnt(8)
    v_pk_add_f32 v[100:101], v[100:101], v[24:25]
    v_pk_add_f32 v[102:103], v[102:103], v[26:27]
    v_pk_add_f32 v[104:105], v[104:105], v[28:29]
    v_pk_add_f32 v[106:107], v[106:107], v[30:31]
    s_waitcnt lgkmcnt(6)
    v_pk_add_f32 v[100:101], v[100:101], v[32:33]
    v_pk_add_f32 v[102:103], v[102:103], v[34:35]
    v_pk_add_f32 v[104:105], v[104:105], v[36:37]
    v_pk_add_f32 v[106:107], v[106:107], v[38:39]
    s_waitcnt lgkmcnt(4)
    v_pk_add_f32 v[100:101], v[100:101], v[40:41]
    v_pk_add_f32 v[102:103], v[102:103], v[42:43]
    v_pk_add_f32 v[104:105], v[104:105], v[44:45]
    v_pk_add_f32 v[106:107], v[106:107], v[46:47]
    s_waitcnt lgkmcnt(2)
    v_pk_add_f32 v[100:101], v[100:101], v[48:49]
    v_pk_add_f32 v[102:103], v[102:103], v[50:51]
    v_pk_add_f32 v[104:105], v[104:105], v[52:53]
    v_pk_add_f32 v[106:107], v[106:107], v[54:55]
    s_waitcnt lgkmcnt(0)
    v_pk_add_f32 v[100:101], v[100:101], v[56:57]
    v_pk_add_f32 v[102:103], v[102:103], v[58:59]
    v_pk_add_f32 v[104:105], v[104:105], v[60:61]
    v_pk_add_f32 v[106:107], v[106:107], v[62:63]
    v_accvgpr_read_b32 v10, a140
    v_lshlrev_b32 v8, 16, v10
    v_and_b32 v9, 0xffff0000, v10
    v_fma_f32 v100, v100, v3, v8
    v_fma_f32 v101, v101, v3, v9
    v_cvt_pk_bf16_f32 v16, v100, v101
    v_accvgpr_read_b32 v10, a141
    v_lshlrev_b32 v8, 16, v10
    v_and_b32 v9, 0xffff0000, v10
    v_fma_f32 v102, v102, v3, v8
    v_fma_f32 v103, v103, v3, v9
    v_cvt_pk_bf16_f32 v17, v102, v103
    v_accvgpr_read_b32 v10, a142
    v_lshlrev_b32 v8, 16, v10
    v_and_b32 v9, 0xffff0000, v10
    v_fma_f32 v104, v104, v3, v8
    v_fma_f32 v105, v105, v3, v9
    v_cvt_pk_bf16_f32 v18, v104, v105
    v_accvgpr_read_b32 v10, a143
    v_lshlrev_b32 v8, 16, v10
    v_and_b32 v9, 0xffff0000, v10
    v_fma_f32 v106, v106, v3, v8
    v_fma_f32 v107, v107, v3, v9
    v_cvt_pk_bf16_f32 v19, v106, v107
    buffer_store_dwordx4 v[16:19], v1, s[20:23], 0 offen
L_dn_e:
L_end:
    s_endpgm
L_attn_slow:
    v_subrev_u32 v3, 103680, v3
    v_mov_b32 v93, 0
    v_mov_b32 v8, 0xff800000
    s_mov_b32 s27, s38
    s_add_u32 s28, s38, 163840
L_attn_slow1:
    buffer_load_dwordx4 v[72:75], v6, s[8:11], s27 offen sc1
    buffer_load_dword v76, v5, s[8:11], s27 offen sc1
    s_waitcnt vmcnt(0)
    v_mfma_f32_32x32x16_bf16 v[16:31], v[72:75], v[88:91], 0
    v_mfma_f32_32x32x8_bf16 v[16:31], v[76:77], v[92:93], v[16:31]
    s_nop 11
    v_max3_f32 v8, v8, v16, v17
    v_max3_f32 v8, v8, v18, v19
    v_max3_f32 v8, v8, v20, v21
    v_max3_f32 v8, v8, v22, v23
    v_max3_f32 v8, v8, v24, v25
    v_max3_f32 v8, v8, v26, v27
    v_max3_f32 v8, v8, v28, v29
    v_max3_f32 v8, v8, v30, v31
    s_add_u32 s27, s27, 2560
    s_cmp_lt_u32 s27, s28
    s_cbranch_scc1 L_attn_slow1
    v_mov_b32 v9, v8
    s_nop 1
    v_permlane32_swap_b32 v8, v9
    v_max_f32 v8, v8, v9
    v_cvt_pk_bf16_f32 v9, -v8, -v8
    v_and_b32 v9, 0xffff0000, v9
    v_sub_f32 v10, -v8, v9
    v_cvt_pk_bf16_f32 v11, v9, v10
    v_and_b32 v9, 0xffff0000, v11
    v_sub_f32 v10, v10, v9
    v_cvt_pk_bf16_f32 v10, v10, 0
    v_cmp_gt_u32 vcc, 32, v0
    s_nop 1
    v_cndmask_b32 v93, v10, v11, vcc
    v_mov_b32 v48, 0
    v_mov_b32 v49, 0
    v_mov_b32 v50, 0
    v_mov_b32 v51, 0
    v_mov_b32 v52, 0
    v_mov_b32 v53, 0
    v_mov_b32 v54, 0
    v_mov_b32 v55, 0
    v_mov_b32 v56, 0
    v_mov_b32 v57, 0
    v_mov_b32 v58, 0
    v_mov_b32 v59, 0
    v_mov_b32 v60, 0
    v_mov_b32 v61, 0
    v_mov_b32 v62, 0
    v_mov_b32 v63, 0
    s_mov_b32 s27, s38
    s_mov_b32 s29, s39
L_attn_slow2:
    buffer_load_dwordx4 v[72:75], v6, s[8:11], s27 offen sc1
    buffer_load_dword v76, v5, s[8:11], s27 offen sc1
    s_mov_b64 exec, s[34:35]
    buffer_load_dwordx4 v[80:83], v3, s[8:11], s29 offen sc1
    buffer_load_dwordx4 v[84:87], v3, s[8:11], s29 offen offset:640 sc1
    s_mov_b64 exec, -1
    s_waitcnt vmcnt(0)
    v_mfma_f32_32x32x16_bf16 v[16:31], v[72:75], v[88:91], 0
    v_mfma_f32_32x32x8_bf16 v[16:31], v[76:77], v[92:93], v[16:31]
    s_nop 11
    v_exp_f32 v16, v16
    v_exp_f32 v17, v17
    v_exp_f32 v18, v18
    v_exp_f32 v19, v19
    v_exp_f32 v20, v20
    v_exp_f32 v21, v21
    v_exp_f32 v22, v22
    v_exp_f32 v23, v23
    v_exp_f32 v24, v24
    v_exp_f32 v25, v25
    v_exp_f32 v26, v26
    v_exp_f32 v27, v27
    v_exp_f32 v28, v28
    v_exp_f32 v29, v29
    v_exp_f32 v30, v30
    v_exp_f32 v31, v31
    v_smfmac_f32_32x32x32_bf16 v[48:63], v[80:83], v[16:23], v79
    s_nop 0
    v_smfmac_f32_32x32x32_bf16 v[48:63], v[84:87], v[24:31], v79
    s_add_u32 s27, s27, 2560
    s_add_u32 s29, s29, 1280
    s_cmp_lt_u32 s27, s28
    s_nop 7
    s_cbranch_scc1 L_attn_slow2
    v_rcp_f32 v8, v58
    s_nop 0
    v_mul_f32 v24, v8, v56
    v_mul_f32 v25, v8, v57
    v_mul_f32 v16, v8, v48
    v_mul_f32 v17, v8, v49
    v_mul_f32 v18, v8, v50
    v_mul_f32 v19, v8, v51
    v_mul_f32 v20, v8, v52
    v_mul_f32 v21, v8, v53
    v_mul_f32 v22, v8, v54
    v_mul_f32 v23, v8, v55
    s_nop 1
    s_branch L_attn_norm
L_code_end:
.section .rodata,"a"
.p2align 6
.amdhsa_kernel sequential_preLN__softmax_full_mha__glu_gated_reglu__prompt_kernel
  .amdhsa_next_free_vgpr 256
  .amdhsa_next_free_sgpr 102
  .amdhsa_accum_offset 112
  .amdhsa_group_segment_fixed_size 0
  .amdhsa_kernarg_size 80
  .amdhsa_user_sgpr_count 2
  .amdhsa_user_sgpr_kernarg_segment_ptr 1
  .amdhsa_system_sgpr_workgroup_id_x 1
  .amdhsa_float_denorm_mode_32 3
  .amdhsa_float_denorm_mode_16_64 3
.end_amdhsa_kernel
```
